```python
import torch

def _softmax(x, axis=-1):
    return torch.softmax(x, dim=axis)
def _gelu(x):
    return torch.nn.functional.gelu(x, approximate="tanh")
def _silu(x):
    return torch.nn.functional.silu(x)
def _sigmoid(x):
    return torch.sigmoid(x)
def _layernorm(x, axis=-1, eps=1e-5):
    m = x.mean(dim=axis, keepdim=True)
    v = x.var(dim=axis, keepdim=True, unbiased=False)
    return (x - m) / torch.sqrt(v + eps)
def _scatter_add(tgt, idx, src, axis=0):
    return tgt.clone().index_add_(axis, idx, src)
def _segment_sum(src, seg, n):
    out = torch.zeros((n,) + src.shape[1:], dtype=src.dtype)
    return out.index_add_(0, seg, src)
def _pad(x, pw):
    flat = tuple(v for pair in reversed(pw) for v in pair)
    return torch.nn.functional.pad(x, flat)

kernel_name = 'parallel_sum__ssm_conv_s4d__mixer_token_mlp__prompt'

def setup_inputs():

    _w = (lambda a: (lambda t: t.to(torch.bfloat16) if t.is_floating_point() else t)(torch.as_tensor(a)))
    def _A_setup():
        Bsz, L, D, N = 1, 2048, 640, 192
        return {
            "u": _w((lambda *s: torch.randn(*s, dtype=torch.bfloat16) * 0.05)(Bsz, L, D)),
            "log_A_real": _w((lambda *s: torch.randn(*s, dtype=torch.bfloat16) * 3.2)(D, N) * 0.5),
            "A_imag": _w((lambda *s: torch.randn(*s, dtype=torch.bfloat16) * 0.05)(D, N) * 3.14),
            "C_real": _w((lambda *s: torch.randn(*s, dtype=torch.bfloat16) * 0.1)(D, N) / N ** 0.5),
            "C_imag": _w((lambda *s: torch.randn(*s, dtype=torch.bfloat16) * 0.1)(D, N) / N ** 0.5),
            "log_dt": _w((lambda *s: torch.randn(*s, dtype=torch.bfloat16) * 0.05)(D) * 0.5 - 4.0),
            "D_skip": _w((lambda *s: torch.randn(*s, dtype=torch.bfloat16) * 0.05)(D)),
        }
    _A_in = _A_setup()

    def _B_setup():
        B, S, D, F = 1, 2048, 640, 1536
        return {
            "x": _w((lambda *s: torch.randn(*s, dtype=torch.bfloat16) * 0.05)(B, S, D)),
            "w1": _w((lambda *s: torch.randn(*s, dtype=torch.bfloat16) * 0.8)(S, F) * (S ** -0.5)),
            "b1": _w((lambda *s: torch.randn(*s, dtype=torch.bfloat16) * 3.2)(F) * 0.02),
            "w2": _w((lambda *s: torch.randn(*s, dtype=torch.bfloat16) * 0.4)(F, S) * (F ** -0.5)),
            "b2": _w((lambda *s: torch.randn(*s, dtype=torch.bfloat16) * 1.6)(S) * 0.02),
        }
    _B_in = _B_setup()

    return {
        "A_u": _A_in["u"],
        "A_log_A_real": _A_in["log_A_real"],
        "A_A_imag": _A_in["A_imag"],
        "A_C_real": _A_in["C_real"],
        "A_C_imag": _A_in["C_imag"],
        "A_log_dt": _A_in["log_dt"],
        "A_D_skip": _A_in["D_skip"],
        "B_x": _B_in["x"],
        "B_w1": _B_in["w1"],
        "B_b1": _B_in["b1"],
        "B_w2": _B_in["w2"],
        "B_b2": _B_in["b2"],
    }

def reference(A_u, A_log_A_real, A_A_imag, A_C_real, A_C_imag, A_log_dt, A_D_skip, B_x, B_w1, B_b1, B_w2, B_b2):
    def _A_ref(u, log_A_real, A_imag, C_real, C_imag, log_dt, D_skip):
        L = u.shape[1]
        dt = torch.exp(log_dt)
        A = -torch.exp(log_A_real) + 1j * A_imag
        C = (C_real + 1j * C_imag) * dt[:, None]
        pos = (lambda x, dt: x.to(dt))(torch.arange(L), log_dt.dtype)
        P = torch.exp((A * dt[:, None])[:, :, None] * pos[None, None, :])
        K = 2.0 * torch.einsum("dn,dnl->dl", C, P).real
        L2 = 2 * L
        u_t = (lambda x, *d: x.permute(*d))(u, 0, 2, 1)
        Kf = (lambda x, *a, **k: torch.fft.rfft(x.float(), *a, **k))(K, L2)
        Uf = (lambda x, *a, **k: torch.fft.rfft(x.float(), *a, **k))(u_t, L2)
        y = (lambda x, *a, **k: torch.fft.irfft(x, *a, **k).to(torch.bfloat16))(Uf * Kf[None, :, :], L2)[:, :, :L]
        y = (lambda x, *d: x.permute(*d))(y, 0, 2, 1)
        return y + u * D_skip[None, None, :]

    def _B_ref(x, w1, b1, w2, b2):
        B, S, D = x.shape
        h = _layernorm(x, axis=-1)
        u = torch.einsum("bsd,sf->bdf", h, w1) + b1
        u = _gelu(u)
        y = torch.einsum("bdf,fs->bds", u, w2) + b2
        return (lambda x, *d: x.permute(*d))(y, 0, 2, 1)

    x = A_u
    xn = _layernorm(x, axis=-1)
    return x + _A_ref(xn, A_log_A_real, A_A_imag, A_C_real, A_C_imag, A_log_dt, A_D_skip) + _B_ref(xn, B_w1, B_b1, B_w2, B_b2)
```

```asm
; @launch grid=(256,1,1) block=(256,1,1) lds=163840
.amdgcn_target "amdgcn-amd-amdhsa--gfx950"
.text
.globl parallel_sum__ssm_conv_s4d__mixer_token_mlp__prompt_kernel
.p2align 8
.type parallel_sum__ssm_conv_s4d__mixer_token_mlp__prompt_kernel,@function
parallel_sum__ssm_conv_s4d__mixer_token_mlp__prompt_kernel:
    s_getpc_b64 s[50:51]
L_pc:
    s_load_dwordx16 s[64:79], s[0:1], 0
    s_load_dwordx8 s[80:87], s[0:1], 64
    s_load_dwordx4 s[88:91], s[0:1], 96
    s_load_dwordx2 s[92:93], s[0:1], 112
    s_cmp_ge_u32 s2, 256
    s_cbranch_scc1 L_end
    s_lshr_b32 s41, s2, 3
    s_mul_i32 s42, s41, 128*((gtab+12288-L_pc+4095)/4096)
    v_lshl_add_u32 v4, v0, 7, s42
    v_min_u32 v4, gtab+12288-L_pc-4, v4
    v_cmp_gt_u32 vcc, ((gtab+12288-L_pc+4095)/4096), v0
    s_nop 0
    s_and_saveexec_b64 s[44:45], vcc
    s_cbranch_execz L_nopf
    global_load_dword v255, v4, s[50:51]
L_nopf:
    s_mov_b64 exec, -1
    v_lshrrev_b32 v4, 5, v0
    v_mul_u32_u24 v4, 1280, v4
    v_and_b32_e64 v5, 31, v0
    v_lshl_add_u32 v4, v5, 3, v4
    v_lshl_add_u32 v5, v5, 3, v4
    s_mul_i32 s42, s2, 10240
    s_waitcnt lgkmcnt(0)
    s_add_u32 s42, s64, s42
    s_addc_u32 s43, s65, 0
    global_load_dwordx4 v[16:19], v5, s[42:43]
    global_load_dwordx4 v[20:23], v5, s[42:43] offset:512
    global_load_dwordx2 v[24:25], v4, s[42:43] offset:1024
    v_lshrrev_b32 v1, 6, v0
    v_and_b32 v0, 63, v0
    v_readfirstlane_b32 s3, v1
    v_lshlrev_b32 v1, 4, v0
    v_add_u32 v2, 4096, v1
    s_and_b32 s40, s2, 7
    s_add_u32 s50, s50, gtab-L_pc
    s_addc_u32 s51, s51, 0
    s_and_b32 s24, s40, 1
    s_lshl_b32 s24, s24, 2
    s_and_b32 s42, s41, 3
    s_add_u32 s24, s24, s42
    s_lshr_b32 s27, s41, 2
    s_lshr_b32 s43, s40, 1
    s_mul_i32 s25, s43, 6
    s_add_u32 s25, s25, s27
    s_lshl_b32 s26, s43, 3
    s_add_u32 s26, s26, s27
    s_mul_i32 s28, s43, 20
    s_lshl_b32 s42, s27, 1
    s_add_u32 s28, s28, s42
    s_cmp_eq_u32 s27, 7
    s_cselect_b32 s42, 2, 0
    s_add_u32 s28, s28, s42
    s_and_b32 s44, s40, 1
    s_cmp_ge_u32 s27, 3
    s_cselect_b32 s42, 0, 0
    s_xor_b32 s42, s42, s44
    s_lshl_b32 s100, s42, 3
    s_lshr_b32 s42, s27, 2
    s_and_b32 s42, s42, 1
    s_xor_b32 s42, s42, s44
    s_add_u32 s43, s27, 1
    s_lshr_b32 s43, s43, 3
    s_xor_b32 s42, s42, s43
    s_mul_i32 s101, s42, 6
    s_mul_i32 s42, s24, 80
    s_add_u32 s28, s28, s42
    s_lshl_b32 s32, s3, 14
    s_add_u32 s33, s32, 65536
    v_mov_b32 v10, 0
    v_mov_b32 v11, 0
    v_mov_b32 v12, 0
    v_mov_b32 v13, 0
    v_mov_b32 v4, 163072
    ds_write_b128 v4, v[10:13]
    s_mov_b32 s8, s92
    s_mov_b32 s9, s93
    s_mov_b32 s10, 0xc00000
    s_mov_b32 s11, 0x20000
    s_mov_b32 s16, s80
    s_mov_b32 s17, s81
    s_mov_b32 s18, 0x600000
    s_mov_b32 s19, 0x20000
    s_mov_b32 s56, 0x3fb8aa3b
    s_mov_b32 s57, 0x32a57060
    s_mov_b32 s58, 0x3f317218
    s_cmp_lt_u32 s27, 6
    s_cbranch_scc0 L_F
    s_and_b32 s42, s3, 1
    s_add_u32 s35, s28, s42
    s_mul_i32 s42, s35, 384
    s_and_b32 s43, s3, 2
    s_lshl_b32 s43, s43, 7
    s_add_u32 s43, s43, s42
    v_lshl_add_u32 v6, v0, 1, s43
    v_lshl_add_u32 v7, v0, 1, s42
    s_lshl_b32 s42, s35, 1
    v_mov_b32 v8, s42
    global_load_ushort v96, v6, s[66:67]
    global_load_ushort v97, v6, s[68:69]
    global_load_ushort v98, v6, s[70:71]
    global_load_ushort v99, v6, s[72:73]
    global_load_ushort v104, v8, s[74:75]
    global_load_ushort v91, v8, s[76:77]
    global_load_ushort v100, v7, s[66:67] offset:128
    global_load_ushort v101, v7, s[68:69] offset:128
    global_load_ushort v102, v7, s[70:71] offset:128
    global_load_ushort v103, v7, s[72:73] offset:128
    s_lshl_b32 s42, s25, 7
    s_lshl_b32 s43, s3, 5
    s_add_u32 s42, s42, s43
    v_lshrrev_b32 v88, 4, v0
    v_lshl_add_u32 v88, v88, 3, s42
    global_load_dwordx2 v[14:15], v88, s[82:83]
    s_mov_b32 s4, s80
    s_mov_b32 s5, s81
    s_mov_b32 s6, 0x600000
    s_mov_b32 s7, 0x20000
    v_lshrrev_b32_e64 v6, 3, v0
    v_mul_u32_u24 v3, 3072, v6
    v_bfe_u32 v6, v6, 1, 1
    v_bfe_u32 v7, v0, 1, 2
    v_xor_b32 v7, v7, v6
    v_lshl_add_u32 v3, v7, 5, v3
    v_and_b32 v6, 1, v0
    v_lshl_add_u32 v3, v6, 4, v3
    v_xor_b32_e64 v4, 64, v3
    v_add_u32 v252, 47104, v3
    v_add_u32 v253, 70656, v4
    v_add_u32 v4, 23552, v4
    s_mul_i32 s34, s3, 1572864
    s_lshl_b32 s42, s25, 7
    s_add_u32 s34, s34, s42
    v_bfe_u32 v168, v0, 2, 2
    v_bfe_u32 v169, v0, 4, 1
    v_lshrrev_b32 v170, 4, v0
    v_lshl_add_u32 v170, v170, 3, v168
    v_lshlrev_b32 v170, 7, v170
    v_lshrrev_b32 v168, 1, v168
    v_lshl_or_b32 v168, v169, 1, v168
    v_xor_b32 v168, s3, v168
    v_lshl_add_u32 v170, v168, 5, v170
    v_and_b32 v168, 3, v0
    v_lshl_add_u32 v170, v168, 3, v170
    v_add_u32 v5, s32, v170
    v_xor_b32 v6, 32, v5
    v_xor_b32 v7, 64, v5
    v_xor_b32 v8, 96, v5
    v_add_u32_e64 v106, s33, v1
    v_bfe_u32 v76, v0, 2, 1
    v_bfe_u32 v77, v0, 4, 1
    v_lshl_or_b32 v76, v76, 1, v77
    v_bfe_u32 v77, v0, 1, 1
    v_lshl_or_b32 v76, v76, 1, v77
    v_mul_u32_u24 v76, 1056, v76
    v_lshrrev_b32_e64 v77, 5, v0
    v_lshl_add_u32 v76, v77, 6, v76
    v_bfe_u32 v77, v0, 3, 1
    v_lshl_add_u32 v76, v77, 4, v76
    v_and_b32 v77, 1, v0
    v_lshl_add_u32 v76, v77, 3, v76
    v_add_u32 v108, s33, v76
    v_lshrrev_b32 v64, 5, v0
    s_lshl_b32 s42, s3, 1
    v_add_u32 v64, s42, v64
    v_lshlrev_b32 v69, 2, v64
    v_mul_u32_u24 v64, 1344, v64
    v_add_u32 v64, 131072, v64
    v_and_b32_e64 v65, 31, v0
    v_lshl_add_u32 v64, v65, 3, v64
    v_lshl_add_u32 v65, v65, 3, v64
    v_add_u32 v69, 141824, v69
    v_bfe_u32 v66, v0, 2, 2
    v_mul_u32_u24 v66, 1344, v66
    v_lshrrev_b32 v67, 4, v0
    v_lshl_add_u32 v66, v67, 5, v66
    v_and_b32 v56, 3, v0
    v_lshl_add_u32 v66, v56, 3, v66
    v_add_u32 v66, 131072, v66
    v_lshlrev_b32 v67, 10, v67
    v_and_b32 v56, 15, v0
    v_lshl_add_u32 v67, v56, 4, v67
    s_lshr_b32 s43, s2, 2
    s_mul_i32 s43, s43, 40960
    s_and_b32 s44, s2, 3
    s_lshl_b32 s44, s44, 8
    s_add_u32 s43, s43, s44
    s_lshl_b32 s45, s2, 5
    s_add_u32 s45, s45, 0xa30000
    v_add_u32 v68, 141824, v1
    s_mov_b32 s42, 0x3acccccd
    v_mov_b32 v61, 0x3727c5ac
    s_cmp_eq_u32 s3, 3
    s_cbranch_scc0 L_tw1
    s_cmp_eq_u32 s2, 0
    s_cbranch_scc0 L_tw3
    s_memrealtime s[30:31]
    v_mov_b32 v72, 0
    s_waitcnt lgkmcnt(0)
    s_or_b32 s31, s31, 0x40000000
    v_mov_b32 v70, s30
    v_mov_b32 v71, s31
    s_mov_b64 exec, 1
    global_store_dwordx2 v72, v[70:71], s[90:91] sc1
    s_mov_b64 exec, -1
    v_mul_u32_u24 v74, 43, v0
    v_lshrrev_b32 v74, 8, v74
    v_mul_u32_u24 v74, 2304, v74
    v_lshl_add_u32 v74, v0, 7, v74
    s_lshr_b32 s29, s41, 3
    s_lshl_b32 s29, s29, 5
    s_and_b32 s55, s41, 7
    s_add_u32 s29, s29, s55
    s_lshl_b32 s55, s100, 1
    s_add_u32 s29, s29, s55
    s_mul_i32 s29, s29, 49152
    s_lshr_b32 s55, s40, 1
    s_mul_i32 s55, s55, 768
    s_add_u32 s29, s29, s55
    s_mov_b32 exec_hi, 0xffff
    buffer_load_dword v254, v74, s[16:19], s29 offen
    s_add_u32 s29, s29, 24576
    buffer_load_dword v254, v74, s[16:19], s29 offen
    s_mov_b64 exec, -1
    s_waitcnt vmcnt(14)
    s_branch L_tw2
L_tw3:
    v_mul_u32_u24 v74, 43, v0
    v_lshrrev_b32 v74, 8, v74
    v_mul_u32_u24 v74, 2304, v74
    v_lshl_add_u32 v74, v0, 7, v74
    s_lshr_b32 s29, s41, 3
    s_lshl_b32 s29, s29, 5
    s_and_b32 s55, s41, 7
    s_add_u32 s29, s29, s55
    s_lshl_b32 s55, s100, 1
    s_add_u32 s29, s29, s55
    s_mul_i32 s29, s29, 49152
    s_lshr_b32 s55, s40, 1
    s_mul_i32 s55, s55, 768
    s_add_u32 s29, s29, s55
    s_mov_b32 exec_hi, 0xffff
    buffer_load_dword v254, v74, s[16:19], s29 offen
    s_add_u32 s29, s29, 24576
    buffer_load_dword v254, v74, s[16:19], s29 offen
    s_mov_b64 exec, -1
    s_waitcnt vmcnt(13)
    s_branch L_tw2
L_tw1:
    s_waitcnt vmcnt(11)
L_tw2:
    v_lshlrev_b32 v36, 16, v16
    v_and_b32 v37, 0xffff0000, v16
    v_lshlrev_b32 v38, 16, v17
    v_and_b32 v39, 0xffff0000, v17
    v_lshlrev_b32 v40, 16, v18
    v_and_b32 v41, 0xffff0000, v18
    v_lshlrev_b32 v42, 16, v19
    v_and_b32 v43, 0xffff0000, v19
    v_lshlrev_b32 v44, 16, v20
    v_and_b32 v45, 0xffff0000, v20
    v_lshlrev_b32 v46, 16, v21
    v_and_b32 v47, 0xffff0000, v21
    v_lshlrev_b32 v48, 16, v22
    v_and_b32 v49, 0xffff0000, v22
    v_lshlrev_b32 v50, 16, v23
    v_and_b32 v51, 0xffff0000, v23
    v_lshlrev_b32 v52, 16, v24
    v_and_b32 v53, 0xffff0000, v24
    v_lshlrev_b32_e64 v54, 16, v25
    v_and_b32 v55, 0xffff0000, v25
    v_pk_add_f32 v[56:57], v[36:37], v[38:39]
    v_pk_add_f32 v[58:59], v[40:41], v[42:43]
    v_pk_add_f32 v[56:57], v[56:57], v[44:45]
    v_pk_add_f32 v[58:59], v[58:59], v[46:47]
    v_pk_add_f32 v[56:57], v[56:57], v[48:49]
    v_pk_add_f32 v[58:59], v[58:59], v[50:51]
    v_pk_add_f32 v[56:57], v[56:57], v[52:53]
    v_pk_add_f32 v[58:59], v[58:59], v[54:55]
    v_pk_add_f32 v[56:57], v[56:57], v[58:59]
    v_add_f32 v56, v56, v57
    s_nop 1
    v_add_f32_dpp v56, v56, v56 quad_perm:[1,0,3,2] row_mask:0xf bank_mask:0xf
    s_nop 1
    v_add_f32_dpp v56, v56, v56 quad_perm:[2,3,0,1] row_mask:0xf bank_mask:0xf
    s_nop 1
    v_add_f32_dpp v56, v56, v56 row_half_mirror row_mask:0xf bank_mask:0xf
    s_nop 1
    v_add_f32_dpp v56, v56, v56 row_mirror row_mask:0xf bank_mask:0xf
    v_mov_b32 v57, v56
    s_nop 1
    v_permlane16_swap_b32 v56, v57
    v_add_f32_e64 v56, v56, v57
    v_mul_f32 v60, 0xbacccccd, v56
    v_pk_add_f32 v[36:37], v[36:37], v[60:61] op_sel_hi:[1,0]
    v_pk_add_f32 v[38:39], v[38:39], v[60:61] op_sel_hi:[1,0]
    v_pk_add_f32 v[40:41], v[40:41], v[60:61] op_sel_hi:[1,0]
    v_pk_add_f32 v[42:43], v[42:43], v[60:61] op_sel_hi:[1,0]
    v_pk_add_f32 v[44:45], v[44:45], v[60:61] op_sel_hi:[1,0]
    v_pk_add_f32 v[46:47], v[46:47], v[60:61] op_sel_hi:[1,0]
    v_pk_add_f32 v[48:49], v[48:49], v[60:61] op_sel_hi:[1,0]
    v_pk_add_f32 v[50:51], v[50:51], v[60:61] op_sel_hi:[1,0]
    v_pk_add_f32 v[52:53], v[52:53], v[60:61] op_sel_hi:[1,0]
    v_pk_add_f32 v[54:55], v[54:55], v[60:61] op_sel_hi:[1,0]
    v_pk_mul_f32 v[56:57], v[36:37], v[36:37]
    v_pk_mul_f32 v[58:59], v[38:39], v[38:39]
    v_pk_fma_f32 v[56:57], v[40:41], v[40:41], v[56:57]
    v_pk_fma_f32 v[58:59], v[42:43], v[42:43], v[58:59]
    v_pk_fma_f32 v[56:57], v[44:45], v[44:45], v[56:57]
    v_pk_fma_f32 v[58:59], v[46:47], v[46:47], v[58:59]
    v_pk_fma_f32 v[56:57], v[48:49], v[48:49], v[56:57]
    v_pk_fma_f32 v[58:59], v[50:51], v[50:51], v[58:59]
    v_pk_fma_f32 v[56:57], v[52:53], v[52:53], v[56:57]
    v_pk_fma_f32 v[58:59], v[54:55], v[54:55], v[58:59]
    v_pk_add_f32 v[56:57], v[56:57], v[58:59]
    v_add_f32 v56, v56, v57
    s_nop 1
    v_add_f32_dpp v56, v56, v56 quad_perm:[1,0,3,2] row_mask:0xf bank_mask:0xf
    s_nop 1
    v_add_f32_dpp v56, v56, v56 quad_perm:[2,3,0,1] row_mask:0xf bank_mask:0xf
    s_nop 1
    v_add_f32_dpp v56, v56, v56 row_half_mirror row_mask:0xf bank_mask:0xf
    s_nop 1
    v_add_f32_dpp v56, v56, v56 row_mirror row_mask:0xf bank_mask:0xf
    v_mov_b32 v57, v56
    s_nop 1
    v_permlane16_swap_b32 v56, v57
    v_add_f32 v56, v56, v57
    v_mul_f32 v56, s42, v56
    v_add_f32 v58, v56, v61
    v_rsq_f32 v58, v58
    s_nop 0
    v_mul_f32 v56, v56, v58
    v_fma_f32 v56, v56, v58, v61
    v_rsq_f32 v57, v56
    s_nop 0
    v_mul_f32 v58, v57, v58
    v_mul_f32 v56, v56, v57
    v_pk_mul_f32 v[70:71], v[36:37], v[58:59] op_sel_hi:[1,0]
    v_cvt_pk_bf16_f32 v26, v70, v71
    v_pk_mul_f32 v[72:73], v[38:39], v[58:59] op_sel_hi:[1,0]
    v_cvt_pk_bf16_f32 v27, v72, v73
    v_pk_mul_f32 v[70:71], v[40:41], v[58:59] op_sel_hi:[1,0]
    v_cvt_pk_bf16_f32 v28, v70, v71
    v_pk_mul_f32 v[72:73], v[42:43], v[58:59] op_sel_hi:[1,0]
    v_cvt_pk_bf16_f32 v29, v72, v73
    v_pk_mul_f32 v[70:71], v[44:45], v[58:59] op_sel_hi:[1,0]
    v_cvt_pk_bf16_f32 v30, v70, v71
    v_pk_mul_f32 v[72:73], v[46:47], v[58:59] op_sel_hi:[1,0]
    v_cvt_pk_bf16_f32 v31, v72, v73
    v_pk_mul_f32 v[70:71], v[48:49], v[58:59] op_sel_hi:[1,0]
    v_cvt_pk_bf16_f32 v32, v70, v71
    v_pk_mul_f32 v[72:73], v[50:51], v[58:59] op_sel_hi:[1,0]
    v_cvt_pk_bf16_f32 v33, v72, v73
    v_pk_mul_f32 v[70:71], v[52:53], v[58:59] op_sel_hi:[1,0]
    v_cvt_pk_bf16_f32 v34, v70, v71
    v_pk_mul_f32 v[72:73], v[54:55], v[58:59] op_sel_hi:[1,0]
    v_cvt_pk_bf16_f32 v35, v72, v73
    ds_write_b128 v65, v[26:29]
    ds_write_b128 v65, v[30:33] offset:512
    ds_write_b64 v64, v[34:35] offset:1024
    ds_write_b32 v69, v56
    s_waitcnt lgkmcnt(0)
    s_barrier
    s_cmp_eq_u32 s3, 2
    s_cbranch_scc0 L_ln4
    ds_read_b64_tr_b16 v[16:17], v66 offset:0
    ds_read_b64_tr_b16 v[18:19], v66 offset:5376
    ds_read_b64_tr_b16 v[20:21], v66 offset:128
    ds_read_b64_tr_b16 v[22:23], v66 offset:5504
    ds_read_b64_tr_b16 v[24:25], v66 offset:256
    ds_read_b64_tr_b16 v[26:27], v66 offset:5632
    ds_read_b64_tr_b16 v[28:29], v66 offset:384
    ds_read_b64_tr_b16 v[30:31], v66 offset:5760
    ds_read_b64_tr_b16 v[32:33], v66 offset:512
    ds_read_b64_tr_b16 v[34:35], v66 offset:5888
    ds_read_b64_tr_b16 v[36:37], v66 offset:640
    ds_read_b64_tr_b16 v[38:39], v66 offset:6016
    ds_read_b64_tr_b16 v[40:41], v66 offset:768
    ds_read_b64_tr_b16 v[42:43], v66 offset:6144
    s_waitcnt vmcnt(0)
    s_waitcnt lgkmcnt(12)
    buffer_store_dwordx4 v[16:19], v67, s[8:11], s43 offen sc1
    s_add_u32 s43, s43, 4096
    ds_read_b64_tr_b16 v[44:45], v66 offset:896
    ds_read_b64_tr_b16 v[46:47], v66 offset:6272
    s_waitcnt lgkmcnt(12)
    buffer_store_dwordx4 v[20:23], v67, s[8:11], s43 offen sc1
    s_add_u32 s43, s43, 4096
    ds_read_b64_tr_b16 v[48:49], v66 offset:1024
    ds_read_b64_tr_b16 v[50:51], v66 offset:6400
    s_waitcnt lgkmcnt(12)
    buffer_store_dwordx4 v[24:27], v67, s[8:11], s43 offen sc1
    s_add_u32 s43, s43, 4096
    ds_read_b64_tr_b16 v[52:53], v66 offset:1152
    ds_read_b64_tr_b16 v[54:55], v66 offset:6528
    s_waitcnt lgkmcnt(12)
    buffer_store_dwordx4 v[28:31], v67, s[8:11], s43 offen sc1
    s_add_u32 s43, s43, 4096
    s_waitcnt lgkmcnt(10)
    buffer_store_dwordx4 v[32:35], v67, s[8:11], s43 offen sc1
    s_add_u32 s43, s43, 4096
    s_waitcnt lgkmcnt(8)
    buffer_store_dwordx4 v[36:39], v67, s[8:11], s43 offen sc1
    s_add_u32 s43, s43, 4096
    s_waitcnt lgkmcnt(6)
    buffer_store_dwordx4 v[40:43], v67, s[8:11], s43 offen sc1
    s_add_u32 s43, s43, 4096
    s_waitcnt lgkmcnt(4)
    buffer_store_dwordx4 v[44:47], v67, s[8:11], s43 offen sc1
    s_add_u32 s43, s43, 4096
    s_waitcnt lgkmcnt(2)
    buffer_store_dwordx4 v[48:51], v67, s[8:11], s43 offen sc1
    s_add_u32 s43, s43, 4096
    s_waitcnt lgkmcnt(0)
    buffer_store_dwordx4 v[52:55], v67, s[8:11], s43 offen sc1
    s_add_u32 s43, s43, 4096
    s_mov_b64 exec, 3
    ds_read_b128 v[56:59], v68
    s_waitcnt lgkmcnt(0)
    buffer_store_dwordx4 v[56:59], v1, s[8:11], s45 offen sc1
    s_mov_b64 exec, -1
    v_mov_b32 v242, 0
    global_load_dwordx2 v[240:241], v242, s[90:91] sc1
    s_branch L_ln6
L_ln4:
    s_cmp_eq_u32 s3, 3
    s_cbranch_scc1 L_ln5
    s_waitcnt vmcnt(0)
    s_branch L_ln6
L_ln5:
    s_cmp_eq_u32 s2, 0
    s_cbranch_scc1 L_ln7
    s_waitcnt vmcnt(2)
L_ln7:
    s_waitcnt vmcnt(3)
L_ln6:
    s_lshl_b32 s42, s3, 6
    v_add_u32 v90, s42, v0
    v_mul_u32_u24 v90, 64, v90
    s_mov_b32 s38, 0xa00000
    v_lshlrev_b32 v104, 16, v104
    v_lshlrev_b32 v91, 16, v91
    v_mul_f32 v73, s56, v104
    v_fma_f32 v74, v104, s56, -v73
    v_fma_f32 v74, v104, s57, v74
    v_exp_f32 v72, v73
    v_mul_f32 v74, s58, v74
    v_fma_f32 v72, v72, v74, v72
    v_cvt_pk_bf16_f32 v104, v72, v72
    v_and_b32 v104, 0xffff0000, v104
    v_add_f32 v105, v104, v104
    v_subrev_u32 v84, 32768, v108
    v_lshrrev_b32 v76, 5, v0
    v_lshlrev_b32 v76, 9, v76
    v_and_b32 v75, 31, v0
    v_lshl_add_u32 v76, v75, 2, v76
    s_and_b32 s42, s3, 1
    s_mul_i32 s42, s42, 3072
    s_add_u32 s42, s42, 156928
    v_add_u32 v89, s42, v76
    v_lshlrev_b32 v96, 16, v96
    v_lshlrev_b32 v97, 16, v97
    v_lshlrev_b32 v98, 16, v98
    v_lshlrev_b32 v99, 16, v99
    v_mul_f32 v142, s56, v96
    v_fma_f32 v143, v96, s56, -v142
    v_fma_f32 v143, v96, s57, v143
    v_exp_f32 v128, v142
    v_mul_f32_e64 v143, s58, v143
    v_fma_f32 v128, v128, v143, v128
    v_pk_mul_f32 v[130:131], v[98:99], v[104:105] op_sel:[0,1] op_sel_hi:[1,1]
    v_cvt_pk_bf16_f32 v128, v128, v128
    v_and_b32 v128, 0xffff0000, v128
    v_mul_f32 v129, v97, v104
    v_mul_f32 v128, v128, v104
    v_mul_f32 v129, 0.15915494, v129
    v_mul_f32 v128, 0xbfb8aa3b, v128
    v_fract_f32 v143, v129
    v_exp_f32 v142, v128
    v_cos_f32 v132, v143
    v_sin_f32 v133, v143
    s_nop 0
    v_pk_mul_f32 v[132:133], v[132:133], v[142:143] op_sel_hi:[1,0]
    v_mul_f32 v142, 0x43800000, v128
    v_mul_f32 v143, 0x43800000, v129
    v_fract_f32 v143, v143
    v_exp_f32 v142, v142
    v_cos_f32 v140, v143
    v_sin_f32 v141, v143
    s_nop 0
    v_pk_mul_f32 v[140:141], v[140:141], v[142:143] op_sel_hi:[1,0]
    v_mul_f32 v142, 0x41000000, v128
    v_mul_f32 v143, 0x41000000, v129
    v_fract_f32 v143, v143
    v_exp_f32 v142, v142
    v_cos_f32 v138, v143
    v_sin_f32 v139, v143
    s_nop 0
    v_pk_mul_f32 v[138:139], v[138:139], v[142:143] op_sel_hi:[1,0]
    v_pk_mul_f32 v[142:143], v[132:133], v[132:133] op_sel_hi:[1,0]
    v_pk_fma_f32 v[134:135], v[132:133], v[132:133], v[142:143] op_sel:[1,1,0] op_sel_hi:[0,1,1] neg_lo:[1,0,0]
    v_pk_mul_f32 v[142:143], v[134:135], v[134:135] op_sel_hi:[1,0]
    v_pk_fma_f32 v[136:137], v[134:135], v[134:135], v[142:143] op_sel:[1,1,0] op_sel_hi:[0,1,1] neg_lo:[1,0,0]
    v_pk_mul_f32 v[142:143], v[130:131], v[132:133] op_sel_hi:[1,0]
    v_pk_fma_f32 v[146:147], v[130:131], v[132:133], v[142:143] op_sel:[1,1,0] op_sel_hi:[0,1,1] neg_lo:[1,0,0]
    v_cvt_pk_bf16_f32 v150, v130, v146
    v_cvt_pk_bf16_f32 v154, -v131, -v147
    v_pk_mul_f32 v[142:143], v[146:147], v[132:133] op_sel_hi:[1,0]
    v_pk_fma_f32 v[144:145], v[146:147], v[132:133], v[142:143] op_sel:[1,1,0] op_sel_hi:[0,1,1] neg_lo:[1,0,0]
    v_pk_mul_f32 v[142:143], v[144:145], v[132:133] op_sel_hi:[1,0]
    v_pk_fma_f32 v[146:147], v[144:145], v[132:133], v[142:143] op_sel:[1,1,0] op_sel_hi:[0,1,1] neg_lo:[1,0,0]
    v_cvt_pk_bf16_f32 v151, v144, v146
    v_cvt_pk_bf16_f32 v155, -v145, -v147
    v_pk_mul_f32 v[142:143], v[146:147], v[132:133] op_sel_hi:[1,0]
    v_pk_fma_f32 v[144:145], v[146:147], v[132:133], v[142:143] op_sel:[1,1,0] op_sel_hi:[0,1,1] neg_lo:[1,0,0]
    v_pk_mul_f32 v[142:143], v[144:145], v[132:133] op_sel_hi:[1,0]
    v_pk_fma_f32 v[146:147], v[144:145], v[132:133], v[142:143] op_sel:[1,1,0] op_sel_hi:[0,1,1] neg_lo:[1,0,0]
    v_cvt_pk_bf16_f32 v152, v144, v146
    v_cvt_pk_bf16_f32 v156, -v145, -v147
    v_pk_mul_f32 v[142:143], v[146:147], v[132:133] op_sel_hi:[1,0]
    v_pk_fma_f32 v[144:145], v[146:147], v[132:133], v[142:143] op_sel:[1,1,0] op_sel_hi:[0,1,1] neg_lo:[1,0,0]
    v_pk_mul_f32 v[142:143], v[144:145], v[132:133] op_sel_hi:[1,0]
    v_pk_fma_f32 v[146:147], v[144:145], v[132:133], v[142:143] op_sel:[1,1,0] op_sel_hi:[0,1,1] neg_lo:[1,0,0]
    v_cvt_pk_bf16_f32 v153, v144, v146
    v_cvt_pk_bf16_f32 v157, -v145, -v147
    ds_write_b128 v106, v[150:153] offset:8448
    ds_write_b128 v106, v[154:157] offset:12672
    v_pk_mul_f32 v[142:143], v[130:131], v[140:141] op_sel_hi:[1,0]
    v_pk_fma_f32 v[148:149], v[130:131], v[140:141], v[142:143] op_sel:[1,1,0] op_sel_hi:[0,1,1] neg_lo:[1,0,0]
    v_pk_mul_f32 v[142:143], v[148:149], v[134:135] op_sel_hi:[1,0]
    v_pk_fma_f32 v[146:147], v[148:149], v[134:135], v[142:143] op_sel:[1,1,0] op_sel_hi:[0,1,1] neg_lo:[1,0,0]
    v_cvt_pk_bf16_f32 v158, v148, v146
    v_cvt_pk_bf16_f32 v162, -v149, -v147
    v_pk_mul_f32 v[142:143], v[146:147], v[134:135] op_sel_hi:[1,0]
    v_pk_fma_f32 v[144:145], v[146:147], v[134:135], v[142:143] op_sel:[1,1,0] op_sel_hi:[0,1,1] neg_lo:[1,0,0]
    v_pk_mul_f32 v[142:143], v[144:145], v[134:135] op_sel_hi:[1,0]
    v_pk_fma_f32 v[146:147], v[144:145], v[134:135], v[142:143] op_sel:[1,1,0] op_sel_hi:[0,1,1] neg_lo:[1,0,0]
    v_cvt_pk_bf16_f32 v159, v144, v146
    v_cvt_pk_bf16_f32 v163, -v145, -v147
    v_pk_mul_f32 v[142:143], v[148:149], v[140:141] op_sel_hi:[1,0]
    v_pk_fma_f32 v[148:149], v[148:149], v[140:141], v[142:143] op_sel:[1,1,0] op_sel_hi:[0,1,1] neg_lo:[1,0,0]
    v_pk_mul_f32 v[142:143], v[148:149], v[136:137] op_sel_hi:[1,0]
    v_pk_fma_f32 v[146:147], v[148:149], v[136:137], v[142:143] op_sel:[1,1,0] op_sel_hi:[0,1,1] neg_lo:[1,0,0]
    v_cvt_pk_bf16_f32 v160, v148, v146
    v_cvt_pk_bf16_f32 v164, -v149, -v147
    v_pk_mul_f32 v[142:143], v[148:149], v[140:141] op_sel_hi:[1,0]
    v_pk_fma_f32 v[148:149], v[148:149], v[140:141], v[142:143] op_sel:[1,1,0] op_sel_hi:[0,1,1] neg_lo:[1,0,0]
    v_pk_mul_f32 v[142:143], v[148:149], v[136:137] op_sel_hi:[1,0]
    v_pk_fma_f32 v[146:147], v[148:149], v[136:137], v[142:143] op_sel:[1,1,0] op_sel_hi:[0,1,1] neg_lo:[1,0,0]
    v_cvt_pk_bf16_f32 v161, v148, v146
    v_cvt_pk_bf16_f32 v165, -v149, -v147
    ds_write_b128 v106, v[158:161] offset:9504
    ds_write_b128 v106, v[162:165] offset:13728
    v_pk_mul_f32 v[142:143], v[148:149], v[140:141] op_sel_hi:[1,0]
    v_pk_fma_f32 v[144:145], v[148:149], v[140:141], v[142:143] op_sel:[1,1,0] op_sel_hi:[0,1,1] neg_lo:[1,0,0]
    v_pk_mul_f32 v[142:143], v[144:145], v[140:141] op_sel_hi:[1,0]
    v_pk_fma_f32 v[146:147], v[144:145], v[140:141], v[142:143] op_sel:[1,1,0] op_sel_hi:[0,1,1] neg_lo:[1,0,0]
    v_cvt_pk_bf16_f32 v150, v144, v146
    v_cvt_pk_bf16_f32 v154, -v145, -v147
    v_pk_mul_f32 v[142:143], v[146:147], v[140:141] op_sel_hi:[1,0]
    v_pk_fma_f32 v[144:145], v[146:147], v[140:141], v[142:143] op_sel:[1,1,0] op_sel_hi:[0,1,1] neg_lo:[1,0,0]
    v_pk_mul_f32 v[142:143], v[144:145], v[140:141] op_sel_hi:[1,0]
    v_pk_fma_f32 v[146:147], v[144:145], v[140:141], v[142:143] op_sel:[1,1,0] op_sel_hi:[0,1,1] neg_lo:[1,0,0]
    v_cvt_pk_bf16_f32 v151, v144, v146
    v_cvt_pk_bf16_f32 v155, -v145, -v147
    v_pk_mul_f32 v[142:143], v[146:147], v[140:141] op_sel_hi:[1,0]
    v_pk_fma_f32 v[144:145], v[146:147], v[140:141], v[142:143] op_sel:[1,1,0] op_sel_hi:[0,1,1] neg_lo:[1,0,0]
    v_cvt_pk_bf16_f32 v152, v144, 0
    v_cvt_pk_bf16_f32 v156, -v145, 0
    ds_write_b128 v106, v[150:153] offset:10560
    ds_write_b128 v106, v[154:157] offset:14784
    v_cvt_pk_bf16_f32 v158, 1.0, v138
    v_cvt_pk_bf16_f32 v162, 0, v139
    s_cmp_eq_u32 s3, 1
    s_cbranch_scc0 L_noo0
    s_lshr_b32 s29, s40, 1
    s_mul_i32 s29, s29, 768
    s_lshl_b32 s55, s41, 7
    s_add_u32 s55, s55, 0
    v_add_u32 v72, s55, v0
    s_mov_b32 s55, 715827883
    v_mul_hi_u32 v73, s55, v72
    v_mul_u32_u24 v74, 6, v73
    v_sub_u32 v72, v72, v74
    v_bfe_u32 v74, v73, 7, 2
    v_mul_u32_u24 v74, 384, v74
    v_add_u32 v74, v74, v73
    v_lshrrev_b32 v73, 9, v73
    v_mul_u32_u24 v73, 384, v73
    v_sub_u32 v73, v74, v73
    s_and_b32 s55, s40, 1
    s_xor_b32 s55, s55, 1
    v_mov_b32 v74, s55
    v_lshl_add_u32 v73, v74, 8, v73
    v_mul_u32_u24 v73, 3072, v73
    v_lshl_add_u32 v72, v72, 7, v73
    buffer_load_dword v254, v72, s[16:19], s29 offen
    s_lshl_b32 s55, s41, 7
    s_add_u32 s55, s55, 64
    v_add_u32 v72, s55, v0
    s_mov_b32 s55, 715827883
    v_mul_hi_u32 v73, s55, v72
    v_mul_u32_u24 v74, 6, v73
    v_sub_u32 v72, v72, v74
    v_bfe_u32 v74, v73, 7, 2
    v_mul_u32_u24 v74, 384, v74
    v_add_u32 v74, v74, v73
    v_lshrrev_b32 v73, 9, v73
    v_mul_u32_u24 v73, 384, v73
    v_sub_u32 v73, v74, v73
    s_and_b32 s55, s40, 1
    s_xor_b32 s55, s55, 1
    v_mov_b32_e64 v74, s55
    v_lshl_add_u32 v73, v74, 8, v73
    v_mul_u32_u24 v73, 3072, v73
    v_lshl_add_u32 v72, v72, 7, v73
    buffer_load_dword v254, v72, s[16:19], s29 offen
L_noo0:
    v_pk_mul_f32 v[142:143], v[138:139], v[138:139] op_sel_hi:[1,0]
    v_pk_fma_f32 v[144:145], v[138:139], v[138:139], v[142:143] op_sel:[1,1,0] op_sel_hi:[0,1,1] neg_lo:[1,0,0]
    v_pk_mul_f32 v[142:143], v[144:145], v[138:139] op_sel_hi:[1,0]
    v_pk_fma_f32 v[146:147], v[144:145], v[138:139], v[142:143] op_sel:[1,1,0] op_sel_hi:[0,1,1] neg_lo:[1,0,0]
    v_cvt_pk_bf16_f32 v159, v144, v146
    v_cvt_pk_bf16_f32 v163, v145, v147
    v_pk_mul_f32 v[142:143], v[146:147], v[138:139] op_sel_hi:[1,0]
    v_pk_fma_f32 v[144:145], v[146:147], v[138:139], v[142:143] op_sel:[1,1,0] op_sel_hi:[0,1,1] neg_lo:[1,0,0]
    v_pk_mul_f32 v[142:143], v[144:145], v[138:139] op_sel_hi:[1,0]
    v_pk_fma_f32 v[146:147], v[144:145], v[138:139], v[142:143] op_sel:[1,1,0] op_sel_hi:[0,1,1] neg_lo:[1,0,0]
    v_cvt_pk_bf16_f32 v160, v144, v146
    v_cvt_pk_bf16_f32 v164, v145, v147
    v_pk_mul_f32 v[142:143], v[146:147], v[138:139] op_sel_hi:[1,0]
    v_pk_fma_f32 v[144:145], v[146:147], v[138:139], v[142:143] op_sel:[1,1,0] op_sel_hi:[0,1,1] neg_lo:[1,0,0]
    v_pk_mul_f32 v[142:143], v[144:145], v[138:139] op_sel_hi:[1,0]
    v_pk_fma_f32 v[146:147], v[144:145], v[138:139], v[142:143] op_sel:[1,1,0] op_sel_hi:[0,1,1] neg_lo:[1,0,0]
    v_cvt_pk_bf16_f32 v161, v144, v146
    v_cvt_pk_bf16_f32 v165, v145, v147
    ds_write_b128 v106, v[158:161] offset:0
    ds_write_b128 v106, v[162:165] offset:4224
    v_pk_mul_f32 v[142:143], v[146:147], v[138:139] op_sel_hi:[1,0]
    v_pk_fma_f32 v[144:145], v[146:147], v[138:139], v[142:143] op_sel:[1,1,0] op_sel_hi:[0,1,1] neg_lo:[1,0,0]
    v_pk_mul_f32 v[142:143], v[144:145], v[138:139] op_sel_hi:[1,0]
    v_pk_fma_f32 v[146:147], v[144:145], v[138:139], v[142:143] op_sel:[1,1,0] op_sel_hi:[0,1,1] neg_lo:[1,0,0]
    v_cvt_pk_bf16_f32 v150, v144, v146
    v_cvt_pk_bf16_f32 v154, v145, v147
    v_pk_mul_f32 v[142:143], v[146:147], v[138:139] op_sel_hi:[1,0]
    v_pk_fma_f32 v[144:145], v[146:147], v[138:139], v[142:143] op_sel:[1,1,0] op_sel_hi:[0,1,1] neg_lo:[1,0,0]
    v_pk_mul_f32 v[142:143], v[144:145], v[138:139] op_sel_hi:[1,0]
    v_pk_fma_f32 v[146:147], v[144:145], v[138:139], v[142:143] op_sel:[1,1,0] op_sel_hi:[0,1,1] neg_lo:[1,0,0]
    v_cvt_pk_bf16_f32 v151, v144, v146
    v_cvt_pk_bf16_f32 v155, v145, v147
    v_pk_mul_f32 v[142:143], v[146:147], v[138:139] op_sel_hi:[1,0]
    v_pk_fma_f32 v[144:145], v[146:147], v[138:139], v[142:143] op_sel:[1,1,0] op_sel_hi:[0,1,1] neg_lo:[1,0,0]
    v_pk_mul_f32 v[142:143], v[144:145], v[138:139] op_sel_hi:[1,0]
    v_pk_fma_f32 v[146:147], v[144:145], v[138:139], v[142:143] op_sel:[1,1,0] op_sel_hi:[0,1,1] neg_lo:[1,0,0]
    v_cvt_pk_bf16_f32 v152, v144, v146
    v_cvt_pk_bf16_f32 v156, v145, v147
    v_pk_mul_f32 v[142:143], v[146:147], v[138:139] op_sel_hi:[1,0]
    v_pk_fma_f32 v[144:145], v[146:147], v[138:139], v[142:143] op_sel:[1,1,0] op_sel_hi:[0,1,1] neg_lo:[1,0,0]
    v_pk_mul_f32 v[142:143], v[144:145], v[138:139] op_sel_hi:[1,0]
    v_pk_fma_f32 v[146:147], v[144:145], v[138:139], v[142:143] op_sel:[1,1,0] op_sel_hi:[0,1,1] neg_lo:[1,0,0]
    v_cvt_pk_bf16_f32 v153, v144, v146
    v_cvt_pk_bf16_f32 v157, v145, v147
    ds_write_b128 v106, v[150:153] offset:1056
    ds_write_b128 v106, v[154:157] offset:5280
    v_pk_mul_f32 v[142:143], v[146:147], v[138:139] op_sel_hi:[1,0]
    v_pk_fma_f32 v[144:145], v[146:147], v[138:139], v[142:143] op_sel:[1,1,0] op_sel_hi:[0,1,1] neg_lo:[1,0,0]
    v_pk_mul_f32 v[142:143], v[144:145], v[138:139] op_sel_hi:[1,0]
    v_pk_fma_f32 v[146:147], v[144:145], v[138:139], v[142:143] op_sel:[1,1,0] op_sel_hi:[0,1,1] neg_lo:[1,0,0]
    v_cvt_pk_bf16_f32 v158, v144, v146
    v_cvt_pk_bf16_f32 v162, v145, v147
    v_pk_mul_f32 v[142:143], v[146:147], v[138:139] op_sel_hi:[1,0]
    v_pk_fma_f32 v[144:145], v[146:147], v[138:139], v[142:143] op_sel:[1,1,0] op_sel_hi:[0,1,1] neg_lo:[1,0,0]
    v_pk_mul_f32 v[142:143], v[144:145], v[138:139] op_sel_hi:[1,0]
    v_pk_fma_f32 v[146:147], v[144:145], v[138:139], v[142:143] op_sel:[1,1,0] op_sel_hi:[0,1,1] neg_lo:[1,0,0]
    v_cvt_pk_bf16_f32 v159, v144, v146
    v_cvt_pk_bf16_f32 v163, v145, v147
    v_pk_mul_f32 v[142:143], v[146:147], v[138:139] op_sel_hi:[1,0]
    v_pk_fma_f32 v[144:145], v[146:147], v[138:139], v[142:143] op_sel:[1,1,0] op_sel_hi:[0,1,1] neg_lo:[1,0,0]
    v_pk_mul_f32 v[142:143], v[144:145], v[138:139] op_sel_hi:[1,0]
    v_pk_fma_f32 v[146:147], v[144:145], v[138:139], v[142:143] op_sel:[1,1,0] op_sel_hi:[0,1,1] neg_lo:[1,0,0]
    v_cvt_pk_bf16_f32 v160, v144, v146
    v_cvt_pk_bf16_f32 v164, v145, v147
    v_pk_mul_f32 v[142:143], v[146:147], v[138:139] op_sel_hi:[1,0]
    v_pk_fma_f32 v[144:145], v[146:147], v[138:139], v[142:143] op_sel:[1,1,0] op_sel_hi:[0,1,1] neg_lo:[1,0,0]
    v_pk_mul_f32 v[142:143], v[144:145], v[138:139] op_sel_hi:[1,0]
    v_pk_fma_f32 v[146:147], v[144:145], v[138:139], v[142:143] op_sel:[1,1,0] op_sel_hi:[0,1,1] neg_lo:[1,0,0]
    v_cvt_pk_bf16_f32 v161, v144, v146
    v_cvt_pk_bf16_f32 v165, v145, v147
    ds_write_b128 v106, v[158:161] offset:2112
    ds_write_b128 v106, v[162:165] offset:6336
    v_pk_mul_f32 v[142:143], v[146:147], v[138:139] op_sel_hi:[1,0]
    v_pk_fma_f32 v[144:145], v[146:147], v[138:139], v[142:143] op_sel:[1,1,0] op_sel_hi:[0,1,1] neg_lo:[1,0,0]
    v_pk_mul_f32 v[142:143], v[144:145], v[138:139] op_sel_hi:[1,0]
    v_pk_fma_f32 v[146:147], v[144:145], v[138:139], v[142:143] op_sel:[1,1,0] op_sel_hi:[0,1,1] neg_lo:[1,0,0]
    v_cvt_pk_bf16_f32 v150, v144, v146
    v_cvt_pk_bf16_f32 v154, v145, v147
    v_pk_mul_f32 v[142:143], v[146:147], v[138:139] op_sel_hi:[1,0]
    v_pk_fma_f32 v[144:145], v[146:147], v[138:139], v[142:143] op_sel:[1,1,0] op_sel_hi:[0,1,1] neg_lo:[1,0,0]
    v_pk_mul_f32 v[142:143], v[144:145], v[138:139] op_sel_hi:[1,0]
    v_pk_fma_f32 v[146:147], v[144:145], v[138:139], v[142:143] op_sel:[1,1,0] op_sel_hi:[0,1,1] neg_lo:[1,0,0]
    v_cvt_pk_bf16_f32 v151, v144, v146
    v_cvt_pk_bf16_f32 v155, v145, v147
    v_pk_mul_f32 v[142:143], v[146:147], v[138:139] op_sel_hi:[1,0]
    v_pk_fma_f32 v[144:145], v[146:147], v[138:139], v[142:143] op_sel:[1,1,0] op_sel_hi:[0,1,1] neg_lo:[1,0,0]
    v_pk_mul_f32 v[142:143], v[144:145], v[138:139] op_sel_hi:[1,0]
    v_pk_fma_f32 v[146:147], v[144:145], v[138:139], v[142:143] op_sel:[1,1,0] op_sel_hi:[0,1,1] neg_lo:[1,0,0]
    v_cvt_pk_bf16_f32 v152, v144, v146
    v_cvt_pk_bf16_f32 v156, v145, v147
    v_pk_mul_f32 v[142:143], v[146:147], v[138:139] op_sel_hi:[1,0]
    v_pk_fma_f32 v[144:145], v[146:147], v[138:139], v[142:143] op_sel:[1,1,0] op_sel_hi:[0,1,1] neg_lo:[1,0,0]
    v_pk_mul_f32 v[142:143], v[144:145], v[138:139] op_sel_hi:[1,0]
    v_pk_fma_f32 v[146:147], v[144:145], v[138:139], v[142:143] op_sel:[1,1,0] op_sel_hi:[0,1,1] neg_lo:[1,0,0]
    v_cvt_pk_bf16_f32 v153, v144, v146
    v_cvt_pk_bf16_f32 v157, v145, v147
    ds_write_b128 v106, v[150:153] offset:3168
    ds_write_b128 v106, v[154:157] offset:7392
    s_cmp_eq_u32 s3, 2
    s_cbranch_scc0 L_es9
    s_waitcnt vmcnt(0)
    s_cmp_eq_u32 s3, 2
    s_cbranch_scc0 L_es9
    s_mov_b32 s29, 0
L_nz10:
    v_readfirstlane_b32 s30, v240
    v_readfirstlane_b32 s31, v241
    s_nop 0
    s_cmp_lg_u32 s31, 0
    s_cbranch_scc1 L_nz11
    s_add_u32 s29, s29, 1
    s_cmp_gt_u32 s29, 262144
    s_cbranch_scc1 L_nz11
    v_mov_b32 v242, 0
    global_load_dwordx2 v[240:241], v242, s[90:91] sc1
    s_waitcnt vmcnt(0)
    s_branch L_nz10
L_nz11:
    v_mov_b32 v242, 163088
    ds_write_b64 v242, v[240:241]
L_es9:
    s_waitcnt lgkmcnt(0)
    s_barrier
    s_cmp_lt_u32 s3, 2
    s_cbranch_scc0 L_nou2
    v_lshlrev_b32 v100, 16, v100
    v_lshlrev_b32 v101, 16, v101
    v_lshlrev_b32 v102, 16, v102
    v_lshlrev_b32 v103, 16, v103
    v_mul_f32 v142, s56, v100
    v_fma_f32 v143, v100, s56, -v142
    v_fma_f32 v143, v100, s57, v143
    v_exp_f32 v128, v142
    v_mul_f32_e64 v143, s58, v143
    v_fma_f32 v128, v128, v143, v128
    v_pk_mul_f32 v[130:131], v[102:103], v[104:105] op_sel:[0,1] op_sel_hi:[1,1]
    v_cvt_pk_bf16_f32 v128, v128, v128
    v_and_b32 v128, 0xffff0000, v128
    v_mul_f32 v129, v101, v104
    v_mul_f32 v128, v128, v104
    v_mul_f32 v129, 0.15915494, v129
    v_mul_f32 v128, 0xbfb8aa3b, v128
    v_fract_f32 v143, v129
    v_exp_f32 v142, v128
    v_cos_f32 v132, v143
    v_sin_f32 v133, v143
    s_nop 0
    v_pk_mul_f32 v[132:133], v[132:133], v[142:143] op_sel_hi:[1,0]
    v_mul_f32 v142, 0x43800000, v128
    v_mul_f32 v143, 0x43800000, v129
    v_fract_f32 v143, v143
    v_exp_f32 v142, v142
    v_cos_f32 v140, v143
    v_sin_f32 v141, v143
    s_nop 0
    v_pk_mul_f32 v[140:141], v[140:141], v[142:143] op_sel_hi:[1,0]
    v_mul_f32 v142, 0x41000000, v128
    v_mul_f32 v143, 0x41000000, v129
    v_fract_f32 v143, v143
    v_exp_f32 v142, v142
    v_cos_f32 v138, v143
    v_sin_f32 v139, v143
    s_nop 0
    v_pk_mul_f32 v[138:139], v[138:139], v[142:143] op_sel_hi:[1,0]
    v_pk_mul_f32 v[142:143], v[132:133], v[132:133] op_sel_hi:[1,0]
    v_pk_fma_f32 v[134:135], v[132:133], v[132:133], v[142:143] op_sel:[1,1,0] op_sel_hi:[0,1,1] neg_lo:[1,0,0]
    v_pk_mul_f32 v[142:143], v[134:135], v[134:135] op_sel_hi:[1,0]
    v_pk_fma_f32 v[136:137], v[134:135], v[134:135], v[142:143] op_sel:[1,1,0] op_sel_hi:[0,1,1] neg_lo:[1,0,0]
    v_pk_mul_f32 v[142:143], v[130:131], v[132:133] op_sel_hi:[1,0]
    v_pk_fma_f32 v[146:147], v[130:131], v[132:133], v[142:143] op_sel:[1,1,0] op_sel_hi:[0,1,1] neg_lo:[1,0,0]
    v_cvt_pk_bf16_f32 v150, v130, v146
    v_cvt_pk_bf16_f32 v154, -v131, -v147
    v_pk_mul_f32 v[142:143], v[146:147], v[132:133] op_sel_hi:[1,0]
    v_pk_fma_f32 v[144:145], v[146:147], v[132:133], v[142:143] op_sel:[1,1,0] op_sel_hi:[0,1,1] neg_lo:[1,0,0]
    v_pk_mul_f32 v[142:143], v[144:145], v[132:133] op_sel_hi:[1,0]
    v_pk_fma_f32 v[146:147], v[144:145], v[132:133], v[142:143] op_sel:[1,1,0] op_sel_hi:[0,1,1] neg_lo:[1,0,0]
    v_cvt_pk_bf16_f32 v151, v144, v146
    v_cvt_pk_bf16_f32 v155, -v145, -v147
    v_pk_mul_f32 v[142:143], v[146:147], v[132:133] op_sel_hi:[1,0]
    v_pk_fma_f32 v[144:145], v[146:147], v[132:133], v[142:143] op_sel:[1,1,0] op_sel_hi:[0,1,1] neg_lo:[1,0,0]
    v_pk_mul_f32 v[142:143], v[144:145], v[132:133] op_sel_hi:[1,0]
    v_pk_fma_f32 v[146:147], v[144:145], v[132:133], v[142:143] op_sel:[1,1,0] op_sel_hi:[0,1,1] neg_lo:[1,0,0]
    v_cvt_pk_bf16_f32 v152, v144, v146
    v_cvt_pk_bf16_f32 v156, -v145, -v147
    v_pk_mul_f32 v[142:143], v[146:147], v[132:133] op_sel_hi:[1,0]
    v_pk_fma_f32 v[144:145], v[146:147], v[132:133], v[142:143] op_sel:[1,1,0] op_sel_hi:[0,1,1] neg_lo:[1,0,0]
    v_pk_mul_f32 v[142:143], v[144:145], v[132:133] op_sel_hi:[1,0]
    v_pk_fma_f32 v[146:147], v[144:145], v[132:133], v[142:143] op_sel:[1,1,0] op_sel_hi:[0,1,1] neg_lo:[1,0,0]
    v_cvt_pk_bf16_f32 v153, v144, v146
    v_cvt_pk_bf16_f32 v157, -v145, -v147
    s_barrier
    s_nop 0
    ds_write_b128 v106, v[150:153] offset:8448
    ds_write_b128 v106, v[154:157] offset:12672
    v_pk_mul_f32 v[142:143], v[130:131], v[140:141] op_sel_hi:[1,0]
    v_pk_fma_f32 v[148:149], v[130:131], v[140:141], v[142:143] op_sel:[1,1,0] op_sel_hi:[0,1,1] neg_lo:[1,0,0]
    v_pk_mul_f32 v[142:143], v[148:149], v[134:135] op_sel_hi:[1,0]
    v_pk_fma_f32 v[146:147], v[148:149], v[134:135], v[142:143] op_sel:[1,1,0] op_sel_hi:[0,1,1] neg_lo:[1,0,0]
    v_cvt_pk_bf16_f32 v158, v148, v146
    v_cvt_pk_bf16_f32 v162, -v149, -v147
    v_pk_mul_f32 v[142:143], v[146:147], v[134:135] op_sel_hi:[1,0]
    v_pk_fma_f32 v[144:145], v[146:147], v[134:135], v[142:143] op_sel:[1,1,0] op_sel_hi:[0,1,1] neg_lo:[1,0,0]
    v_pk_mul_f32 v[142:143], v[144:145], v[134:135] op_sel_hi:[1,0]
    v_pk_fma_f32 v[146:147], v[144:145], v[134:135], v[142:143] op_sel:[1,1,0] op_sel_hi:[0,1,1] neg_lo:[1,0,0]
    v_cvt_pk_bf16_f32 v159, v144, v146
    v_cvt_pk_bf16_f32 v163, -v145, -v147
    v_pk_mul_f32 v[142:143], v[148:149], v[140:141] op_sel_hi:[1,0]
    v_pk_fma_f32 v[148:149], v[148:149], v[140:141], v[142:143] op_sel:[1,1,0] op_sel_hi:[0,1,1] neg_lo:[1,0,0]
    v_pk_mul_f32 v[142:143], v[148:149], v[136:137] op_sel_hi:[1,0]
    v_pk_fma_f32 v[146:147], v[148:149], v[136:137], v[142:143] op_sel:[1,1,0] op_sel_hi:[0,1,1] neg_lo:[1,0,0]
    v_cvt_pk_bf16_f32 v160, v148, v146
    v_cvt_pk_bf16_f32 v164, -v149, -v147
    v_pk_mul_f32 v[142:143], v[148:149], v[140:141] op_sel_hi:[1,0]
    v_pk_fma_f32 v[148:149], v[148:149], v[140:141], v[142:143] op_sel:[1,1,0] op_sel_hi:[0,1,1] neg_lo:[1,0,0]
    v_pk_mul_f32 v[142:143], v[148:149], v[136:137] op_sel_hi:[1,0]
    v_pk_fma_f32 v[146:147], v[148:149], v[136:137], v[142:143] op_sel:[1,1,0] op_sel_hi:[0,1,1] neg_lo:[1,0,0]
    v_cvt_pk_bf16_f32 v161, v148, v146
    v_cvt_pk_bf16_f32 v165, -v149, -v147
    ds_write_b128 v106, v[158:161] offset:9504
    ds_write_b128 v106, v[162:165] offset:13728
    v_pk_mul_f32 v[142:143], v[148:149], v[140:141] op_sel_hi:[1,0]
    v_pk_fma_f32 v[144:145], v[148:149], v[140:141], v[142:143] op_sel:[1,1,0] op_sel_hi:[0,1,1] neg_lo:[1,0,0]
    v_pk_mul_f32 v[142:143], v[144:145], v[140:141] op_sel_hi:[1,0]
    v_pk_fma_f32 v[146:147], v[144:145], v[140:141], v[142:143] op_sel:[1,1,0] op_sel_hi:[0,1,1] neg_lo:[1,0,0]
    v_cvt_pk_bf16_f32 v150, v144, v146
    v_cvt_pk_bf16_f32 v154, -v145, -v147
    v_pk_mul_f32 v[142:143], v[146:147], v[140:141] op_sel_hi:[1,0]
    v_pk_fma_f32 v[144:145], v[146:147], v[140:141], v[142:143] op_sel:[1,1,0] op_sel_hi:[0,1,1] neg_lo:[1,0,0]
    v_pk_mul_f32 v[142:143], v[144:145], v[140:141] op_sel_hi:[1,0]
    v_pk_fma_f32 v[146:147], v[144:145], v[140:141], v[142:143] op_sel:[1,1,0] op_sel_hi:[0,1,1] neg_lo:[1,0,0]
    v_cvt_pk_bf16_f32 v151, v144, v146
    v_cvt_pk_bf16_f32 v155, -v145, -v147
    v_pk_mul_f32 v[142:143], v[146:147], v[140:141] op_sel_hi:[1,0]
    v_pk_fma_f32 v[144:145], v[146:147], v[140:141], v[142:143] op_sel:[1,1,0] op_sel_hi:[0,1,1] neg_lo:[1,0,0]
    v_cvt_pk_bf16_f32 v152, v144, 0
    v_cvt_pk_bf16_f32 v156, -v145, 0
    ds_write_b128 v106, v[150:153] offset:10560
    ds_write_b128 v106, v[154:157] offset:14784
    v_cvt_pk_bf16_f32 v158, 1.0, v138
    v_cvt_pk_bf16_f32 v162, 0, v139
    v_pk_mul_f32 v[142:143], v[138:139], v[138:139] op_sel_hi:[1,0]
    v_pk_fma_f32 v[144:145], v[138:139], v[138:139], v[142:143] op_sel:[1,1,0] op_sel_hi:[0,1,1] neg_lo:[1,0,0]
    v_pk_mul_f32 v[142:143], v[144:145], v[138:139] op_sel_hi:[1,0]
    v_pk_fma_f32 v[146:147], v[144:145], v[138:139], v[142:143] op_sel:[1,1,0] op_sel_hi:[0,1,1] neg_lo:[1,0,0]
    v_cvt_pk_bf16_f32 v159, v144, v146
    v_cvt_pk_bf16_f32 v163, v145, v147
    v_pk_mul_f32 v[142:143], v[146:147], v[138:139] op_sel_hi:[1,0]
    v_pk_fma_f32 v[144:145], v[146:147], v[138:139], v[142:143] op_sel:[1,1,0] op_sel_hi:[0,1,1] neg_lo:[1,0,0]
    v_pk_mul_f32 v[142:143], v[144:145], v[138:139] op_sel_hi:[1,0]
    v_pk_fma_f32 v[146:147], v[144:145], v[138:139], v[142:143] op_sel:[1,1,0] op_sel_hi:[0,1,1] neg_lo:[1,0,0]
    v_cvt_pk_bf16_f32 v160, v144, v146
    v_cvt_pk_bf16_f32 v164, v145, v147
    v_pk_mul_f32 v[142:143], v[146:147], v[138:139] op_sel_hi:[1,0]
    v_pk_fma_f32 v[144:145], v[146:147], v[138:139], v[142:143] op_sel:[1,1,0] op_sel_hi:[0,1,1] neg_lo:[1,0,0]
    v_pk_mul_f32 v[142:143], v[144:145], v[138:139] op_sel_hi:[1,0]
    v_pk_fma_f32 v[146:147], v[144:145], v[138:139], v[142:143] op_sel:[1,1,0] op_sel_hi:[0,1,1] neg_lo:[1,0,0]
    v_cvt_pk_bf16_f32 v161, v144, v146
    v_cvt_pk_bf16_f32 v165, v145, v147
    ds_write_b128 v106, v[158:161] offset:0
    ds_write_b128 v106, v[162:165] offset:4224
    v_pk_mul_f32 v[142:143], v[146:147], v[138:139] op_sel_hi:[1,0]
    v_pk_fma_f32 v[144:145], v[146:147], v[138:139], v[142:143] op_sel:[1,1,0] op_sel_hi:[0,1,1] neg_lo:[1,0,0]
    v_pk_mul_f32 v[142:143], v[144:145], v[138:139] op_sel_hi:[1,0]
    v_pk_fma_f32 v[146:147], v[144:145], v[138:139], v[142:143] op_sel:[1,1,0] op_sel_hi:[0,1,1] neg_lo:[1,0,0]
    v_cvt_pk_bf16_f32 v150, v144, v146
    v_cvt_pk_bf16_f32 v154, v145, v147
    v_pk_mul_f32 v[142:143], v[146:147], v[138:139] op_sel_hi:[1,0]
    v_pk_fma_f32 v[144:145], v[146:147], v[138:139], v[142:143] op_sel:[1,1,0] op_sel_hi:[0,1,1] neg_lo:[1,0,0]
    v_pk_mul_f32 v[142:143], v[144:145], v[138:139] op_sel_hi:[1,0]
    v_pk_fma_f32 v[146:147], v[144:145], v[138:139], v[142:143] op_sel:[1,1,0] op_sel_hi:[0,1,1] neg_lo:[1,0,0]
    v_cvt_pk_bf16_f32 v151, v144, v146
    v_cvt_pk_bf16_f32 v155, v145, v147
    v_pk_mul_f32 v[142:143], v[146:147], v[138:139] op_sel_hi:[1,0]
    v_pk_fma_f32 v[144:145], v[146:147], v[138:139], v[142:143] op_sel:[1,1,0] op_sel_hi:[0,1,1] neg_lo:[1,0,0]
    v_pk_mul_f32 v[142:143], v[144:145], v[138:139] op_sel_hi:[1,0]
    v_pk_fma_f32 v[146:147], v[144:145], v[138:139], v[142:143] op_sel:[1,1,0] op_sel_hi:[0,1,1] neg_lo:[1,0,0]
    v_cvt_pk_bf16_f32 v152, v144, v146
    v_cvt_pk_bf16_f32 v156, v145, v147
    v_pk_mul_f32 v[142:143], v[146:147], v[138:139] op_sel_hi:[1,0]
    v_pk_fma_f32 v[144:145], v[146:147], v[138:139], v[142:143] op_sel:[1,1,0] op_sel_hi:[0,1,1] neg_lo:[1,0,0]
    v_pk_mul_f32 v[142:143], v[144:145], v[138:139] op_sel_hi:[1,0]
    v_pk_fma_f32 v[146:147], v[144:145], v[138:139], v[142:143] op_sel:[1,1,0] op_sel_hi:[0,1,1] neg_lo:[1,0,0]
    v_cvt_pk_bf16_f32 v153, v144, v146
    v_cvt_pk_bf16_f32 v157, v145, v147
    ds_write_b128 v106, v[150:153] offset:1056
    ds_write_b128 v106, v[154:157] offset:5280
    v_pk_mul_f32 v[142:143], v[146:147], v[138:139] op_sel_hi:[1,0]
    v_pk_fma_f32 v[144:145], v[146:147], v[138:139], v[142:143] op_sel:[1,1,0] op_sel_hi:[0,1,1] neg_lo:[1,0,0]
    v_pk_mul_f32 v[142:143], v[144:145], v[138:139] op_sel_hi:[1,0]
    v_pk_fma_f32 v[146:147], v[144:145], v[138:139], v[142:143] op_sel:[1,1,0] op_sel_hi:[0,1,1] neg_lo:[1,0,0]
    v_cvt_pk_bf16_f32 v158, v144, v146
    v_cvt_pk_bf16_f32 v162, v145, v147
    v_pk_mul_f32 v[142:143], v[146:147], v[138:139] op_sel_hi:[1,0]
    v_pk_fma_f32 v[144:145], v[146:147], v[138:139], v[142:143] op_sel:[1,1,0] op_sel_hi:[0,1,1] neg_lo:[1,0,0]
    v_pk_mul_f32 v[142:143], v[144:145], v[138:139] op_sel_hi:[1,0]
    v_pk_fma_f32 v[146:147], v[144:145], v[138:139], v[142:143] op_sel:[1,1,0] op_sel_hi:[0,1,1] neg_lo:[1,0,0]
    v_cvt_pk_bf16_f32 v159, v144, v146
    v_cvt_pk_bf16_f32 v163, v145, v147
    v_pk_mul_f32 v[142:143], v[146:147], v[138:139] op_sel_hi:[1,0]
    v_pk_fma_f32 v[144:145], v[146:147], v[138:139], v[142:143] op_sel:[1,1,0] op_sel_hi:[0,1,1] neg_lo:[1,0,0]
    v_pk_mul_f32 v[142:143], v[144:145], v[138:139] op_sel_hi:[1,0]
    v_pk_fma_f32 v[146:147], v[144:145], v[138:139], v[142:143] op_sel:[1,1,0] op_sel_hi:[0,1,1] neg_lo:[1,0,0]
    v_cvt_pk_bf16_f32 v160, v144, v146
    v_cvt_pk_bf16_f32 v164, v145, v147
    v_pk_mul_f32 v[142:143], v[146:147], v[138:139] op_sel_hi:[1,0]
    v_pk_fma_f32 v[144:145], v[146:147], v[138:139], v[142:143] op_sel:[1,1,0] op_sel_hi:[0,1,1] neg_lo:[1,0,0]
    v_pk_mul_f32 v[142:143], v[144:145], v[138:139] op_sel_hi:[1,0]
    v_pk_fma_f32 v[146:147], v[144:145], v[138:139], v[142:143] op_sel:[1,1,0] op_sel_hi:[0,1,1] neg_lo:[1,0,0]
    v_cvt_pk_bf16_f32 v161, v144, v146
    v_cvt_pk_bf16_f32 v165, v145, v147
    ds_write_b128 v106, v[158:161] offset:2112
    ds_write_b128 v106, v[162:165] offset:6336
    v_pk_mul_f32 v[142:143], v[146:147], v[138:139] op_sel_hi:[1,0]
    v_pk_fma_f32 v[144:145], v[146:147], v[138:139], v[142:143] op_sel:[1,1,0] op_sel_hi:[0,1,1] neg_lo:[1,0,0]
    v_pk_mul_f32 v[142:143], v[144:145], v[138:139] op_sel_hi:[1,0]
    v_pk_fma_f32 v[146:147], v[144:145], v[138:139], v[142:143] op_sel:[1,1,0] op_sel_hi:[0,1,1] neg_lo:[1,0,0]
    v_cvt_pk_bf16_f32 v150, v144, v146
    v_cvt_pk_bf16_f32 v154, v145, v147
    v_pk_mul_f32 v[142:143], v[146:147], v[138:139] op_sel_hi:[1,0]
    v_pk_fma_f32 v[144:145], v[146:147], v[138:139], v[142:143] op_sel:[1,1,0] op_sel_hi:[0,1,1] neg_lo:[1,0,0]
    v_pk_mul_f32 v[142:143], v[144:145], v[138:139] op_sel_hi:[1,0]
    v_pk_fma_f32 v[146:147], v[144:145], v[138:139], v[142:143] op_sel:[1,1,0] op_sel_hi:[0,1,1] neg_lo:[1,0,0]
    v_cvt_pk_bf16_f32 v151, v144, v146
    v_cvt_pk_bf16_f32 v155, v145, v147
    v_pk_mul_f32 v[142:143], v[146:147], v[138:139] op_sel_hi:[1,0]
    v_pk_fma_f32 v[144:145], v[146:147], v[138:139], v[142:143] op_sel:[1,1,0] op_sel_hi:[0,1,1] neg_lo:[1,0,0]
    v_pk_mul_f32 v[142:143], v[144:145], v[138:139] op_sel_hi:[1,0]
    v_pk_fma_f32 v[146:147], v[144:145], v[138:139], v[142:143] op_sel:[1,1,0] op_sel_hi:[0,1,1] neg_lo:[1,0,0]
    v_cvt_pk_bf16_f32 v152, v144, v146
    v_cvt_pk_bf16_f32 v156, v145, v147
    v_pk_mul_f32 v[142:143], v[146:147], v[138:139] op_sel_hi:[1,0]
    v_pk_fma_f32 v[144:145], v[146:147], v[138:139], v[142:143] op_sel:[1,1,0] op_sel_hi:[0,1,1] neg_lo:[1,0,0]
    v_pk_mul_f32 v[142:143], v[144:145], v[138:139] op_sel_hi:[1,0]
    v_pk_fma_f32 v[146:147], v[144:145], v[138:139], v[142:143] op_sel:[1,1,0] op_sel_hi:[0,1,1] neg_lo:[1,0,0]
    v_cvt_pk_bf16_f32 v153, v144, v146
    v_cvt_pk_bf16_f32 v157, v145, v147
    ds_write_b128 v106, v[150:153] offset:3168
    ds_write_b128 v106, v[154:157] offset:7392
    s_waitcnt lgkmcnt(0)
    s_barrier
    ds_read_b64_tr_b16 a[0:1], v5 offset:0
    ds_read_b64_tr_b16 a[2:3], v5 offset:512
    ds_read_b64_tr_b16 a[4:5], v6 offset:0
    ds_read_b64_tr_b16 a[6:7], v6 offset:512
    ds_read_b64_tr_b16 a[8:9], v7 offset:0
    ds_read_b64_tr_b16 a[10:11], v7 offset:512
    ds_read_b64_tr_b16 a[12:13], v8 offset:0
    ds_read_b64_tr_b16 a[14:15], v8 offset:512
    ds_read_b64_tr_b16 a[16:17], v5 offset:4096
    ds_read_b64_tr_b16 a[18:19], v5 offset:4608
    ds_read_b64_tr_b16 a[20:21], v6 offset:4096
    ds_read_b64_tr_b16 a[22:23], v6 offset:4608
    ds_read_b64_tr_b16 a[24:25], v7 offset:4096
    ds_read_b64_tr_b16 a[26:27], v7 offset:4608
    ds_read_b64_tr_b16 a[28:29], v8 offset:4096
    ds_read_b64_tr_b16 a[30:31], v8 offset:4608
    s_waitcnt lgkmcnt(8)
    s_add_u32 m0, s32, 0
    s_add_u32 s54, s100, 4
    s_mul_i32 s54, s54, 98304
    s_add_u32 s54, s54, s34
    buffer_load_dwordx4 v3, s[4:7], s54 offen offset:0  lds
    buffer_load_dwordx4 v4, s[4:7], s54 offen offset:1024  lds
    buffer_load_dwordx4 v252, s[4:7], s54 offen offset:2048  lds
    buffer_load_dwordx4 v253, s[4:7], s54 offen offset:3072  lds
    s_mul_i32 s42, s3, 3072
    v_add_u32_e64 v88, s42, v1
    global_load_dwordx4 v[192:195], v88, s[50:51] offset:0
    global_load_dwordx4 v[196:199], v88, s[50:51] offset:1024
    global_load_dwordx4 v[200:203], v88, s[50:51] offset:2048
    ds_read_b64_tr_b16 a[32:33], v5 offset:8192
    ds_read_b64_tr_b16 a[34:35], v5 offset:8704
    ds_read_b64_tr_b16 a[36:37], v6 offset:8192
    ds_read_b64_tr_b16 a[38:39], v6 offset:8704
    ds_read_b64_tr_b16 a[40:41], v7 offset:8192
    ds_read_b64_tr_b16 a[42:43], v7 offset:8704
    ds_read_b64_tr_b16 a[44:45], v8 offset:8192
    ds_read_b64_tr_b16 a[46:47], v8 offset:8704
    s_waitcnt lgkmcnt(8)
    s_add_u32 m0, s32, 4096
    s_add_u32 s54, s100, 5
    s_mul_i32 s54, s54, 98304
    s_add_u32 s54, s54, s34
    buffer_load_dwordx4 v3, s[4:7], s54 offen offset:0  lds
    buffer_load_dwordx4 v4, s[4:7], s54 offen offset:1024  lds
    buffer_load_dwordx4 v252, s[4:7], s54 offen offset:2048  lds
    buffer_load_dwordx4 v253, s[4:7], s54 offen offset:3072  lds
    s_xor_b32 s42, s3, 1
    s_mul_i32 s42, s42, 15360
    s_add_u32 s42, s42, 0
    v_add_u32 v222, s42, v1
    s_xor_b32 s42, s3, 2
    s_mul_i32 s42, s42, 15360
    s_add_u32 s42, s42, 5120
    v_add_u32 v223, s42, v1
    s_xor_b32 s42, s3, 3
    s_mul_i32 s42, s42, 15360
    s_add_u32 s42, s42, 10240
    v_add_u32 v224, s42, v1
    s_mul_i32 s42, s3, 15360
    v_add_u32 v225, s42, v1
    s_mov_b32 s60, 0xc0135761
    s_mov_b32 s61, 0xbdd2d3e8
    v_lshrrev_b32 v230, 5, v0
    v_lshlrev_b32 v230, 10, v230
    v_and_b32 v180, 31, v0
    v_lshl_add_u32 v230, v180, 4, v230
    s_lshl_b32 s46, s25, 1
    s_lshr_b32 s47, s3, 1
    s_add_u32 s46, s46, s47
    s_mul_i32 s46, s46, 40
    ds_read_b64_tr_b16 a[48:49], v5 offset:12288
    ds_read_b64_tr_b16 a[50:51], v5 offset:12800
    ds_read_b64_tr_b16 a[52:53], v6 offset:12288
    ds_read_b64_tr_b16 a[54:55], v6 offset:12800
    ds_read_b64_tr_b16 a[56:57], v7 offset:12288
    ds_read_b64_tr_b16 a[58:59], v7 offset:12800
    ds_read_b64_tr_b16 a[60:61], v8 offset:12288
    ds_read_b64_tr_b16 a[62:63], v8 offset:12800
    s_waitcnt lgkmcnt(8)
    s_add_u32 m0, s32, 8192
    s_add_u32 s54, s100, 6
    s_mul_i32 s54, s54, 98304
    s_add_u32 s54, s54, s34
    buffer_load_dwordx4 v3, s[4:7], s54 offen offset:0  lds
    buffer_load_dwordx4 v4, s[4:7], s54 offen offset:1024  lds
    buffer_load_dwordx4 v252, s[4:7], s54 offen offset:2048  lds
    buffer_load_dwordx4 v253, s[4:7], s54 offen offset:3072  lds
    s_mul_i32 s47, s24, 5
    s_add_u32 s46, s46, s47
    s_lshl_b32 s46, s46, 10
    s_and_b32 s47, s3, 1
    s_lshl_b32 s47, s47, 9
    s_add_u32 s46, s46, s47
    s_add_u32 s46, s46, 0x500000
    s_add_u32 s47, s46, 4096
    v_lshrrev_b32 v231, 1, v0
    s_lshl_b32 s42, s3, 6
    v_add_u32 v231, s42, v231
    v_lshrrev_b32 v232, 2, v231
    v_mul_u32_u24 v232, 40960, v232
    v_and_b32 v234, 3, v231
    v_lshl_add_u32 v232, v234, 8, v232
    v_and_b32_e64 v234, 1, v0
    v_lshl_add_u32 v232, v234, 4, v232
    v_mul_u32_u24 v234, 4608, v234
    v_lshl_add_u32 v233, v231, 4, v234
    v_add_u32 v233, 148224, v233
    v_lshlrev_b32 v231, 5, v231
    s_and_b32 s42, s3, 1
    s_lshr_b32 s43, s3, 1
    s_lshl_b32 s43, s43, 8
    s_waitcnt vmcnt(11)
    s_nop 0
    ds_read_b64_tr_b16 a[64:65], v5 offset:0
    ds_read_b64_tr_b16 a[66:67], v5 offset:512
    ds_read_b64_tr_b16 a[68:69], v6 offset:0
    ds_read_b64_tr_b16 a[70:71], v6 offset:512
    ds_read_b64_tr_b16 a[72:73], v7 offset:0
    ds_read_b64_tr_b16 a[74:75], v7 offset:512
    ds_read_b64_tr_b16 a[76:77], v8 offset:0
    ds_read_b64_tr_b16 a[78:79], v8 offset:512
    s_waitcnt lgkmcnt(8)
    s_add_u32 m0, s32, 12288
    s_add_u32 s54, s100, 7
    s_mul_i32 s54, s54, 98304
    s_add_u32 s54, s54, s34
    s_nop 0
    buffer_load_dwordx4 v3, s[4:7], s54 offen offset:0  lds
    buffer_load_dwordx4 v4, s[4:7], s54 offen offset:1024  lds
    buffer_load_dwordx4 v252, s[4:7], s54 offen offset:2048  lds
    buffer_load_dwordx4 v253, s[4:7], s54 offen offset:3072  lds
    s_mul_i32 s44, s42, 8320
    s_add_u32 s44, s44, 131072
    s_sub_u32 s44, s44, s43
    s_mul_i32 s45, s42, 4608
    s_add_u32 s45, s45, 148224
    s_sub_u32 s45, s45, s43
    v_and_b32 v180, 15, v0
    v_bfe_u32 v181, v0, 4, 1
    v_lshrrev_b32 v182, 5, v0
    v_sub_u32 v183, 2047, v180
    v_lshl_add_u32 v183, v181, 3, v183
    v_lshlrev_b32 v184, 4, v182
    v_sub_u32 v183, v183, v184
    v_lshrrev_b32 v183, 1, v183
    v_lshlrev_b32 v183, 2, v183
    v_and_b32 v184, 1, v0
    v_mul_u32_u24 v184, 4160, v184
    v_sub_u32 v183, v183, v184
    v_add_u32_e64 v183, s44, v183
    v_add_u32 v235, 3456, v183
    v_add_u32 v236, 2432, v183
    v_add_u32 v237, 1408, v183
    v_add_u32 v238, 384, v183
    v_sub_u32 v183, v180, v182
    s_waitcnt vmcnt(8)
    ds_read_b64_tr_b16 a[80:81], v5 offset:4096
    ds_read_b64_tr_b16 a[82:83], v5 offset:4608
    ds_read_b64_tr_b16 a[84:85], v6 offset:4096
    ds_read_b64_tr_b16 a[86:87], v6 offset:4608
    ds_read_b64_tr_b16 a[88:89], v7 offset:4096
    ds_read_b64_tr_b16 a[90:91], v7 offset:4608
    ds_read_b64_tr_b16 a[92:93], v8 offset:4096
    ds_read_b64_tr_b16 a[94:95], v8 offset:4608
    s_waitcnt lgkmcnt(8)
    s_add_u32 m0, s32, 0
    s_sub_u32 s54, 8, s100
    s_mul_i32 s54, s54, 98304
    s_add_u32 s54, s54, s34
    buffer_load_dwordx4 v3, s[4:7], s54 offen offset:0  lds
    buffer_load_dwordx4 v4, s[4:7], s54 offen offset:1024  lds
    buffer_load_dwordx4 v252, s[4:7], s54 offen offset:2048  lds
    buffer_load_dwordx4 v253, s[4:7], s54 offen offset:3072  lds
    v_lshlrev_b32 v183, 5, v183
    v_lshl_add_u32 v183, v181, 4, v183
    v_add_u32 v183, s45, v183
    v_subrev_u32 v239, 192, v183
    s_mov_b32 s12, s64
    s_mov_b32 s13, s65
    s_mov_b32 s14, 0x280000
    s_mov_b32 s15, 0x20000
    s_mov_b32 s20, s88
    s_mov_b32 s21, s89
    s_mov_b32 s22, 0x280000
    s_mov_b32 s23, 0x20000
    v_and_b32 v246, 15, v0
    v_lshlrev_b32 v247, 1, v246
    v_mul_u32_u24 v246, 1280, v246
    v_lshrrev_b32_e64 v248, 4, v0
    v_lshl_add_u32 v249, v248, 3, v246
    v_bfe_u32 v248, v0, 4, 1
    v_lshl_add_u32 v246, v248, 5, v246
    v_lshrrev_b32 v248, 5, v0
    v_lshl_add_u32 v246, v248, 4, v246
    s_lshl_b32 s39, s26, 2
    s_add_u32 s39, s39, s3
    s_lshl_b32 s29, s39, 5
    s_waitcnt vmcnt(8)
    s_nop 0
    ds_read_b64_tr_b16 a[96:97], v5 offset:8192
    ds_read_b64_tr_b16 a[98:99], v5 offset:8704
    ds_read_b64_tr_b16 a[100:101], v6 offset:8192
    ds_read_b64_tr_b16 a[102:103], v6 offset:8704
    ds_read_b64_tr_b16 a[104:105], v7 offset:8192
    ds_read_b64_tr_b16 a[106:107], v7 offset:8704
    ds_read_b64_tr_b16 a[108:109], v8 offset:8192
    ds_read_b64_tr_b16 a[110:111], v8 offset:8704
    s_waitcnt lgkmcnt(8)
    s_add_u32 m0, s32, 4096
    s_sub_u32 s54, 9, s100
    s_mul_i32 s54, s54, 98304
    s_add_u32 s54, s54, s34
    s_nop 0
    buffer_load_dwordx4 v3, s[4:7], s54 offen offset:0  lds
    buffer_load_dwordx4 v4, s[4:7], s54 offen offset:1024  lds
    buffer_load_dwordx4 v252, s[4:7], s54 offen offset:2048  lds
    buffer_load_dwordx4 v253, s[4:7], s54 offen offset:3072  lds
    s_mul_i32 s39, s39, 20480
    s_mul_i32 s55, s24, 160
    s_add_u32 s39, s39, s55
    v_add_u32 v247, s29, v247
    v_bfe_u32 v180, v0, 2, 2
    v_bfe_u32 v181, v0, 4, 1
    v_lshrrev_b32 v182, 5, v0
    v_lshl_add_u32 v182, v182, 4, v180
    v_lshl_add_u32 v182, v181, 2, v182
    v_lshlrev_b32 v182, 7, v182
    v_lshrrev_b32 v180, 1, v180
    v_lshl_or_b32 v180, v181, 1, v180
    v_xor_b32 v180, s3, v180
    v_lshl_add_u32 v182, v180, 5, v182
    v_and_b32 v180, 3, v0
    v_lshl_add_u32 v182, v180, 3, v182
    v_add_u32 v10, s33, v182
    v_xor_b32 v11, 32, v10
    v_xor_b32 v12, 64, v10
    v_xor_b32 v13, 96, v10
    s_lshl_b32 s42, s41, 2
    s_add_u32 s42, s42, s3
    s_lshr_b32 s43, s42, 5
    s_lshl_b32 s43, s43, 6
    s_waitcnt vmcnt(8)
    s_nop 0
    ds_read_b64_tr_b16 a[112:113], v5 offset:12288
    ds_read_b64_tr_b16 a[114:115], v5 offset:12800
    ds_read_b64_tr_b16 a[116:117], v6 offset:12288
    ds_read_b64_tr_b16 a[118:119], v6 offset:12800
    ds_read_b64_tr_b16 a[120:121], v7 offset:12288
    ds_read_b64_tr_b16 a[122:123], v7 offset:12800
    ds_read_b64_tr_b16 a[124:125], v8 offset:12288
    ds_read_b64_tr_b16 a[126:127], v8 offset:12800
    s_waitcnt lgkmcnt(8)
    s_add_u32 m0, s32, 8192
    s_sub_u32 s54, 10, s100
    s_mul_i32 s54, s54, 98304
    s_add_u32 s54, s54, s34
    s_nop 0
    buffer_load_dwordx4 v3, s[4:7], s54 offen offset:0  lds
    buffer_load_dwordx4 v4, s[4:7], s54 offen offset:1024  lds
    buffer_load_dwordx4 v252, s[4:7], s54 offen offset:2048  lds
    buffer_load_dwordx4 v253, s[4:7], s54 offen offset:3072  lds
    s_bfe_u32 s44, s42, 0x20003
    s_mul_i32 s44, s44, 384
    s_add_u32 s43, s43, s44
    s_and_b32 s42, s42, 7
    s_lshl_b32 s42, s42, 3
    s_add_u32 s43, s43, s42
    s_lshl_b32 s59, s43, 12
    s_lshr_b32 s42, s40, 1
    s_lshl_b32 s42, s42, 10
    s_add_u32 s59, s59, s42
    v_bfe_u32 v180, v0, 2, 1
    v_and_b32 v180, 1, v180
    s_and_b32 s42, s40, 1
    s_xor_b32 s42, s42, 1
    v_xor_b32 v180, s42, v180
    v_mul_u32_u24 v180, 192, v180
    v_lshrrev_b32 v251, 3, v0
    v_add_u32 v251, v251, v180
    v_lshlrev_b32 v251, 12, v251
    v_and_b32 v180, 7, v0
    v_lshl_add_u32 v251, v180, 7, v251
    s_lshl_b32 s48, s24, 5
    s_add_u32 s48, s48, s25
    s_mul_i32 s48, s48, 64
    s_waitcnt vmcnt(8)
    ds_read_b64_tr_b16 a[128:129], v5 offset:0
    ds_read_b64_tr_b16 a[130:131], v5 offset:512
    ds_read_b64_tr_b16 a[132:133], v6 offset:0
    ds_read_b64_tr_b16 a[134:135], v6 offset:512
    ds_read_b64_tr_b16 a[136:137], v7 offset:0
    ds_read_b64_tr_b16 a[138:139], v7 offset:512
    ds_read_b64_tr_b16 a[140:141], v8 offset:0
    ds_read_b64_tr_b16 a[142:143], v8 offset:512
    s_waitcnt lgkmcnt(8)
    s_add_u32 m0, s32, 12288
    s_sub_u32 s54, 11, s100
    s_mul_i32 s54, s54, 98304
    s_add_u32 s54, s54, s34
    buffer_load_dwordx4 v3, s[4:7], s54 offen offset:0  lds
    buffer_load_dwordx4 v4, s[4:7], s54 offen offset:1024  lds
    buffer_load_dwordx4 v252, s[4:7], s54 offen offset:2048  lds
    buffer_load_dwordx4 v253, s[4:7], s54 offen offset:3072  lds
    s_add_u32 s48, s48, 0xa10000
    s_waitcnt vmcnt(8)
    ds_read_b64_tr_b16 a[144:145], v5 offset:4096
    ds_read_b64_tr_b16 a[146:147], v5 offset:4608
    ds_read_b64_tr_b16 a[148:149], v6 offset:4096
    ds_read_b64_tr_b16 a[150:151], v6 offset:4608
    ds_read_b64_tr_b16 a[152:153], v7 offset:4096
    ds_read_b64_tr_b16 a[154:155], v7 offset:4608
    ds_read_b64_tr_b16 a[156:157], v8 offset:4096
    ds_read_b64_tr_b16 a[158:159], v8 offset:4608
    s_waitcnt lgkmcnt(8)
    s_add_u32 m0, s32, 0
    s_sub_u32 s54, 12, s100
    s_mul_i32 s54, s54, 98304
    s_add_u32 s54, s54, s34
    buffer_load_dwordx4 v3, s[4:7], s54 offen offset:0  lds
    buffer_load_dwordx4 v4, s[4:7], s54 offen offset:1024  lds
    buffer_load_dwordx4 v252, s[4:7], s54 offen offset:2048  lds
    buffer_load_dwordx4 v253, s[4:7], s54 offen offset:3072  lds
    s_waitcnt vmcnt(8)
    s_nop 0
    ds_read_b64_tr_b16 a[160:161], v5 offset:8192
    ds_read_b64_tr_b16 a[162:163], v5 offset:8704
    ds_read_b64_tr_b16 a[164:165], v6 offset:8192
    ds_read_b64_tr_b16 a[166:167], v6 offset:8704
    ds_read_b64_tr_b16 a[168:169], v7 offset:8192
    ds_read_b64_tr_b16 a[170:171], v7 offset:8704
    ds_read_b64_tr_b16 a[172:173], v8 offset:8192
    ds_read_b64_tr_b16 a[174:175], v8 offset:8704
    s_waitcnt lgkmcnt(8)
    s_add_u32 m0, s32, 4096
    s_sub_u32 s54, 13, s100
    s_mul_i32 s54, s54, 98304
    s_add_u32 s54, s54, s34
    buffer_load_dwordx4 v3, s[4:7], s54 offen offset:0  lds
    buffer_load_dwordx4 v4, s[4:7], s54 offen offset:1024  lds
    buffer_load_dwordx4 v252, s[4:7], s54 offen offset:2048  lds
    buffer_load_dwordx4 v253, s[4:7], s54 offen offset:3072  lds
    s_waitcnt vmcnt(8)
    ds_read_b64_tr_b16 a[176:177], v5 offset:12288
    ds_read_b64_tr_b16 a[178:179], v5 offset:12800
    ds_read_b64_tr_b16 a[180:181], v6 offset:12288
    ds_read_b64_tr_b16 a[182:183], v6 offset:12800
    ds_read_b64_tr_b16 a[184:185], v7 offset:12288
    ds_read_b64_tr_b16 a[186:187], v7 offset:12800
    ds_read_b64_tr_b16 a[188:189], v8 offset:12288
    ds_read_b64_tr_b16 a[190:191], v8 offset:12800
    s_waitcnt lgkmcnt(8)
    s_add_u32 m0, s32, 8192
    s_sub_u32 s54, 14, s100
    s_mul_i32 s54, s54, 98304
    s_add_u32 s54, s54, s34
    buffer_load_dwordx4 v3, s[4:7], s54 offen offset:0  lds
    buffer_load_dwordx4 v4, s[4:7], s54 offen offset:1024  lds
    buffer_load_dwordx4 v252, s[4:7], s54 offen offset:2048  lds
    buffer_load_dwordx4 v253, s[4:7], s54 offen offset:3072  lds
    buffer_load_dwordx2 v[92:93], v90, s[8:11], s38 offen sc1
    s_waitcnt vmcnt(9)
    ds_read_b64_tr_b16 a[192:193], v5 offset:0
    ds_read_b64_tr_b16 a[194:195], v5 offset:512
    ds_read_b64_tr_b16 a[196:197], v6 offset:0
    ds_read_b64_tr_b16 a[198:199], v6 offset:512
    ds_read_b64_tr_b16 a[200:201], v7 offset:0
    ds_read_b64_tr_b16 a[202:203], v7 offset:512
    ds_read_b64_tr_b16 a[204:205], v8 offset:0
    ds_read_b64_tr_b16 a[206:207], v8 offset:512
    s_waitcnt lgkmcnt(8)
    s_add_u32 m0, s32, 12288
    s_sub_u32 s54, 15, s100
    s_mul_i32 s54, s54, 98304
    s_add_u32 s54, s54, s34
    buffer_load_dwordx4 v3, s[4:7], s54 offen offset:0  lds
    buffer_load_dwordx4 v4, s[4:7], s54 offen offset:1024  lds
    buffer_load_dwordx4 v252, s[4:7], s54 offen offset:2048  lds
    buffer_load_dwordx4 v253, s[4:7], s54 offen offset:3072  lds
    s_branch L_u2d
L_nou2:
    s_cmp_eq_u32 s3, 2
    s_cbranch_scc0 L_es12
    s_mul_i32 s43, s2, 64
    s_add_u32 s43, s43, 0xa00000
    s_mov_b64 exec, 1
    v_mov_b32 v242, s30
    v_mov_b32 v243, s31
    v_mov_b32 v244, 0
    buffer_store_dwordx2 v[242:243], v244, s[8:11], s43 offen sc1
    s_mov_b64 exec, -1
L_es12:
    ds_read_b64_tr_b16 v[16:17], v84 offset:8448
    ds_read_b64_tr_b16 v[18:19], v84 offset:8480
    ds_read_b64_tr_b16 v[20:21], v84 offset:0
    ds_read_b64_tr_b16 v[22:23], v84 offset:32
    ds_read_b64_tr_b16 v[24:25], v84 offset:8576
    ds_read_b64_tr_b16 v[26:27], v84 offset:8608
    ds_read_b64_tr_b16 v[28:29], v84 offset:128
    ds_read_b64_tr_b16 v[30:31], v84 offset:160
    ds_read_b64_tr_b16 v[32:33], v84 offset:8704
    ds_read_b64_tr_b16 v[34:35], v84 offset:8736
    ds_read_b64_tr_b16 v[36:37], v84 offset:256
    ds_read_b64_tr_b16 v[38:39], v84 offset:288
    ds_read_b64_tr_b16 v[40:41], v84 offset:8832
    ds_read_b64_tr_b16 v[42:43], v84 offset:8864
    ds_read_b64_tr_b16 v[44:45], v84 offset:384
    ds_read_b64_tr_b16 v[46:47], v84 offset:416
    ds_read_b64_tr_b16 v[48:49], v84 offset:8960
    ds_read_b64_tr_b16 v[50:51], v84 offset:8992
    ds_read_b64_tr_b16 v[52:53], v84 offset:512
    ds_read_b64_tr_b16 v[54:55], v84 offset:544
    ds_read_b64_tr_b16 v[56:57], v84 offset:9088
    ds_read_b64_tr_b16 v[58:59], v84 offset:9120
    ds_read_b64_tr_b16 v[60:61], v84 offset:640
    ds_read_b64_tr_b16 v[62:63], v84 offset:672
    ds_read_b64_tr_b16 v[64:65], v84 offset:9216
    ds_read_b64_tr_b16 v[66:67], v84 offset:9248
    ds_read_b64_tr_b16 v[68:69], v84 offset:768
    ds_read_b64_tr_b16 v[70:71], v84 offset:800
    ds_read_b64_tr_b16 v[72:73], v84 offset:9344
    ds_read_b64_tr_b16 v[74:75], v84 offset:9376
    ds_read_b64_tr_b16 v[76:77], v84 offset:896
    ds_read_b64_tr_b16 v[78:79], v84 offset:928
    s_sub_u32 s44, s32, 32768
    s_sub_u32 s45, s34, 3145728
    s_add_u32 m0, s44, 0
    s_add_u32 s54, s100, 0
    s_mul_i32 s54, s54, 98304
    s_add_u32 s54, s54, s45
    buffer_load_dwordx4 v3, s[4:7], s54 offen offset:0  lds
    buffer_load_dwordx4 v4, s[4:7], s54 offen offset:1024  lds
    buffer_load_dwordx4 v252, s[4:7], s54 offen offset:2048  lds
    buffer_load_dwordx4 v253, s[4:7], s54 offen offset:3072  lds
    s_waitcnt lgkmcnt(0)
    s_barrier
    s_add_u32 m0, s44, 4096
    s_add_u32 s54, s100, 1
    s_mul_i32 s54, s54, 98304
    s_add_u32 s54, s54, s45
    buffer_load_dwordx4 v3, s[4:7], s54 offen offset:0  lds
    buffer_load_dwordx4 v4, s[4:7], s54 offen offset:1024  lds
    v_mfma_f32_32x32x16_bf16 v[204:219], v[16:19], v[20:23], 0
    buffer_load_dwordx4 v252, s[4:7], s54 offen offset:2048  lds
    buffer_load_dwordx4 v253, s[4:7], s54 offen offset:3072  lds
    v_mfma_f32_32x32x16_bf16 v[204:219], v[24:27], v[28:31], v[204:219]
    s_add_u32 m0, s44, 8192
    s_add_u32 s54, s100, 2
    s_mul_i32 s54, s54, 98304
    s_add_u32 s54, s54, s45
    buffer_load_dwordx4 v3, s[4:7], s54 offen offset:0  lds
    buffer_load_dwordx4 v4, s[4:7], s54 offen offset:1024  lds
    v_mfma_f32_32x32x16_bf16 v[204:219], v[32:35], v[36:39], v[204:219]
    buffer_load_dwordx4 v252, s[4:7], s54 offen offset:2048  lds
    buffer_load_dwordx4 v253, s[4:7], s54 offen offset:3072  lds
    v_mfma_f32_32x32x16_bf16 v[204:219], v[40:43], v[44:47], v[204:219]
    s_add_u32 m0, s44, 12288
    s_add_u32 s54, s100, 3
    s_mul_i32 s54, s54, 98304
    s_add_u32 s54, s54, s45
    buffer_load_dwordx4 v3, s[4:7], s54 offen offset:0  lds
    buffer_load_dwordx4 v4, s[4:7], s54 offen offset:1024  lds
    v_mfma_f32_32x32x16_bf16 v[204:219], v[48:51], v[52:55], v[204:219]
    buffer_load_dwordx4 v252, s[4:7], s54 offen offset:2048  lds
    buffer_load_dwordx4 v253, s[4:7], s54 offen offset:3072  lds
    v_mfma_f32_32x32x16_bf16 v[204:219], v[56:59], v[60:63], v[204:219]
    s_add_u32 m0, s32, 0
    s_add_u32 s54, s100, 0
    s_mul_i32 s54, s54, 98304
    s_add_u32 s54, s54, s34
    buffer_load_dwordx4 v3, s[4:7], s54 offen offset:0  lds
    buffer_load_dwordx4 v4, s[4:7], s54 offen offset:1024  lds
    v_mfma_f32_32x32x16_bf16 v[204:219], v[64:67], v[68:71], v[204:219]
    buffer_load_dwordx4 v252, s[4:7], s54 offen offset:2048  lds
    buffer_load_dwordx4 v253, s[4:7], s54 offen offset:3072  lds
    v_mfma_f32_32x32x16_bf16 v[204:219], v[72:75], v[76:79], v[204:219]
    s_add_u32 m0, s32, 4096
    s_add_u32 s54, s100, 1
    s_mul_i32 s54, s54, 98304
    s_add_u32 s54, s54, s34
    buffer_load_dwordx4 v3, s[4:7], s54 offen offset:0  lds
    buffer_load_dwordx4 v4, s[4:7], s54 offen offset:1024  lds
    buffer_load_dwordx4 v252, s[4:7], s54 offen offset:2048  lds
    buffer_load_dwordx4 v253, s[4:7], s54 offen offset:3072  lds
    ds_read_b64_tr_b16 v[16:17], v108 offset:8448
    ds_read_b64_tr_b16 v[18:19], v108 offset:8480
    ds_read_b64_tr_b16 v[20:21], v108 offset:0
    ds_read_b64_tr_b16 v[22:23], v108 offset:32
    ds_read_b64_tr_b16 v[24:25], v108 offset:8576
    ds_read_b64_tr_b16 v[26:27], v108 offset:8608
    ds_read_b64_tr_b16 v[28:29], v108 offset:128
    ds_read_b64_tr_b16 v[30:31], v108 offset:160
    ds_read_b64_tr_b16 v[32:33], v108 offset:8704
    ds_read_b64_tr_b16 v[34:35], v108 offset:8736
    ds_read_b64_tr_b16 v[36:37], v108 offset:256
    ds_read_b64_tr_b16 v[38:39], v108 offset:288
    ds_read_b64_tr_b16 v[40:41], v108 offset:8832
    ds_read_b64_tr_b16 v[42:43], v108 offset:8864
    ds_read_b64_tr_b16 v[44:45], v108 offset:384
    ds_read_b64_tr_b16 v[46:47], v108 offset:416
    ds_read_b64_tr_b16 v[48:49], v108 offset:8960
    ds_read_b64_tr_b16 v[50:51], v108 offset:8992
    ds_read_b64_tr_b16 v[52:53], v108 offset:512
    ds_read_b64_tr_b16 v[54:55], v108 offset:544
    ds_read_b64_tr_b16 v[56:57], v108 offset:9088
    ds_read_b64_tr_b16 v[58:59], v108 offset:9120
    ds_read_b64_tr_b16 v[60:61], v108 offset:640
    ds_read_b64_tr_b16 v[62:63], v108 offset:672
    ds_read_b64_tr_b16 v[64:65], v108 offset:9216
    ds_read_b64_tr_b16 v[66:67], v108 offset:9248
    ds_read_b64_tr_b16 v[68:69], v108 offset:768
    ds_read_b64_tr_b16 v[70:71], v108 offset:800
    ds_read_b64_tr_b16 v[72:73], v108 offset:9344
    ds_read_b64_tr_b16 v[74:75], v108 offset:9376
    ds_read_b64_tr_b16 v[76:77], v108 offset:896
    ds_read_b64_tr_b16 v[78:79], v108 offset:928
    s_add_u32 m0, s32, 8192
    s_add_u32 s54, s100, 2
    s_mul_i32 s54, s54, 98304
    s_add_u32 s54, s54, s34
    buffer_load_dwordx4 v3, s[4:7], s54 offen offset:0  lds
    buffer_load_dwordx4 v4, s[4:7], s54 offen offset:1024  lds
    buffer_load_dwordx4 v252, s[4:7], s54 offen offset:2048  lds
    buffer_load_dwordx4 v253, s[4:7], s54 offen offset:3072  lds
    s_add_u32 m0, s32, 12288
    s_add_u32 s54, s100, 3
    s_mul_i32 s54, s54, 98304
    s_add_u32 s54, s54, s34
    buffer_load_dwordx4 v3, s[4:7], s54 offen offset:0  lds
    buffer_load_dwordx4 v4, s[4:7], s54 offen offset:1024  lds
    buffer_load_dwordx4 v252, s[4:7], s54 offen offset:2048  lds
    buffer_load_dwordx4 v253, s[4:7], s54 offen offset:3072  lds
    s_waitcnt lgkmcnt(0)
    v_add_u32 v186, 65536, v5
    v_add_u32 v187, 65536, v6
    v_add_u32 v188, 65536, v7
    v_add_u32 v189, 65536, v8
    s_add_u32 m0, s33, 0
    s_add_u32 s54, s100, 4
    s_mul_i32 s54, s54, 98304
    s_add_u32 s54, s54, s34
    buffer_load_dwordx4 v3, s[4:7], s54 offen offset:0  lds
    buffer_load_dwordx4 v4, s[4:7], s54 offen offset:1024  lds
    v_mfma_f32_32x32x16_bf16 v[204:219], v[16:19], v[20:23], v[204:219]
    buffer_load_dwordx4 v252, s[4:7], s54 offen offset:2048  lds
    buffer_load_dwordx4 v253, s[4:7], s54 offen offset:3072  lds
    v_mfma_f32_32x32x16_bf16 v[204:219], v[24:27], v[28:31], v[204:219]
    s_add_u32 m0, s33, 4096
    s_add_u32 s54, s100, 5
    s_mul_i32 s54, s54, 98304
    s_add_u32 s54, s54, s34
    buffer_load_dwordx4 v3, s[4:7], s54 offen offset:0  lds
    buffer_load_dwordx4 v4, s[4:7], s54 offen offset:1024  lds
    v_mfma_f32_32x32x16_bf16 v[204:219], v[32:35], v[36:39], v[204:219]
    buffer_load_dwordx4 v252, s[4:7], s54 offen offset:2048  lds
    buffer_load_dwordx4 v253, s[4:7], s54 offen offset:3072  lds
    v_mfma_f32_32x32x16_bf16 v[204:219], v[40:43], v[44:47], v[204:219]
    s_add_u32 m0, s33, 8192
    s_add_u32 s54, s100, 6
    s_mul_i32 s54, s54, 98304
    s_add_u32 s54, s54, s34
    buffer_load_dwordx4 v3, s[4:7], s54 offen offset:0  lds
    buffer_load_dwordx4 v4, s[4:7], s54 offen offset:1024  lds
    v_mfma_f32_32x32x16_bf16 v[204:219], v[48:51], v[52:55], v[204:219]
    buffer_load_dwordx4 v252, s[4:7], s54 offen offset:2048  lds
    buffer_load_dwordx4 v253, s[4:7], s54 offen offset:3072  lds
    v_mfma_f32_32x32x16_bf16 v[204:219], v[56:59], v[60:63], v[204:219]
    s_add_u32 m0, s33, 12288
    s_add_u32 s54, s100, 7
    s_mul_i32 s54, s54, 98304
    s_add_u32 s54, s54, s34
    buffer_load_dwordx4 v3, s[4:7], s54 offen offset:0  lds
    buffer_load_dwordx4 v4, s[4:7], s54 offen offset:1024  lds
    v_mfma_f32_32x32x16_bf16 v[204:219], v[64:67], v[68:71], v[204:219]
    buffer_load_dwordx4 v252, s[4:7], s54 offen offset:2048  lds
    buffer_load_dwordx4 v253, s[4:7], s54 offen offset:3072  lds
    v_mfma_f32_32x32x16_bf16 v[204:219], v[72:75], v[76:79], v[204:219]
    s_waitcnt vmcnt(32)
    s_barrier
    ds_read_b64_tr_b16 v[16:17], v84 offset:8448
    ds_read_b64_tr_b16 v[18:19], v84 offset:8480
    ds_read_b64_tr_b16 v[20:21], v84 offset:0
    ds_read_b64_tr_b16 v[22:23], v84 offset:32
    ds_read_b64_tr_b16 v[24:25], v84 offset:8576
    ds_read_b64_tr_b16 v[26:27], v84 offset:8608
    ds_read_b64_tr_b16 v[28:29], v84 offset:128
    ds_read_b64_tr_b16 v[30:31], v84 offset:160
    ds_read_b64_tr_b16 v[32:33], v84 offset:8704
    ds_read_b64_tr_b16 v[34:35], v84 offset:8736
    ds_read_b64_tr_b16 v[36:37], v84 offset:256
    ds_read_b64_tr_b16 v[38:39], v84 offset:288
    ds_read_b64_tr_b16 v[40:41], v84 offset:8832
    ds_read_b64_tr_b16 v[42:43], v84 offset:8864
    ds_read_b64_tr_b16 v[44:45], v84 offset:384
    ds_read_b64_tr_b16 v[46:47], v84 offset:416
    ds_read_b64_tr_b16 v[48:49], v84 offset:8960
    ds_read_b64_tr_b16 v[50:51], v84 offset:8992
    ds_read_b64_tr_b16 v[52:53], v84 offset:512
    ds_read_b64_tr_b16 v[54:55], v84 offset:544
    ds_read_b64_tr_b16 v[56:57], v84 offset:9088
    ds_read_b64_tr_b16 v[58:59], v84 offset:9120
    ds_read_b64_tr_b16 v[60:61], v84 offset:640
    ds_read_b64_tr_b16 v[62:63], v84 offset:672
    ds_read_b64_tr_b16 v[64:65], v84 offset:9216
    ds_read_b64_tr_b16 v[66:67], v84 offset:9248
    ds_read_b64_tr_b16 v[68:69], v84 offset:768
    ds_read_b64_tr_b16 v[70:71], v84 offset:800
    ds_read_b64_tr_b16 v[72:73], v84 offset:9344
    ds_read_b64_tr_b16 v[74:75], v84 offset:9376
    ds_read_b64_tr_b16 v[76:77], v84 offset:896
    ds_read_b64_tr_b16 v[78:79], v84 offset:928
    s_mul_i32 s42, s3, 3072
    v_add_u32_e64 v88, s42, v1
    global_load_dwordx4 v[192:195], v88, s[50:51] offset:0
    global_load_dwordx4 v[196:199], v88, s[50:51] offset:1024
    global_load_dwordx4 v[200:203], v88, s[50:51] offset:2048
    s_waitcnt vmcnt(31)
    s_nop 0
    ds_read_b64_tr_b16 a[0:1], v5 offset:0
    ds_read_b64_tr_b16 a[2:3], v5 offset:512
    ds_read_b64_tr_b16 a[4:5], v6 offset:0
    ds_read_b64_tr_b16 a[6:7], v6 offset:512
    ds_read_b64_tr_b16 a[8:9], v7 offset:0
    ds_read_b64_tr_b16 a[10:11], v7 offset:512
    ds_read_b64_tr_b16 a[12:13], v8 offset:0
    ds_read_b64_tr_b16 a[14:15], v8 offset:512
    s_waitcnt vmcnt(27)
    s_nop 0
    ds_read_b64_tr_b16 a[16:17], v5 offset:4096
    ds_read_b64_tr_b16 a[18:19], v5 offset:4608
    ds_read_b64_tr_b16 a[20:21], v6 offset:4096
    ds_read_b64_tr_b16 a[22:23], v6 offset:4608
    ds_read_b64_tr_b16 a[24:25], v7 offset:4096
    ds_read_b64_tr_b16 a[26:27], v7 offset:4608
    ds_read_b64_tr_b16 a[28:29], v8 offset:4096
    ds_read_b64_tr_b16 a[30:31], v8 offset:4608
    s_waitcnt lgkmcnt(8)
    v_mfma_f32_32x32x16_bf16 v[204:219], v[16:19], v[20:23], v[204:219]
    s_xor_b32 s42, s3, 1
    s_mul_i32 s42, s42, 15360
    s_add_u32 s42, s42, 0
    v_add_u32 v222, s42, v1
    s_xor_b32 s42, s3, 2
    s_mul_i32 s42, s42, 15360
    s_add_u32 s42, s42, 5120
    v_add_u32 v223, s42, v1
    s_xor_b32 s42, s3, 3
    s_mul_i32 s42, s42, 15360
    s_add_u32 s42, s42, 10240
    v_add_u32 v224, s42, v1
    s_mul_i32 s42, s3, 15360
    v_add_u32 v225, s42, v1
    s_mov_b32 s60, 0xc0135761
    s_mov_b32 s61, 0xbdd2d3e8
    v_lshrrev_b32 v230, 5, v0
    v_lshlrev_b32 v230, 10, v230
    v_and_b32 v180, 31, v0
    s_add_u32 m0, s32, 0
    s_sub_u32 s54, 8, s100
    s_mul_i32 s54, s54, 98304
    s_add_u32 s54, s54, s34
    buffer_load_dwordx4 v3, s[4:7], s54 offen offset:0  lds
    buffer_load_dwordx4 v4, s[4:7], s54 offen offset:1024  lds
    buffer_load_dwordx4 v252, s[4:7], s54 offen offset:2048  lds
    buffer_load_dwordx4 v253, s[4:7], s54 offen offset:3072  lds
    s_waitcnt vmcnt(27)
    ds_read_b64_tr_b16 a[32:33], v5 offset:8192
    ds_read_b64_tr_b16 a[34:35], v5 offset:8704
    ds_read_b64_tr_b16 a[36:37], v6 offset:8192
    ds_read_b64_tr_b16 a[38:39], v6 offset:8704
    ds_read_b64_tr_b16 a[40:41], v7 offset:8192
    ds_read_b64_tr_b16 a[42:43], v7 offset:8704
    ds_read_b64_tr_b16 a[44:45], v8 offset:8192
    ds_read_b64_tr_b16 a[46:47], v8 offset:8704
    s_waitcnt lgkmcnt(8)
    v_mfma_f32_32x32x16_bf16 v[204:219], v[24:27], v[28:31], v[204:219]
    v_lshl_add_u32 v230, v180, 4, v230
    s_lshl_b32 s46, s25, 1
    s_lshr_b32 s47, s3, 1
    s_add_u32 s46, s46, s47
    s_mul_i32 s46, s46, 40
    s_mul_i32 s47, s24, 5
    s_add_u32 s46, s46, s47
    s_lshl_b32 s46, s46, 10
    s_and_b32 s47, s3, 1
    s_lshl_b32 s47, s47, 9
    s_add_u32 s46, s46, s47
    s_add_u32 s46, s46, 0x500000
    s_add_u32 s47, s46, 4096
    v_lshrrev_b32 v231, 1, v0
    s_lshl_b32 s42, s3, 6
    v_add_u32 v231, s42, v231
    v_lshrrev_b32 v232, 2, v231
    v_mul_u32_u24 v232, 40960, v232
    v_and_b32 v234, 3, v231
    s_add_u32 m0, s32, 4096
    s_sub_u32 s54, 9, s100
    s_mul_i32 s54, s54, 98304
    s_add_u32 s54, s54, s34
    buffer_load_dwordx4 v3, s[4:7], s54 offen offset:0  lds
    buffer_load_dwordx4 v4, s[4:7], s54 offen offset:1024  lds
    buffer_load_dwordx4 v252, s[4:7], s54 offen offset:2048  lds
    buffer_load_dwordx4 v253, s[4:7], s54 offen offset:3072  lds
    s_waitcnt vmcnt(27)
    s_nop 0
    ds_read_b64_tr_b16 a[48:49], v5 offset:12288
    ds_read_b64_tr_b16 a[50:51], v5 offset:12800
    ds_read_b64_tr_b16 a[52:53], v6 offset:12288
    ds_read_b64_tr_b16 a[54:55], v6 offset:12800
    ds_read_b64_tr_b16 a[56:57], v7 offset:12288
    ds_read_b64_tr_b16 a[58:59], v7 offset:12800
    ds_read_b64_tr_b16 a[60:61], v8 offset:12288
    ds_read_b64_tr_b16 a[62:63], v8 offset:12800
    s_waitcnt lgkmcnt(8)
    v_mfma_f32_32x32x16_bf16 v[204:219], v[32:35], v[36:39], v[204:219]
    v_lshl_add_u32 v232, v234, 8, v232
    v_and_b32 v234, 1, v0
    v_lshl_add_u32 v232, v234, 4, v232
    v_mul_u32_u24 v234, 4608, v234
    v_lshl_add_u32 v233, v231, 4, v234
    v_add_u32 v233, 148224, v233
    v_lshlrev_b32 v231, 5, v231
    s_and_b32 s42, s3, 1
    s_lshr_b32 s43, s3, 1
    s_lshl_b32 s43, s43, 8
    s_mul_i32 s44, s42, 8320
    s_add_u32 s44, s44, 131072
    s_sub_u32 s44, s44, s43
    s_mul_i32 s45, s42, 4608
    s_add_u32 s45, s45, 148224
    s_sub_u32 s45, s45, s43
    v_and_b32 v180, 15, v0
    v_bfe_u32 v181, v0, 4, 1
    v_lshrrev_b32 v182, 5, v0
    s_add_u32 m0, s32, 8192
    s_sub_u32 s54, 10, s100
    s_mul_i32 s54, s54, 98304
    s_add_u32 s54, s54, s34
    buffer_load_dwordx4 v3, s[4:7], s54 offen offset:0  lds
    buffer_load_dwordx4 v4, s[4:7], s54 offen offset:1024  lds
    buffer_load_dwordx4 v252, s[4:7], s54 offen offset:2048  lds
    buffer_load_dwordx4 v253, s[4:7], s54 offen offset:3072  lds
    s_waitcnt vmcnt(27)
    s_nop 0
    ds_read_b64_tr_b16 a[64:65], v186 offset:0
    ds_read_b64_tr_b16 a[66:67], v186 offset:512
    ds_read_b64_tr_b16 a[68:69], v187 offset:0
    ds_read_b64_tr_b16 a[70:71], v187 offset:512
    ds_read_b64_tr_b16 a[72:73], v188 offset:0
    ds_read_b64_tr_b16 a[74:75], v188 offset:512
    ds_read_b64_tr_b16 a[76:77], v189 offset:0
    ds_read_b64_tr_b16 a[78:79], v189 offset:512
    s_waitcnt lgkmcnt(8)
    v_mfma_f32_32x32x16_bf16 v[204:219], v[40:43], v[44:47], v[204:219]
    v_sub_u32 v183, 2047, v180
    v_lshl_add_u32 v183, v181, 3, v183
    v_lshlrev_b32 v184, 4, v182
    v_sub_u32 v183, v183, v184
    v_lshrrev_b32 v183, 1, v183
    v_lshlrev_b32 v183, 2, v183
    v_and_b32 v184, 1, v0
    v_mul_u32_u24 v184, 4160, v184
    v_sub_u32 v183, v183, v184
    v_add_u32 v183, s44, v183
    v_add_u32 v235, 3456, v183
    v_add_u32 v236, 2432, v183
    v_add_u32 v237, 1408, v183
    v_add_u32 v238, 384, v183
    v_sub_u32 v183, v180, v182
    v_lshlrev_b32 v183, 5, v183
    v_lshl_add_u32 v183, v181, 4, v183
    v_add_u32 v183, s45, v183
    v_subrev_u32 v239, 192, v183
    s_add_u32 m0, s32, 12288
    s_sub_u32 s54, 11, s100
    s_mul_i32 s54, s54, 98304
    s_add_u32 s54, s54, s34
    buffer_load_dwordx4 v3, s[4:7], s54 offen offset:0  lds
    buffer_load_dwordx4 v4, s[4:7], s54 offen offset:1024  lds
    buffer_load_dwordx4 v252, s[4:7], s54 offen offset:2048  lds
    buffer_load_dwordx4 v253, s[4:7], s54 offen offset:3072  lds
    s_waitcnt vmcnt(27)
    ds_read_b64_tr_b16 a[80:81], v186 offset:4096
    ds_read_b64_tr_b16 a[82:83], v186 offset:4608
    ds_read_b64_tr_b16 a[84:85], v187 offset:4096
    ds_read_b64_tr_b16 a[86:87], v187 offset:4608
    ds_read_b64_tr_b16 a[88:89], v188 offset:4096
    ds_read_b64_tr_b16 a[90:91], v188 offset:4608
    ds_read_b64_tr_b16 a[92:93], v189 offset:4096
    ds_read_b64_tr_b16 a[94:95], v189 offset:4608
    s_waitcnt lgkmcnt(8)
    v_mfma_f32_32x32x16_bf16 v[204:219], v[48:51], v[52:55], v[204:219]
    s_mov_b32 s12, s64
    s_mov_b32 s13, s65
    s_mov_b32 s14, 0x280000
    s_mov_b32 s15, 0x20000
    s_mov_b32 s20, s88
    s_mov_b32 s21, s89
    s_mov_b32 s22, 0x280000
    s_mov_b32 s23, 0x20000
    v_and_b32 v246, 15, v0
    v_lshlrev_b32 v247, 1, v246
    v_mul_u32_u24 v246, 1280, v246
    v_lshrrev_b32 v248, 4, v0
    v_lshl_add_u32 v249, v248, 3, v246
    v_bfe_u32 v248, v0, 4, 1
    v_lshl_add_u32 v246, v248, 5, v246
    v_lshrrev_b32 v248, 5, v0
    v_lshl_add_u32 v246, v248, 4, v246
    s_lshl_b32 s39, s26, 2
    s_add_u32 s39, s39, s3
    s_add_u32 m0, s33, 0
    s_sub_u32 s54, 12, s100
    s_mul_i32 s54, s54, 98304
    s_add_u32 s54, s54, s34
    buffer_load_dwordx4 v3, s[4:7], s54 offen offset:0  lds
    buffer_load_dwordx4 v4, s[4:7], s54 offen offset:1024  lds
    buffer_load_dwordx4 v252, s[4:7], s54 offen offset:2048  lds
    buffer_load_dwordx4 v253, s[4:7], s54 offen offset:3072  lds
    s_waitcnt vmcnt(27)
    s_nop 0
    ds_read_b64_tr_b16 a[96:97], v186 offset:8192
    ds_read_b64_tr_b16 a[98:99], v186 offset:8704
    ds_read_b64_tr_b16 a[100:101], v187 offset:8192
    ds_read_b64_tr_b16 a[102:103], v187 offset:8704
    ds_read_b64_tr_b16 a[104:105], v188 offset:8192
    ds_read_b64_tr_b16 a[106:107], v188 offset:8704
    ds_read_b64_tr_b16 a[108:109], v189 offset:8192
    ds_read_b64_tr_b16 a[110:111], v189 offset:8704
    s_waitcnt lgkmcnt(8)
    v_mfma_f32_32x32x16_bf16 v[204:219], v[56:59], v[60:63], v[204:219]
    s_lshl_b32 s29, s39, 5
    s_mul_i32 s39, s39, 20480
    s_mul_i32 s55, s24, 160
    s_add_u32 s39, s39, s55
    v_add_u32 v247, s29, v247
    v_bfe_u32 v180, v0, 2, 2
    v_bfe_u32 v181, v0, 4, 1
    v_lshrrev_b32 v182, 5, v0
    v_lshl_add_u32 v182, v182, 4, v180
    v_lshl_add_u32 v182, v181, 2, v182
    v_lshlrev_b32 v182, 7, v182
    v_lshrrev_b32 v180, 1, v180
    v_lshl_or_b32 v180, v181, 1, v180
    v_xor_b32 v180, s3, v180
    v_lshl_add_u32 v182, v180, 5, v182
    v_and_b32 v180, 3, v0
    v_lshl_add_u32 v182, v180, 3, v182
    v_add_u32 v10, s33, v182
    v_xor_b32 v11, 32, v10
    s_add_u32 m0, s33, 4096
    s_sub_u32 s54, 13, s100
    s_mul_i32 s54, s54, 98304
    s_add_u32 s54, s54, s34
    buffer_load_dwordx4 v3, s[4:7], s54 offen offset:0  lds
    buffer_load_dwordx4 v4, s[4:7], s54 offen offset:1024  lds
    buffer_load_dwordx4 v252, s[4:7], s54 offen offset:2048  lds
    buffer_load_dwordx4 v253, s[4:7], s54 offen offset:3072  lds
    s_waitcnt vmcnt(27)
    ds_read_b64_tr_b16 a[112:113], v186 offset:12288
    ds_read_b64_tr_b16 a[114:115], v186 offset:12800
    ds_read_b64_tr_b16 a[116:117], v187 offset:12288
    ds_read_b64_tr_b16 a[118:119], v187 offset:12800
    ds_read_b64_tr_b16 a[120:121], v188 offset:12288
    ds_read_b64_tr_b16 a[122:123], v188 offset:12800
    ds_read_b64_tr_b16 a[124:125], v189 offset:12288
    ds_read_b64_tr_b16 a[126:127], v189 offset:12800
    s_waitcnt lgkmcnt(8)
    v_mfma_f32_32x32x16_bf16 v[204:219], v[64:67], v[68:71], v[204:219]
    v_xor_b32 v12, 64, v10
    v_xor_b32 v13, 96, v10
    s_lshl_b32 s42, s41, 2
    s_add_u32 s42, s42, s3
    s_lshr_b32 s43, s42, 5
    s_lshl_b32 s43, s43, 6
    s_bfe_u32 s44, s42, 0x20003
    s_mul_i32 s44, s44, 384
    s_add_u32 s43, s43, s44
    s_and_b32 s42, s42, 7
    s_lshl_b32 s42, s42, 3
    s_add_u32 s43, s43, s42
    s_lshl_b32 s59, s43, 12
    s_lshr_b32 s42, s40, 1
    s_lshl_b32 s42, s42, 10
    s_add_u32 s59, s59, s42
    v_bfe_u32 v180, v0, 2, 1
    v_and_b32 v180, 1, v180
    s_and_b32 s42, s40, 1
    s_add_u32 m0, s33, 8192
    s_sub_u32 s54, 14, s100
    s_mul_i32 s54, s54, 98304
    s_add_u32 s54, s54, s34
    buffer_load_dwordx4 v3, s[4:7], s54 offen offset:0  lds
    buffer_load_dwordx4 v4, s[4:7], s54 offen offset:1024  lds
    buffer_load_dwordx4 v252, s[4:7], s54 offen offset:2048  lds
    buffer_load_dwordx4 v253, s[4:7], s54 offen offset:3072  lds
    s_waitcnt vmcnt(24)
    s_nop 0
    ds_read_b64_tr_b16 a[128:129], v5 offset:0
    ds_read_b64_tr_b16 a[130:131], v5 offset:512
    ds_read_b64_tr_b16 a[132:133], v6 offset:0
    ds_read_b64_tr_b16 a[134:135], v6 offset:512
    ds_read_b64_tr_b16 a[136:137], v7 offset:0
    ds_read_b64_tr_b16 a[138:139], v7 offset:512
    ds_read_b64_tr_b16 a[140:141], v8 offset:0
    ds_read_b64_tr_b16 a[142:143], v8 offset:512
    s_waitcnt lgkmcnt(8)
    v_mfma_f32_32x32x16_bf16 v[204:219], v[72:75], v[76:79], v[204:219]
    s_xor_b32 s42, s42, 1
    v_xor_b32 v180, s42, v180
    v_mul_u32_u24 v180, 192, v180
    v_lshrrev_b32 v251, 3, v0
    v_add_u32 v251, v251, v180
    v_lshlrev_b32 v251, 12, v251
    v_and_b32 v180, 7, v0
    v_lshl_add_u32 v251, v180, 7, v251
    s_lshl_b32 s48, s24, 5
    s_add_u32 s48, s48, s25
    s_mul_i32 s48, s48, 64
    s_add_u32 s48, s48, 0xa10000
    buffer_load_dwordx2 v[92:93], v90, s[8:11], s38 offen sc1
    s_add_u32 m0, s33, 12288
    s_sub_u32 s54, 15, s100
    s_mul_i32 s54, s54, 98304
    s_add_u32 s54, s54, s34
    buffer_load_dwordx4 v3, s[4:7], s54 offen offset:0  lds
    buffer_load_dwordx4 v4, s[4:7], s54 offen offset:1024  lds
    buffer_load_dwordx4 v252, s[4:7], s54 offen offset:2048  lds
    buffer_load_dwordx4 v253, s[4:7], s54 offen offset:3072  lds
    s_mov_b64 exec, 1
    v_add_f32 v204, v204, v91
    s_mov_b64 exec, -1
    s_nop 0
    ds_write_b32 v89, v204 offset:0
    ds_write_b32 v89, v205 offset:128
    ds_write_b32 v89, v206 offset:256
    ds_write_b32 v89, v207 offset:384
    ds_write_b32 v89, v208 offset:1024
    ds_write_b32 v89, v209 offset:1152
    ds_write_b32 v89, v210 offset:1280
    ds_write_b32 v89, v211 offset:1408
    ds_write_b32 v89, v212 offset:2048
    ds_write_b32 v89, v213 offset:2176
    ds_write_b32 v89, v214 offset:2304
    ds_write_b32 v89, v215 offset:2432
    s_waitcnt vmcnt(25)
    s_nop 0
    ds_read_b64_tr_b16 a[144:145], v5 offset:4096
    ds_read_b64_tr_b16 a[146:147], v5 offset:4608
    ds_read_b64_tr_b16 a[148:149], v6 offset:4096
    ds_read_b64_tr_b16 a[150:151], v6 offset:4608
    ds_read_b64_tr_b16 a[152:153], v7 offset:4096
    ds_read_b64_tr_b16 a[154:155], v7 offset:4608
    ds_read_b64_tr_b16 a[156:157], v8 offset:4096
    ds_read_b64_tr_b16 a[158:159], v8 offset:4608
    s_waitcnt vmcnt(21)
    s_nop 0
    ds_read_b64_tr_b16 a[160:161], v5 offset:8192
    ds_read_b64_tr_b16 a[162:163], v5 offset:8704
    ds_read_b64_tr_b16 a[164:165], v6 offset:8192
    ds_read_b64_tr_b16 a[166:167], v6 offset:8704
    ds_read_b64_tr_b16 a[168:169], v7 offset:8192
    ds_read_b64_tr_b16 a[170:171], v7 offset:8704
    ds_read_b64_tr_b16 a[172:173], v8 offset:8192
    ds_read_b64_tr_b16 a[174:175], v8 offset:8704
L_u2d:
    s_mul_i32 s36, s3, 655360
    s_mul_i32 s43, s24, 5120
    s_add_u32 s36, s36, s43
    v_mov_b32 v242, 163088
    ds_read_b64 v[240:241], v242
    s_waitcnt lgkmcnt(0)
    v_readfirstlane_b32 s30, v240
    v_readfirstlane_b32 s31, v241
    s_barrier
    s_waitcnt vmcnt(4)
    v_cmp_ne_u64 vcc, s[30:31], v[92:93]
    s_cbranch_vccz L_pp1
    s_mov_b32 s29, 0
L_pl13:
    buffer_load_dwordx2 v[242:243], v90, s[8:11], s38 offen sc1
    s_add_u32 s29, s29, 1
    s_cmp_gt_u32 s29, 262144
    s_cbranch_scc1 L_pl14
    s_waitcnt vmcnt(0)
    v_cmp_ne_u64 vcc, s[30:31], v[242:243]
    s_cbranch_vccz L_pl14
    s_branch L_pl13
L_pl14:
L_pp1:
    s_add_u32 s62, s100, 0
    s_mul_i32 s62, s62, 40960
    s_add_u32 s62, s62, s36
    buffer_load_dwordx4 v[96:99], v1, s[8:11], s62 offen offset:0 sc1
    buffer_load_dwordx4 v[100:103], v1, s[8:11], s62 offen offset:1024 sc1
    buffer_load_dwordx4 v[104:107], v1, s[8:11], s62 offen offset:2048 sc1
    buffer_load_dwordx4 v[108:111], v1, s[8:11], s62 offen offset:3072 sc1
    buffer_load_dwordx4 v[112:115], v2, s[8:11], s62 offen sc1
    s_add_u32 s63, s100, 1
    s_mul_i32 s63, s63, 40960
    s_add_u32 s63, s63, s36
    s_nop 0
    buffer_load_dwordx4 v[116:119], v1, s[8:11], s63 offen offset:0 sc1
    buffer_load_dwordx4 v[120:123], v1, s[8:11], s63 offen offset:1024 sc1
    buffer_load_dwordx4 v[124:127], v1, s[8:11], s63 offen offset:2048 sc1
    buffer_load_dwordx4 v[128:131], v1, s[8:11], s63 offen offset:3072 sc1
    buffer_load_dwordx4 v[132:135], v2, s[8:11], s63 offen sc1
    v_add_u32 v192, 156928, v192
    v_add_u32 v193, 156928, v193
    v_add_u32 v194, 156928, v194
    v_add_u32 v195, 156928, v195
    v_add_u32 v196, 156928, v196
    v_add_u32 v197, 156928, v197
    v_add_u32 v198, 156928, v198
    v_add_u32 v199, 156928, v199
    v_add_u32 v200, 156928, v200
    s_lshl_b32 s42, s3, 10
    s_add_u32 s42, s42, 131072
    v_add_u32 v202, s42, v1
    v_lshlrev_b32 v226, 16, v14
    v_and_b32 v227, 0xffff0000, v14
    v_lshlrev_b32 v228, 16, v15
    v_and_b32 v229, 0xffff0000, v15
    s_waitcnt vmcnt(9)
    s_nop 0
    v_mfma_f32_16x16x32_bf16 v[16:19], a[0:3], v[96:99], v[226:229]
    s_add_u32 s62, s100, 2
    s_mul_i32 s62, s62, 40960
    v_mfma_f32_16x16x32_bf16 v[36:39], a[4:7], v[96:99], 0
    s_add_u32 s62, s62, s36
    buffer_load_dwordx4 v[136:139], v1, s[8:11], s62 offen offset:0 sc1
    v_mfma_f32_16x16x32_bf16 v[56:59], a[8:11], v[96:99], 0
    s_add_u32 s63, s100, 3
    s_mul_i32 s63, s63, 40960
    v_mfma_f32_16x16x32_bf16 v[76:79], a[12:15], v[96:99], 0
    s_cmp_lt_u32 s3, 2
    s_cbranch_scc0 L_nohold
    s_nop 0
    ds_read_b64_tr_b16 a[208:209], v5 offset:4096
    ds_read_b64_tr_b16 a[210:211], v5 offset:4608
    ds_read_b64_tr_b16 a[212:213], v6 offset:4096
    ds_read_b64_tr_b16 a[214:215], v6 offset:4608
    ds_read_b64_tr_b16 a[216:217], v7 offset:4096
    ds_read_b64_tr_b16 a[218:219], v7 offset:4608
    ds_read_b64_tr_b16 a[220:221], v8 offset:4096
    ds_read_b64_tr_b16 a[222:223], v8 offset:4608
    ds_read_b64_tr_b16 a[224:225], v5 offset:8192
    ds_read_b64_tr_b16 a[226:227], v5 offset:8704
    ds_read_b64_tr_b16 a[228:229], v6 offset:8192
    ds_read_b64_tr_b16 a[230:231], v6 offset:8704
    ds_read_b64_tr_b16 a[232:233], v7 offset:8192
    ds_read_b64_tr_b16 a[234:235], v7 offset:8704
    ds_read_b64_tr_b16 a[236:237], v8 offset:8192
    ds_read_b64_tr_b16 a[238:239], v8 offset:8704
    ds_read_b64_tr_b16 a[240:241], v5 offset:12288
    ds_read_b64_tr_b16 a[242:243], v5 offset:12800
    ds_read_b64_tr_b16 a[244:245], v6 offset:12288
    ds_read_b64_tr_b16 a[246:247], v6 offset:12800
    ds_read_b64_tr_b16 a[248:249], v7 offset:12288
    ds_read_b64_tr_b16 a[250:251], v7 offset:12800
    ds_read_b64_tr_b16 a[252:253], v8 offset:12288
    ds_read_b64_tr_b16 a[254:255], v8 offset:12800
    s_branch L_nohold2
L_nohold:
    s_nop 0
    ds_read_b64_tr_b16 a[176:177], v5 offset:12288
    ds_read_b64_tr_b16 a[178:179], v5 offset:12800
    ds_read_b64_tr_b16 a[180:181], v6 offset:12288
    ds_read_b64_tr_b16 a[182:183], v6 offset:12800
    ds_read_b64_tr_b16 a[184:185], v7 offset:12288
    ds_read_b64_tr_b16 a[186:187], v7 offset:12800
    ds_read_b64_tr_b16 a[188:189], v8 offset:12288
    ds_read_b64_tr_b16 a[190:191], v8 offset:12800
    ds_read_b64_tr_b16 a[192:193], v186 offset:0
    ds_read_b64_tr_b16 a[194:195], v186 offset:512
    ds_read_b64_tr_b16 a[196:197], v187 offset:0
    ds_read_b64_tr_b16 a[198:199], v187 offset:512
    ds_read_b64_tr_b16 a[200:201], v188 offset:0
    ds_read_b64_tr_b16 a[202:203], v188 offset:512
    ds_read_b64_tr_b16 a[204:205], v189 offset:0
    ds_read_b64_tr_b16 a[206:207], v189 offset:512
    ds_read_b64_tr_b16 a[208:209], v186 offset:4096
    ds_read_b64_tr_b16 a[210:211], v186 offset:4608
    ds_read_b64_tr_b16 a[212:213], v187 offset:4096
    ds_read_b64_tr_b16 a[214:215], v187 offset:4608
    ds_read_b64_tr_b16 a[216:217], v188 offset:4096
    ds_read_b64_tr_b16 a[218:219], v188 offset:4608
    ds_read_b64_tr_b16 a[220:221], v189 offset:4096
    ds_read_b64_tr_b16 a[222:223], v189 offset:4608
    ds_read_b64_tr_b16 a[224:225], v186 offset:8192
    ds_read_b64_tr_b16 a[226:227], v186 offset:8704
    ds_read_b64_tr_b16 a[228:229], v187 offset:8192
    ds_read_b64_tr_b16 a[230:231], v187 offset:8704
    ds_read_b64_tr_b16 a[232:233], v188 offset:8192
    ds_read_b64_tr_b16 a[234:235], v188 offset:8704
    ds_read_b64_tr_b16 a[236:237], v189 offset:8192
    ds_read_b64_tr_b16 a[238:239], v189 offset:8704
    ds_read_b64_tr_b16 a[240:241], v186 offset:12288
    ds_read_b64_tr_b16 a[242:243], v186 offset:12800
    ds_read_b64_tr_b16 a[244:245], v187 offset:12288
    ds_read_b64_tr_b16 a[246:247], v187 offset:12800
    ds_read_b64_tr_b16 a[248:249], v188 offset:12288
    ds_read_b64_tr_b16 a[250:251], v188 offset:12800
    ds_read_b64_tr_b16 a[252:253], v189 offset:12288
    ds_read_b64_tr_b16 a[254:255], v189 offset:12800
L_nohold2:
    s_waitcnt vmcnt(9)
    v_mfma_f32_16x16x32_bf16 v[20:23], a[0:3], v[100:103], v[226:229]
    s_add_u32 s63, s63, s36
    v_mfma_f32_16x16x32_bf16 v[40:43], a[4:7], v[100:103], 0
    buffer_load_dwordx4 v[140:143], v1, s[8:11], s62 offen offset:1024 sc1
    v_mfma_f32_16x16x32_bf16 v[60:63], a[8:11], v[100:103], 0
    v_mfma_f32_16x16x32_bf16 v[80:83], a[12:15], v[100:103], 0
    ds_read_b32 v204, v192 offset:0
    ds_read_b32 v205, v193 offset:0
    ds_read_b32 v206, v194 offset:0
    ds_read_b32 v207, v195 offset:0
    ds_read_b32 v208, v196 offset:0
    ds_read_b32 v209, v197 offset:0
    ds_read_b32 v210, v198 offset:0
    ds_read_b32 v211, v199 offset:0
    ds_read_b32 v212, v200 offset:0
    s_waitcnt vmcnt(9)
    v_mfma_f32_16x16x32_bf16 v[24:27], a[0:3], v[104:107], v[226:229]
    v_mfma_f32_16x16x32_bf16 v[44:47], a[4:7], v[104:107], 0
    buffer_load_dwordx4 v[144:147], v1, s[8:11], s62 offen offset:2048 sc1
    v_mfma_f32_16x16x32_bf16 v[64:67], a[8:11], v[104:107], 0
    v_mfma_f32_16x16x32_bf16 v[84:87], a[12:15], v[104:107], 0
    s_waitcnt vmcnt(9)
    v_mfma_f32_16x16x32_bf16 v[28:31], a[0:3], v[108:111], v[226:229]
    s_waitcnt lgkmcnt(0)
    v_cvt_pk_bf16_f32 v214, v204, v205
    v_mfma_f32_16x16x32_bf16 v[48:51], a[4:7], v[108:111], 0
    buffer_load_dwordx4 v[148:151], v1, s[8:11], s62 offen offset:3072 sc1
    v_mfma_f32_16x16x32_bf16 v[68:71], a[8:11], v[108:111], 0
    v_cvt_pk_bf16_f32 v218, v205, v206
    v_cvt_pk_bf16_f32 v215, v206, v207
    v_mfma_f32_16x16x32_bf16 v[88:91], a[12:15], v[108:111], 0
    v_cvt_pk_bf16_f32 v219, v207, v208
    v_cvt_pk_bf16_f32 v216, v208, v209
    s_waitcnt vmcnt(9)
    v_mfma_f32_16x16x32_bf16 v[32:35], a[0:3], v[112:115], v[226:229]
    v_cvt_pk_bf16_f32 v220, v209, v210
    v_cvt_pk_bf16_f32 v217, v210, v211
    v_mfma_f32_16x16x32_bf16 v[52:55], a[4:7], v[112:115], 0
    buffer_load_dwordx4 v[152:155], v2, s[8:11], s62 offen sc1
    v_mfma_f32_16x16x32_bf16 v[72:75], a[8:11], v[112:115], 0
    v_cvt_pk_bf16_f32 v221, v211, v212
    ds_write_b128 v202, v[214:217] offset:0
    v_mfma_f32_16x16x32_bf16 v[92:95], a[12:15], v[112:115], 0
    ds_write_b128 v202, v[218:221] offset:4160
    s_waitcnt vmcnt(9)
    v_mfma_f32_16x16x32_bf16 v[16:19], a[16:19], v[116:119], v[16:19]
    v_mfma_f32_16x16x32_bf16 v[36:39], a[20:23], v[116:119], v[36:39]
    buffer_load_dwordx4 v[156:159], v1, s[8:11], s63 offen offset:0 sc1
    v_mfma_f32_16x16x32_bf16 v[56:59], a[24:27], v[116:119], v[56:59]
    s_add_u32 s62, s100, 4
    s_mul_i32 s62, s62, 40960
    v_mfma_f32_16x16x32_bf16 v[76:79], a[28:31], v[116:119], v[76:79]
    ds_read_b32 v204, v192 offset:3072
    ds_read_b32 v205, v193 offset:3072
    ds_read_b32 v206, v194 offset:3072
    ds_read_b32 v207, v195 offset:3072
    ds_read_b32 v208, v196 offset:3072
    ds_read_b32 v209, v197 offset:3072
    ds_read_b32 v210, v198 offset:3072
    ds_read_b32 v211, v199 offset:3072
    ds_read_b32 v212, v200 offset:3072
    s_waitcnt vmcnt(9)
    v_mfma_f32_16x16x32_bf16 v[20:23], a[16:19], v[120:123], v[20:23]
    s_add_u32 s62, s62, s36
    v_mfma_f32_16x16x32_bf16 v[40:43], a[20:23], v[120:123], v[40:43]
    buffer_load_dwordx4 v[160:163], v1, s[8:11], s63 offen offset:1024 sc1
    v_mfma_f32_16x16x32_bf16 v[60:63], a[24:27], v[120:123], v[60:63]
    v_mfma_f32_16x16x32_bf16 v[80:83], a[28:31], v[120:123], v[80:83]
    s_waitcnt vmcnt(9)
    v_mfma_f32_16x16x32_bf16 v[24:27], a[16:19], v[124:127], v[24:27]
    s_waitcnt lgkmcnt(0)
    v_cvt_pk_bf16_f32 v214, v204, v205
    v_mfma_f32_16x16x32_bf16 v[44:47], a[20:23], v[124:127], v[44:47]
    buffer_load_dwordx4 v[164:167], v1, s[8:11], s63 offen offset:2048 sc1
    v_mfma_f32_16x16x32_bf16 v[64:67], a[24:27], v[124:127], v[64:67]
    v_cvt_pk_bf16_f32 v218, v205, v206
    v_cvt_pk_bf16_f32 v215, v206, v207
    v_mfma_f32_16x16x32_bf16 v[84:87], a[28:31], v[124:127], v[84:87]
    v_cvt_pk_bf16_f32 v219, v207, v208
    v_cvt_pk_bf16_f32 v216, v208, v209
    s_waitcnt vmcnt(9)
    v_mfma_f32_16x16x32_bf16 v[28:31], a[16:19], v[128:131], v[28:31]
    v_cvt_pk_bf16_f32 v220, v209, v210
    v_cvt_pk_bf16_f32 v217, v210, v211
    v_mfma_f32_16x16x32_bf16 v[48:51], a[20:23], v[128:131], v[48:51]
    buffer_load_dwordx4 v[168:171], v1, s[8:11], s63 offen offset:3072 sc1
    v_mfma_f32_16x16x32_bf16 v[68:71], a[24:27], v[128:131], v[68:71]
    v_cvt_pk_bf16_f32 v221, v211, v212
    ds_write_b128 v202, v[214:217] offset:8320
    v_mfma_f32_16x16x32_bf16 v[88:91], a[28:31], v[128:131], v[88:91]
    ds_write_b128 v202, v[218:221] offset:12480
    s_waitcnt vmcnt(9)
    v_mfma_f32_16x16x32_bf16 v[32:35], a[16:19], v[132:135], v[32:35]
    v_mfma_f32_16x16x32_bf16 v[52:55], a[20:23], v[132:135], v[52:55]
    buffer_load_dwordx4 v[172:175], v2, s[8:11], s63 offen sc1
    v_mfma_f32_16x16x32_bf16 v[72:75], a[24:27], v[132:135], v[72:75]
    v_mfma_f32_16x16x32_bf16 v[92:95], a[28:31], v[132:135], v[92:95]
    s_waitcnt vmcnt(9)
    v_mfma_f32_16x16x32_bf16 v[16:19], a[32:35], v[136:139], v[16:19]
    v_mov_b32 v204, 0
    v_mov_b32 v205, 0
    v_mfma_f32_16x16x32_bf16 v[36:39], a[36:39], v[136:139], v[36:39]
    buffer_load_dwordx4 v[176:179], v1, s[8:11], s62 offen offset:0 sc1
    v_mfma_f32_16x16x32_bf16 v[56:59], a[40:43], v[136:139], v[56:59]
    s_add_u32 s63, s100, 5
    s_mul_i32 s63, s63, 40960
    v_mfma_f32_16x16x32_bf16 v[76:79], a[44:47], v[136:139], v[76:79]
    v_mov_b32 v206, 0
    v_mov_b32 v207, 0
    s_waitcnt vmcnt(9)
    v_mfma_f32_16x16x32_bf16 v[20:23], a[32:35], v[140:143], v[20:23]
    s_add_u32 s63, s63, s36
    v_mfma_f32_16x16x32_bf16 v[40:43], a[36:39], v[140:143], v[40:43]
    buffer_load_dwordx4 v[96:99], v1, s[8:11], s62 offen offset:1024 sc1
    v_mfma_f32_16x16x32_bf16 v[60:63], a[40:43], v[140:143], v[60:63]
    s_and_b32 s42, s3, 1
    s_mul_i32 s43, s42, 4608
    v_mfma_f32_16x16x32_bf16 v[80:83], a[44:47], v[140:143], v[80:83]
    s_add_u32 s43, s43, 147712
    s_mul_i32 s42, s42, 8320
    s_waitcnt vmcnt(9)
    v_mfma_f32_16x16x32_bf16 v[24:27], a[32:35], v[144:147], v[24:27]
    s_add_u32 s42, s42, 135168
    v_add_u32 v202, s43, v1
    v_mfma_f32_16x16x32_bf16 v[44:47], a[36:39], v[144:147], v[44:47]
    buffer_load_dwordx4 v[100:103], v1, s[8:11], s62 offen offset:2048 sc1
    v_mfma_f32_16x16x32_bf16 v[64:67], a[40:43], v[144:147], v[64:67]
    v_add_u32 v203, s42, v1
    v_mfma_f32_16x16x32_bf16 v[84:87], a[44:47], v[144:147], v[84:87]
    s_waitcnt vmcnt(9)
    v_mfma_f32_16x16x32_bf16 v[28:31], a[32:35], v[148:151], v[28:31]
    v_mfma_f32_16x16x32_bf16 v[48:51], a[36:39], v[148:151], v[48:51]
    buffer_load_dwordx4 v[104:107], v1, s[8:11], s62 offen offset:3072 sc1
    v_mfma_f32_16x16x32_bf16 v[68:71], a[40:43], v[148:151], v[68:71]
    v_mfma_f32_16x16x32_bf16 v[88:91], a[44:47], v[148:151], v[88:91]
    s_mov_b32 exec_hi, 0
    ds_write_b128 v202, v[204:207]
    s_mov_b64 exec, 3
    ds_write_b128 v203, v[204:207]
    ds_write_b128 v203, v[204:207] offset:4160
    s_mov_b64 exec, -1
    s_waitcnt vmcnt(9)
    v_mfma_f32_16x16x32_bf16 v[32:35], a[32:35], v[152:155], v[32:35]
    v_mfma_f32_16x16x32_bf16 v[52:55], a[36:39], v[152:155], v[52:55]
    buffer_load_dwordx4 v[108:111], v2, s[8:11], s62 offen sc1
    v_mfma_f32_16x16x32_bf16 v[72:75], a[40:43], v[152:155], v[72:75]
    v_mfma_f32_16x16x32_bf16 v[92:95], a[44:47], v[152:155], v[92:95]
    s_waitcnt vmcnt(9)
    v_mfma_f32_16x16x32_bf16 v[16:19], a[48:51], v[156:159], v[16:19]
    v_mfma_f32_16x16x32_bf16 v[36:39], a[52:55], v[156:159], v[36:39]
    buffer_load_dwordx4 v[112:115], v1, s[8:11], s63 offen offset:0 sc1
    v_mfma_f32_16x16x32_bf16 v[56:59], a[56:59], v[156:159], v[56:59]
    s_add_u32 s62, s100, 6
    s_mul_i32 s62, s62, 40960
    v_mfma_f32_16x16x32_bf16 v[76:79], a[60:63], v[156:159], v[76:79]
    s_waitcnt vmcnt(9)
    v_mfma_f32_16x16x32_bf16 v[20:23], a[48:51], v[160:163], v[20:23]
    s_add_u32 s62, s62, s36
    v_mfma_f32_16x16x32_bf16 v[40:43], a[52:55], v[160:163], v[40:43]
    buffer_load_dwordx4 v[116:119], v1, s[8:11], s63 offen offset:1024 sc1
    v_mfma_f32_16x16x32_bf16 v[60:63], a[56:59], v[160:163], v[60:63]
    v_mfma_f32_16x16x32_bf16 v[80:83], a[60:63], v[160:163], v[80:83]
    s_waitcnt vmcnt(9)
    v_mfma_f32_16x16x32_bf16 v[24:27], a[48:51], v[164:167], v[24:27]
    s_mov_b32 s4, s84
    s_mov_b32 s5, s85
    v_mfma_f32_16x16x32_bf16 v[44:47], a[52:55], v[164:167], v[44:47]
    buffer_load_dwordx4 v[120:123], v1, s[8:11], s63 offen offset:2048 sc1
    v_mfma_f32_16x16x32_bf16 v[64:67], a[56:59], v[164:167], v[64:67]
    s_mov_b32 s6, 0x600000
    s_mov_b32 s7, 0x20000
    v_mfma_f32_16x16x32_bf16 v[84:87], a[60:63], v[164:167], v[84:87]
    s_waitcnt vmcnt(9)
    v_mfma_f32_16x16x32_bf16 v[28:31], a[48:51], v[168:171], v[28:31]
    v_lshrrev_b32 v208, 3, v0
    v_lshlrev_b32 v3, 12, v208
    v_mfma_f32_16x16x32_bf16 v[48:51], a[52:55], v[168:171], v[48:51]
    buffer_load_dwordx4 v[124:127], v1, s[8:11], s63 offen offset:3072 sc1
    v_mfma_f32_16x16x32_bf16 v[68:71], a[56:59], v[168:171], v[68:71]
    v_lshrrev_b32 v208, 1, v208
    v_bfe_u32 v209, v0, 1, 2
    v_mfma_f32_16x16x32_bf16 v[88:91], a[60:63], v[168:171], v[88:91]
    s_waitcnt vmcnt(9)
    v_mfma_f32_16x16x32_bf16 v[32:35], a[48:51], v[172:175], v[32:35]
    v_xor_b32 v209, v209, v208
    v_lshl_add_u32 v3, v209, 5, v3
    v_mfma_f32_16x16x32_bf16 v[52:55], a[52:55], v[172:175], v[52:55]
    buffer_load_dwordx4 v[128:131], v2, s[8:11], s63 offen sc1
    v_mfma_f32_16x16x32_bf16 v[72:75], a[56:59], v[172:175], v[72:75]
    v_and_b32 v208, 1, v0
    v_lshl_add_u32 v3, v208, 4, v3
    v_mfma_f32_16x16x32_bf16 v[92:95], a[60:63], v[172:175], v[92:95]
    s_waitcnt vmcnt(9)
    v_mfma_f32_16x16x32_bf16 v[16:19], a[64:67], v[176:179], v[16:19]
    v_add_u32 v4, 31744, v3
    v_add_u32 v252, 63488, v3
    v_mfma_f32_16x16x32_bf16 v[36:39], a[68:71], v[176:179], v[36:39]
    buffer_load_dwordx4 v[132:135], v1, s[8:11], s62 offen offset:0 sc1
    v_mfma_f32_16x16x32_bf16 v[56:59], a[72:75], v[176:179], v[56:59]
    s_add_u32 s63, s100, 7
    s_mul_i32 s63, s63, 40960
    v_mfma_f32_16x16x32_bf16 v[76:79], a[76:79], v[176:179], v[76:79]
    v_add_u32 v253, 95232, v3
    s_mul_i32 s34, s3, 1572864
    s_waitcnt vmcnt(9)
    v_mfma_f32_16x16x32_bf16 v[20:23], a[64:67], v[96:99], v[20:23]
    s_add_u32 s63, s63, s36
    v_mfma_f32_16x16x32_bf16 v[40:43], a[68:71], v[96:99], v[40:43]
    buffer_load_dwordx4 v[136:139], v1, s[8:11], s62 offen offset:1024 sc1
    v_mfma_f32_16x16x32_bf16 v[60:63], a[72:75], v[96:99], v[60:63]
    s_lshl_b32 s42, s26, 7
    s_add_u32 s34, s34, s42
    v_mfma_f32_16x16x32_bf16 v[80:83], a[76:79], v[96:99], v[80:83]
    s_waitcnt vmcnt(9)
    v_mfma_f32_16x16x32_bf16 v[24:27], a[64:67], v[100:103], v[24:27]
    v_mfma_f32_16x16x32_bf16 v[44:47], a[68:71], v[100:103], v[44:47]
    buffer_load_dwordx4 v[140:143], v1, s[8:11], s62 offen offset:2048 sc1
    v_mfma_f32_16x16x32_bf16 v[64:67], a[72:75], v[100:103], v[64:67]
    v_mfma_f32_16x16x32_bf16 v[84:87], a[76:79], v[100:103], v[84:87]
    s_waitcnt vmcnt(9)
    v_mfma_f32_16x16x32_bf16 v[28:31], a[64:67], v[104:107], v[28:31]
    v_mfma_f32_16x16x32_bf16 v[48:51], a[68:71], v[104:107], v[48:51]
    buffer_load_dwordx4 v[144:147], v1, s[8:11], s62 offen offset:3072 sc1
    v_mfma_f32_16x16x32_bf16 v[68:71], a[72:75], v[104:107], v[68:71]
    v_mfma_f32_16x16x32_bf16 v[88:91], a[76:79], v[104:107], v[88:91]
    s_waitcnt vmcnt(9)
    v_mfma_f32_16x16x32_bf16 v[32:35], a[64:67], v[108:111], v[32:35]
    v_mfma_f32_16x16x32_bf16 v[52:55], a[68:71], v[108:111], v[52:55]
    buffer_load_dwordx4 v[148:151], v2, s[8:11], s62 offen sc1
    v_mfma_f32_16x16x32_bf16 v[72:75], a[72:75], v[108:111], v[72:75]
    v_mfma_f32_16x16x32_bf16 v[92:95], a[76:79], v[108:111], v[92:95]
    s_waitcnt vmcnt(9)
    v_mfma_f32_16x16x32_bf16 v[16:19], a[80:83], v[112:115], v[16:19]
    v_mfma_f32_16x16x32_bf16 v[36:39], a[84:87], v[112:115], v[36:39]
    buffer_load_dwordx4 v[152:155], v1, s[8:11], s63 offen offset:0 sc1
    v_mfma_f32_16x16x32_bf16 v[56:59], a[88:91], v[112:115], v[56:59]
    s_sub_u32 s62, 8, s100
    s_mul_i32 s62, s62, 40960
    v_mfma_f32_16x16x32_bf16 v[76:79], a[92:95], v[112:115], v[76:79]
    s_waitcnt vmcnt(9)
    v_mfma_f32_16x16x32_bf16 v[20:23], a[80:83], v[116:119], v[20:23]
    s_add_u32 s62, s62, s36
    v_mfma_f32_16x16x32_bf16 v[40:43], a[84:87], v[116:119], v[40:43]
    buffer_load_dwordx4 v[156:159], v1, s[8:11], s63 offen offset:1024 sc1
    v_mfma_f32_16x16x32_bf16 v[60:63], a[88:91], v[116:119], v[60:63]
    v_mfma_f32_16x16x32_bf16 v[80:83], a[92:95], v[116:119], v[80:83]
    s_waitcnt vmcnt(9)
    v_mfma_f32_16x16x32_bf16 v[24:27], a[80:83], v[120:123], v[24:27]
    v_mfma_f32_16x16x32_bf16 v[44:47], a[84:87], v[120:123], v[44:47]
    buffer_load_dwordx4 v[160:163], v1, s[8:11], s63 offen offset:2048 sc1
    v_mfma_f32_16x16x32_bf16 v[64:67], a[88:91], v[120:123], v[64:67]
    v_mfma_f32_16x16x32_bf16 v[84:87], a[92:95], v[120:123], v[84:87]
    s_waitcnt vmcnt(9)
    v_mfma_f32_16x16x32_bf16 v[28:31], a[80:83], v[124:127], v[28:31]
    v_mfma_f32_16x16x32_bf16 v[48:51], a[84:87], v[124:127], v[48:51]
    buffer_load_dwordx4 v[164:167], v1, s[8:11], s63 offen offset:3072 sc1
    v_mfma_f32_16x16x32_bf16 v[68:71], a[88:91], v[124:127], v[68:71]
    v_mfma_f32_16x16x32_bf16 v[88:91], a[92:95], v[124:127], v[88:91]
    s_waitcnt vmcnt(9)
    v_mfma_f32_16x16x32_bf16 v[32:35], a[80:83], v[128:131], v[32:35]
    v_mfma_f32_16x16x32_bf16 v[52:55], a[84:87], v[128:131], v[52:55]
    buffer_load_dwordx4 v[168:171], v2, s[8:11], s63 offen sc1
    v_mfma_f32_16x16x32_bf16 v[72:75], a[88:91], v[128:131], v[72:75]
    v_mfma_f32_16x16x32_bf16 v[92:95], a[92:95], v[128:131], v[92:95]
    s_waitcnt vmcnt(9)
    v_mfma_f32_16x16x32_bf16 v[16:19], a[96:99], v[132:135], v[16:19]
    v_mfma_f32_16x16x32_bf16 v[36:39], a[100:103], v[132:135], v[36:39]
    buffer_load_dwordx4 v[172:175], v1, s[8:11], s62 offen offset:0 sc1
    v_mfma_f32_16x16x32_bf16 v[56:59], a[104:107], v[132:135], v[56:59]
    s_sub_u32 s63, 9, s100
    s_mul_i32 s63, s63, 40960
    v_mfma_f32_16x16x32_bf16 v[76:79], a[108:111], v[132:135], v[76:79]
    s_waitcnt vmcnt(9)
    v_mfma_f32_16x16x32_bf16 v[20:23], a[96:99], v[136:139], v[20:23]
    s_add_u32 s63, s63, s36
    v_mfma_f32_16x16x32_bf16 v[40:43], a[100:103], v[136:139], v[40:43]
    buffer_load_dwordx4 v[176:179], v1, s[8:11], s62 offen offset:1024 sc1
    v_mfma_f32_16x16x32_bf16 v[60:63], a[104:107], v[136:139], v[60:63]
    v_mfma_f32_16x16x32_bf16 v[80:83], a[108:111], v[136:139], v[80:83]
    s_waitcnt vmcnt(9)
    v_mfma_f32_16x16x32_bf16 v[24:27], a[96:99], v[140:143], v[24:27]
    v_mfma_f32_16x16x32_bf16 v[44:47], a[100:103], v[140:143], v[44:47]
    buffer_load_dwordx4 v[96:99], v1, s[8:11], s62 offen offset:2048 sc1
    v_mfma_f32_16x16x32_bf16 v[64:67], a[104:107], v[140:143], v[64:67]
    v_mfma_f32_16x16x32_bf16 v[84:87], a[108:111], v[140:143], v[84:87]
    s_waitcnt vmcnt(9)
    v_mfma_f32_16x16x32_bf16 v[28:31], a[96:99], v[144:147], v[28:31]
    v_mfma_f32_16x16x32_bf16 v[48:51], a[100:103], v[144:147], v[48:51]
    buffer_load_dwordx4 v[100:103], v1, s[8:11], s62 offen offset:3072 sc1
    v_mfma_f32_16x16x32_bf16 v[68:71], a[104:107], v[144:147], v[68:71]
    v_mfma_f32_16x16x32_bf16 v[88:91], a[108:111], v[144:147], v[88:91]
    s_waitcnt vmcnt(9)
    v_mfma_f32_16x16x32_bf16 v[32:35], a[96:99], v[148:151], v[32:35]
    v_mfma_f32_16x16x32_bf16 v[52:55], a[100:103], v[148:151], v[52:55]
    buffer_load_dwordx4 v[104:107], v2, s[8:11], s62 offen sc1
    v_mfma_f32_16x16x32_bf16 v[72:75], a[104:107], v[148:151], v[72:75]
    v_mfma_f32_16x16x32_bf16 v[92:95], a[108:111], v[148:151], v[92:95]
    s_waitcnt vmcnt(9)
    v_mfma_f32_16x16x32_bf16 v[16:19], a[112:115], v[152:155], v[16:19]
    v_mfma_f32_16x16x32_bf16 v[36:39], a[116:119], v[152:155], v[36:39]
    buffer_load_dwordx4 v[108:111], v1, s[8:11], s63 offen offset:0 sc1
    v_mfma_f32_16x16x32_bf16 v[56:59], a[120:123], v[152:155], v[56:59]
    s_sub_u32 s62, 10, s100
    s_mul_i32 s62, s62, 40960
    v_mfma_f32_16x16x32_bf16 v[76:79], a[124:127], v[152:155], v[76:79]
    s_waitcnt vmcnt(9)
    v_mfma_f32_16x16x32_bf16 v[20:23], a[112:115], v[156:159], v[20:23]
    s_add_u32 s62, s62, s36
    v_mfma_f32_16x16x32_bf16 v[40:43], a[116:119], v[156:159], v[40:43]
    buffer_load_dwordx4 v[112:115], v1, s[8:11], s63 offen offset:1024 sc1
    v_mfma_f32_16x16x32_bf16 v[60:63], a[120:123], v[156:159], v[60:63]
    v_mfma_f32_16x16x32_bf16 v[80:83], a[124:127], v[156:159], v[80:83]
    s_waitcnt vmcnt(9)
    v_mfma_f32_16x16x32_bf16 v[24:27], a[112:115], v[160:163], v[24:27]
    v_mfma_f32_16x16x32_bf16 v[44:47], a[116:119], v[160:163], v[44:47]
    buffer_load_dwordx4 v[116:119], v1, s[8:11], s63 offen offset:2048 sc1
    v_mfma_f32_16x16x32_bf16 v[64:67], a[120:123], v[160:163], v[64:67]
    v_mfma_f32_16x16x32_bf16 v[84:87], a[124:127], v[160:163], v[84:87]
    s_waitcnt vmcnt(9)
    v_mfma_f32_16x16x32_bf16 v[28:31], a[112:115], v[164:167], v[28:31]
    v_mfma_f32_16x16x32_bf16 v[48:51], a[116:119], v[164:167], v[48:51]
    buffer_load_dwordx4 v[120:123], v1, s[8:11], s63 offen offset:3072 sc1
    v_mfma_f32_16x16x32_bf16 v[68:71], a[120:123], v[164:167], v[68:71]
    v_mfma_f32_16x16x32_bf16 v[88:91], a[124:127], v[164:167], v[88:91]
    s_waitcnt vmcnt(9)
    v_mfma_f32_16x16x32_bf16 v[32:35], a[112:115], v[168:171], v[32:35]
    v_mfma_f32_16x16x32_bf16 v[52:55], a[116:119], v[168:171], v[52:55]
    buffer_load_dwordx4 v[124:127], v2, s[8:11], s63 offen sc1
    v_mfma_f32_16x16x32_bf16 v[72:75], a[120:123], v[168:171], v[72:75]
    v_mfma_f32_16x16x32_bf16 v[92:95], a[124:127], v[168:171], v[92:95]
    s_waitcnt vmcnt(9)
    v_mfma_f32_16x16x32_bf16 v[16:19], a[128:131], v[172:175], v[16:19]
    v_mfma_f32_16x16x32_bf16 v[36:39], a[132:135], v[172:175], v[36:39]
    buffer_load_dwordx4 v[128:131], v1, s[8:11], s62 offen offset:0 sc1
    v_mfma_f32_16x16x32_bf16 v[56:59], a[136:139], v[172:175], v[56:59]
    s_sub_u32 s63, 11, s100
    s_mul_i32 s63, s63, 40960
    v_mfma_f32_16x16x32_bf16 v[76:79], a[140:143], v[172:175], v[76:79]
    s_waitcnt vmcnt(9)
    v_mfma_f32_16x16x32_bf16 v[20:23], a[128:131], v[176:179], v[20:23]
    s_add_u32 s63, s63, s36
    v_mfma_f32_16x16x32_bf16 v[40:43], a[132:135], v[176:179], v[40:43]
    buffer_load_dwordx4 v[132:135], v1, s[8:11], s62 offen offset:1024 sc1
    v_mfma_f32_16x16x32_bf16 v[60:63], a[136:139], v[176:179], v[60:63]
    v_mfma_f32_16x16x32_bf16 v[80:83], a[140:143], v[176:179], v[80:83]
    s_waitcnt vmcnt(9)
    v_mfma_f32_16x16x32_bf16 v[24:27], a[128:131], v[96:99], v[24:27]
    v_mfma_f32_16x16x32_bf16 v[44:47], a[132:135], v[96:99], v[44:47]
    buffer_load_dwordx4 v[136:139], v1, s[8:11], s62 offen offset:2048 sc1
    v_mfma_f32_16x16x32_bf16 v[64:67], a[136:139], v[96:99], v[64:67]
    v_mfma_f32_16x16x32_bf16 v[84:87], a[140:143], v[96:99], v[84:87]
    s_waitcnt vmcnt(9)
    v_mfma_f32_16x16x32_bf16 v[28:31], a[128:131], v[100:103], v[28:31]
    v_mfma_f32_16x16x32_bf16 v[48:51], a[132:135], v[100:103], v[48:51]
    buffer_load_dwordx4 v[140:143], v1, s[8:11], s62 offen offset:3072 sc1
    v_mfma_f32_16x16x32_bf16 v[68:71], a[136:139], v[100:103], v[68:71]
    v_mfma_f32_16x16x32_bf16 v[88:91], a[140:143], v[100:103], v[88:91]
    s_waitcnt vmcnt(9)
    v_mfma_f32_16x16x32_bf16 v[32:35], a[128:131], v[104:107], v[32:35]
    v_mfma_f32_16x16x32_bf16 v[52:55], a[132:135], v[104:107], v[52:55]
    buffer_load_dwordx4 v[144:147], v2, s[8:11], s62 offen sc1
    v_mfma_f32_16x16x32_bf16 v[72:75], a[136:139], v[104:107], v[72:75]
    v_mfma_f32_16x16x32_bf16 v[92:95], a[140:143], v[104:107], v[92:95]
    s_waitcnt vmcnt(9)
    v_mfma_f32_16x16x32_bf16 v[16:19], a[144:147], v[108:111], v[16:19]
    v_mfma_f32_16x16x32_bf16 v[36:39], a[148:151], v[108:111], v[36:39]
    buffer_load_dwordx4 v[148:151], v1, s[8:11], s63 offen offset:0 sc1
    v_mfma_f32_16x16x32_bf16 v[56:59], a[152:155], v[108:111], v[56:59]
    s_sub_u32 s62, 12, s100
    s_mul_i32 s62, s62, 40960
    v_mfma_f32_16x16x32_bf16 v[76:79], a[156:159], v[108:111], v[76:79]
    s_waitcnt vmcnt(9)
    v_mfma_f32_16x16x32_bf16 v[20:23], a[144:147], v[112:115], v[20:23]
    s_add_u32 s62, s62, s36
    v_mfma_f32_16x16x32_bf16 v[40:43], a[148:151], v[112:115], v[40:43]
    buffer_load_dwordx4 v[152:155], v1, s[8:11], s63 offen offset:1024 sc1
    v_mfma_f32_16x16x32_bf16 v[60:63], a[152:155], v[112:115], v[60:63]
    v_mfma_f32_16x16x32_bf16 v[80:83], a[156:159], v[112:115], v[80:83]
    s_waitcnt vmcnt(9)
    v_mfma_f32_16x16x32_bf16 v[24:27], a[144:147], v[116:119], v[24:27]
    v_mfma_f32_16x16x32_bf16 v[44:47], a[148:151], v[116:119], v[44:47]
    buffer_load_dwordx4 v[156:159], v1, s[8:11], s63 offen offset:2048 sc1
    v_mfma_f32_16x16x32_bf16 v[64:67], a[152:155], v[116:119], v[64:67]
    v_mfma_f32_16x16x32_bf16 v[84:87], a[156:159], v[116:119], v[84:87]
    s_waitcnt vmcnt(9)
    v_mfma_f32_16x16x32_bf16 v[28:31], a[144:147], v[120:123], v[28:31]
    v_mfma_f32_16x16x32_bf16 v[48:51], a[148:151], v[120:123], v[48:51]
    buffer_load_dwordx4 v[160:163], v1, s[8:11], s63 offen offset:3072 sc1
    v_mfma_f32_16x16x32_bf16 v[68:71], a[152:155], v[120:123], v[68:71]
    v_mfma_f32_16x16x32_bf16 v[88:91], a[156:159], v[120:123], v[88:91]
    s_waitcnt vmcnt(9)
    v_mfma_f32_16x16x32_bf16 v[32:35], a[144:147], v[124:127], v[32:35]
    v_mfma_f32_16x16x32_bf16 v[52:55], a[148:151], v[124:127], v[52:55]
    buffer_load_dwordx4 v[164:167], v2, s[8:11], s63 offen sc1
    v_mfma_f32_16x16x32_bf16 v[72:75], a[152:155], v[124:127], v[72:75]
    v_mfma_f32_16x16x32_bf16 v[92:95], a[156:159], v[124:127], v[92:95]
    s_waitcnt vmcnt(9)
    v_mfma_f32_16x16x32_bf16 v[16:19], a[160:163], v[128:131], v[16:19]
    v_mfma_f32_16x16x32_bf16 v[36:39], a[164:167], v[128:131], v[36:39]
    buffer_load_dwordx4 v[168:171], v1, s[8:11], s62 offen offset:0 sc1
    v_mfma_f32_16x16x32_bf16 v[56:59], a[168:171], v[128:131], v[56:59]
    s_sub_u32 s63, 13, s100
    s_mul_i32 s63, s63, 40960
    v_mfma_f32_16x16x32_bf16 v[76:79], a[172:175], v[128:131], v[76:79]
    s_waitcnt vmcnt(9)
    v_mfma_f32_16x16x32_bf16 v[20:23], a[160:163], v[132:135], v[20:23]
    s_add_u32 s63, s63, s36
    v_mfma_f32_16x16x32_bf16 v[40:43], a[164:167], v[132:135], v[40:43]
    buffer_load_dwordx4 v[172:175], v1, s[8:11], s62 offen offset:1024 sc1
    v_mfma_f32_16x16x32_bf16 v[60:63], a[168:171], v[132:135], v[60:63]
    v_mfma_f32_16x16x32_bf16 v[80:83], a[172:175], v[132:135], v[80:83]
    s_waitcnt vmcnt(9)
    v_mfma_f32_16x16x32_bf16 v[24:27], a[160:163], v[136:139], v[24:27]
    v_mfma_f32_16x16x32_bf16 v[44:47], a[164:167], v[136:139], v[44:47]
    buffer_load_dwordx4 v[176:179], v1, s[8:11], s62 offen offset:2048 sc1
    v_mfma_f32_16x16x32_bf16 v[64:67], a[168:171], v[136:139], v[64:67]
    v_mfma_f32_16x16x32_bf16 v[84:87], a[172:175], v[136:139], v[84:87]
    s_waitcnt vmcnt(9)
    v_mfma_f32_16x16x32_bf16 v[28:31], a[160:163], v[140:143], v[28:31]
    v_mfma_f32_16x16x32_bf16 v[48:51], a[164:167], v[140:143], v[48:51]
    buffer_load_dwordx4 v[96:99], v1, s[8:11], s62 offen offset:3072 sc1
    v_mfma_f32_16x16x32_bf16 v[68:71], a[168:171], v[140:143], v[68:71]
    v_mfma_f32_16x16x32_bf16 v[88:91], a[172:175], v[140:143], v[88:91]
    s_waitcnt vmcnt(9)
    v_mfma_f32_16x16x32_bf16 v[32:35], a[160:163], v[144:147], v[32:35]
    v_mfma_f32_16x16x32_bf16 v[52:55], a[164:167], v[144:147], v[52:55]
    buffer_load_dwordx4 v[100:103], v2, s[8:11], s62 offen sc1
    v_mfma_f32_16x16x32_bf16 v[72:75], a[168:171], v[144:147], v[72:75]
    v_mfma_f32_16x16x32_bf16 v[92:95], a[172:175], v[144:147], v[92:95]
    s_waitcnt vmcnt(9)
    v_mfma_f32_16x16x32_bf16 v[16:19], a[176:179], v[148:151], v[16:19]
    v_mfma_f32_16x16x32_bf16 v[36:39], a[180:183], v[148:151], v[36:39]
    buffer_load_dwordx4 v[104:107], v1, s[8:11], s63 offen offset:0 sc1
    v_mfma_f32_16x16x32_bf16 v[56:59], a[184:187], v[148:151], v[56:59]
    s_sub_u32 s62, 14, s100
    s_mul_i32 s62, s62, 40960
    v_mfma_f32_16x16x32_bf16 v[76:79], a[188:191], v[148:151], v[76:79]
    s_waitcnt vmcnt(9)
    v_mfma_f32_16x16x32_bf16 v[20:23], a[176:179], v[152:155], v[20:23]
    s_add_u32 s62, s62, s36
    v_mfma_f32_16x16x32_bf16 v[40:43], a[180:183], v[152:155], v[40:43]
    buffer_load_dwordx4 v[108:111], v1, s[8:11], s63 offen offset:1024 sc1
    v_mfma_f32_16x16x32_bf16 v[60:63], a[184:187], v[152:155], v[60:63]
    v_mfma_f32_16x16x32_bf16 v[80:83], a[188:191], v[152:155], v[80:83]
    s_waitcnt vmcnt(9)
    v_mfma_f32_16x16x32_bf16 v[24:27], a[176:179], v[156:159], v[24:27]
    v_mfma_f32_16x16x32_bf16 v[44:47], a[180:183], v[156:159], v[44:47]
    buffer_load_dwordx4 v[112:115], v1, s[8:11], s63 offen offset:2048 sc1
    v_mfma_f32_16x16x32_bf16 v[64:67], a[184:187], v[156:159], v[64:67]
    v_mfma_f32_16x16x32_bf16 v[84:87], a[188:191], v[156:159], v[84:87]
    s_waitcnt vmcnt(9)
    v_mfma_f32_16x16x32_bf16 v[28:31], a[176:179], v[160:163], v[28:31]
    v_mfma_f32_16x16x32_bf16 v[48:51], a[180:183], v[160:163], v[48:51]
    buffer_load_dwordx4 v[116:119], v1, s[8:11], s63 offen offset:3072 sc1
    v_mfma_f32_16x16x32_bf16 v[68:71], a[184:187], v[160:163], v[68:71]
    v_mfma_f32_16x16x32_bf16 v[88:91], a[188:191], v[160:163], v[88:91]
    s_waitcnt vmcnt(9)
    v_mfma_f32_16x16x32_bf16 v[32:35], a[176:179], v[164:167], v[32:35]
    v_mfma_f32_16x16x32_bf16 v[52:55], a[180:183], v[164:167], v[52:55]
    buffer_load_dwordx4 v[120:123], v2, s[8:11], s63 offen sc1
    v_mfma_f32_16x16x32_bf16 v[72:75], a[184:187], v[164:167], v[72:75]
    v_mfma_f32_16x16x32_bf16 v[92:95], a[188:191], v[164:167], v[92:95]
    s_waitcnt vmcnt(9)
    v_mfma_f32_16x16x32_bf16 v[16:19], a[192:195], v[168:171], v[16:19]
    v_mfma_f32_16x16x32_bf16 v[36:39], a[196:199], v[168:171], v[36:39]
    buffer_load_dwordx4 v[124:127], v1, s[8:11], s62 offen offset:0 sc1
    v_mfma_f32_16x16x32_bf16 v[56:59], a[200:203], v[168:171], v[56:59]
    s_sub_u32 s63, 15, s100
    s_mul_i32 s63, s63, 40960
    v_mfma_f32_16x16x32_bf16 v[76:79], a[204:207], v[168:171], v[76:79]
    s_waitcnt vmcnt(9)
    v_mfma_f32_16x16x32_bf16 v[20:23], a[192:195], v[172:175], v[20:23]
    s_add_u32 s63, s63, s36
    v_mfma_f32_16x16x32_bf16 v[40:43], a[196:199], v[172:175], v[40:43]
    buffer_load_dwordx4 v[128:131], v1, s[8:11], s62 offen offset:1024 sc1
    v_mfma_f32_16x16x32_bf16 v[60:63], a[200:203], v[172:175], v[60:63]
    v_mfma_f32_16x16x32_bf16 v[80:83], a[204:207], v[172:175], v[80:83]
    s_waitcnt vmcnt(9)
    v_mfma_f32_16x16x32_bf16 v[24:27], a[192:195], v[176:179], v[24:27]
    v_mfma_f32_16x16x32_bf16 v[44:47], a[196:199], v[176:179], v[44:47]
    buffer_load_dwordx4 v[132:135], v1, s[8:11], s62 offen offset:2048 sc1
    v_mfma_f32_16x16x32_bf16 v[64:67], a[200:203], v[176:179], v[64:67]
    v_mfma_f32_16x16x32_bf16 v[84:87], a[204:207], v[176:179], v[84:87]
    s_waitcnt vmcnt(9)
    v_mfma_f32_16x16x32_bf16 v[28:31], a[192:195], v[96:99], v[28:31]
    v_mfma_f32_16x16x32_bf16 v[48:51], a[196:199], v[96:99], v[48:51]
    buffer_load_dwordx4 v[136:139], v1, s[8:11], s62 offen offset:3072 sc1
    v_mfma_f32_16x16x32_bf16 v[68:71], a[200:203], v[96:99], v[68:71]
    v_mfma_f32_16x16x32_bf16 v[88:91], a[204:207], v[96:99], v[88:91]
    s_waitcnt vmcnt(9)
    v_mfma_f32_16x16x32_bf16 v[32:35], a[192:195], v[100:103], v[32:35]
    v_mfma_f32_16x16x32_bf16 v[52:55], a[196:199], v[100:103], v[52:55]
    buffer_load_dwordx4 v[140:143], v2, s[8:11], s62 offen sc1
    v_mfma_f32_16x16x32_bf16 v[72:75], a[200:203], v[100:103], v[72:75]
    v_mfma_f32_16x16x32_bf16 v[92:95], a[204:207], v[100:103], v[92:95]
    s_waitcnt vmcnt(9)
    v_mfma_f32_16x16x32_bf16 v[16:19], a[208:211], v[104:107], v[16:19]
    v_mfma_f32_16x16x32_bf16 v[36:39], a[212:215], v[104:107], v[36:39]
    buffer_load_dwordx4 v[144:147], v1, s[8:11], s63 offen offset:0 sc1
    v_mfma_f32_16x16x32_bf16 v[56:59], a[216:219], v[104:107], v[56:59]
    v_mfma_f32_16x16x32_bf16 v[76:79], a[220:223], v[104:107], v[76:79]
    s_waitcnt vmcnt(9)
    v_mfma_f32_16x16x32_bf16 v[20:23], a[208:211], v[108:111], v[20:23]
    v_mfma_f32_16x16x32_bf16 v[40:43], a[212:215], v[108:111], v[40:43]
    buffer_load_dwordx4 v[148:151], v1, s[8:11], s63 offen offset:1024 sc1
    v_mfma_f32_16x16x32_bf16 v[60:63], a[216:219], v[108:111], v[60:63]
    v_mfma_f32_16x16x32_bf16 v[80:83], a[220:223], v[108:111], v[80:83]
    s_waitcnt vmcnt(9)
    v_mfma_f32_16x16x32_bf16 v[24:27], a[208:211], v[112:115], v[24:27]
    v_mfma_f32_16x16x32_bf16 v[44:47], a[212:215], v[112:115], v[44:47]
    buffer_load_dwordx4 v[152:155], v1, s[8:11], s63 offen offset:2048 sc1
    v_mfma_f32_16x16x32_bf16 v[64:67], a[216:219], v[112:115], v[64:67]
    v_mfma_f32_16x16x32_bf16 v[84:87], a[220:223], v[112:115], v[84:87]
    s_waitcnt vmcnt(9)
    v_mfma_f32_16x16x32_bf16 v[28:31], a[208:211], v[116:119], v[28:31]
    v_mfma_f32_16x16x32_bf16 v[48:51], a[212:215], v[116:119], v[48:51]
    buffer_load_dwordx4 v[156:159], v1, s[8:11], s63 offen offset:3072 sc1
    v_mfma_f32_16x16x32_bf16 v[68:71], a[216:219], v[116:119], v[68:71]
    v_mfma_f32_16x16x32_bf16 v[88:91], a[220:223], v[116:119], v[88:91]
    s_waitcnt vmcnt(9)
    v_mfma_f32_16x16x32_bf16 v[32:35], a[208:211], v[120:123], v[32:35]
    v_mfma_f32_16x16x32_bf16 v[52:55], a[212:215], v[120:123], v[52:55]
    buffer_load_dwordx4 v[160:163], v2, s[8:11], s63 offen sc1
    v_mfma_f32_16x16x32_bf16 v[72:75], a[216:219], v[120:123], v[72:75]
    v_mfma_f32_16x16x32_bf16 v[92:95], a[220:223], v[120:123], v[92:95]
    s_waitcnt vmcnt(9)
    v_mfma_f32_16x16x32_bf16 v[16:19], a[224:227], v[124:127], v[16:19]
    v_mfma_f32_16x16x32_bf16 v[36:39], a[228:231], v[124:127], v[36:39]
    v_mfma_f32_16x16x32_bf16 v[56:59], a[232:235], v[124:127], v[56:59]
    v_mfma_f32_16x16x32_bf16 v[76:79], a[236:239], v[124:127], v[76:79]
    s_lshr_b32 s42, s28, 4
    s_lshl_b32 s42, s42, 10
    s_and_b32 s44, s28, 15
    s_lshl_b32 s44, s44, 4
    s_add_u32 s42, s42, s44
    s_mov_b32 s43, 0xa30000
    buffer_load_dwordx4 v[192:195], v232, s[8:11], s42 offen sc1
    s_waitcnt vmcnt(9)
    v_mfma_f32_16x16x32_bf16 v[20:23], a[224:227], v[128:131], v[20:23]
    s_add_u32 s42, s42, 327680
    buffer_load_dwordx4 v[196:199], v232, s[8:11], s42 offen sc1
    v_mfma_f32_16x16x32_bf16 v[40:43], a[228:231], v[128:131], v[40:43]
    v_mfma_f32_16x16x32_bf16 v[60:63], a[232:235], v[128:131], v[60:63]
    v_mfma_f32_16x16x32_bf16 v[80:83], a[236:239], v[128:131], v[80:83]
    s_waitcnt vmcnt(9)
    v_mfma_f32_16x16x32_bf16 v[24:27], a[224:227], v[132:135], v[24:27]
    buffer_load_dwordx4 v[200:203], v231, s[8:11], s43 offen offset:0 sc1
    v_mfma_f32_16x16x32_bf16 v[44:47], a[228:231], v[132:135], v[44:47]
    v_mfma_f32_16x16x32_bf16 v[64:67], a[232:235], v[132:135], v[64:67]
    v_mfma_f32_16x16x32_bf16 v[84:87], a[236:239], v[132:135], v[84:87]
    s_waitcnt vmcnt(9)
    v_mfma_f32_16x16x32_bf16 v[28:31], a[224:227], v[136:139], v[28:31]
    buffer_load_dwordx4 v[204:207], v231, s[8:11], s43 offen offset:16 sc1
    v_mfma_f32_16x16x32_bf16 v[48:51], a[228:231], v[136:139], v[48:51]
    v_mfma_f32_16x16x32_bf16 v[68:71], a[232:235], v[136:139], v[68:71]
    v_mfma_f32_16x16x32_bf16 v[88:91], a[236:239], v[136:139], v[88:91]
    s_waitcnt vmcnt(9)
    v_mfma_f32_16x16x32_bf16 v[32:35], a[224:227], v[140:143], v[32:35]
    s_waitcnt lgkmcnt(0)
    s_barrier
    v_mfma_f32_16x16x32_bf16 v[52:55], a[228:231], v[140:143], v[52:55]
    v_mfma_f32_16x16x32_bf16 v[72:75], a[232:235], v[140:143], v[72:75]
    buffer_load_dwordx4 v[208:211], v231, s[8:11], s43 offen offset:1024 sc1
    v_mfma_f32_16x16x32_bf16 v[92:95], a[236:239], v[140:143], v[92:95]
    s_waitcnt vmcnt(9)
    v_mfma_f32_16x16x32_bf16 v[36:39], a[244:247], v[144:147], v[36:39]
    buffer_load_dwordx4 v[212:215], v231, s[8:11], s43 offen offset:1040 sc1
    s_waitcnt vmcnt(9)
    v_mfma_f32_16x16x32_bf16 v[40:43], a[244:247], v[148:151], v[40:43]
    s_add_u32 m0, s33, 0
    s_add_u32 s54, s101, 0
    s_mul_i32 s54, s54, 131072
    s_add_u32 s54, s54, s34
    buffer_load_dwordx4 v3, s[4:7], s54 offen offset:0  lds
    buffer_load_dwordx4 v4, s[4:7], s54 offen offset:1024  lds
    s_waitcnt vmcnt(10)
    v_mfma_f32_16x16x32_bf16 v[44:47], a[244:247], v[152:155], v[44:47]
    buffer_load_dwordx4 v252, s[4:7], s54 offen offset:2048  lds
    buffer_load_dwordx4 v253, s[4:7], s54 offen offset:3072  lds
    s_waitcnt vmcnt(11)
    v_mfma_f32_16x16x32_bf16 v[48:51], a[244:247], v[156:159], v[48:51]
    s_waitcnt vmcnt(10)
    v_mfma_f32_16x16x32_bf16 v[52:55], a[244:247], v[160:163], v[52:55]
    v_mfma_f32_16x16x32_bf16 v[56:59], a[248:251], v[144:147], v[56:59]
    v_mfma_f32_16x16x32_bf16 v[60:63], a[248:251], v[148:151], v[60:63]
    v_cvt_pk_bf16_f32 v36, v36, v37
    v_cvt_pk_bf16_f32 v37, v38, v39
    v_mfma_f32_16x16x32_bf16 v[64:67], a[248:251], v[152:155], v[64:67]
    v_cvt_pk_bf16_f32 v38, v40, v41
    v_cvt_pk_bf16_f32 v39, v42, v43
    v_mfma_f32_16x16x32_bf16 v[68:71], a[248:251], v[156:159], v[68:71]
    ds_write_b128 v222, v[36:39] offset:0
    v_mfma_f32_16x16x32_bf16 v[72:75], a[248:251], v[160:163], v[72:75]
    v_cvt_pk_bf16_f32 v44, v44, v45
    v_cvt_pk_bf16_f32 v45, v46, v47
    v_mfma_f32_16x16x32_bf16 v[76:79], a[252:255], v[144:147], v[76:79]
    v_mfma_f32_16x16x32_bf16 v[80:83], a[252:255], v[148:151], v[80:83]
    v_cvt_pk_bf16_f32 v46, v48, v49
    v_cvt_pk_bf16_f32 v47, v50, v51
    v_mfma_f32_16x16x32_bf16 v[84:87], a[252:255], v[152:155], v[84:87]
    ds_write_b128 v222, v[44:47] offset:1024
    v_mfma_f32_16x16x32_bf16 v[88:91], a[252:255], v[156:159], v[88:91]
    v_cvt_pk_bf16_f32 v52, v52, v53
    v_cvt_pk_bf16_f32 v53, v54, v55
    v_mfma_f32_16x16x32_bf16 v[92:95], a[252:255], v[160:163], v[92:95]
    ds_write_b64 v222, v[52:53] offset:2048
    v_mfma_f32_16x16x32_bf16 v[16:19], a[240:243], v[144:147], v[16:19]
    v_mfma_f32_16x16x32_bf16 v[20:23], a[240:243], v[148:151], v[20:23]
    v_cvt_pk_bf16_f32 v56, v56, v57
    v_cvt_pk_bf16_f32 v57, v58, v59
    v_mfma_f32_16x16x32_bf16 v[24:27], a[240:243], v[152:155], v[24:27]
    v_cvt_pk_bf16_f32 v58, v60, v61
    v_cvt_pk_bf16_f32 v59, v62, v63
    v_mfma_f32_16x16x32_bf16 v[28:31], a[240:243], v[156:159], v[28:31]
    ds_write_b128 v223, v[56:59] offset:0
    v_mfma_f32_16x16x32_bf16 v[32:35], a[240:243], v[160:163], v[32:35]
    s_nop 0
    v_cvt_pk_bf16_f32 v64, v64, v65
    v_cvt_pk_bf16_f32 v65, v66, v67
    v_cvt_pk_bf16_f32 v66, v68, v69
    v_cvt_pk_bf16_f32 v67, v70, v71
    ds_write_b128 v223, v[64:67] offset:1024
    v_cvt_pk_bf16_f32 v72, v72, v73
    v_cvt_pk_bf16_f32 v73, v74, v75
    ds_write_b64 v223, v[72:73] offset:2048
    v_cvt_pk_bf16_f32 v76, v76, v77
    v_cvt_pk_bf16_f32 v77, v78, v79
    v_cvt_pk_bf16_f32 v78, v80, v81
    v_cvt_pk_bf16_f32 v79, v82, v83
    ds_write_b128 v224, v[76:79] offset:0
    v_cvt_pk_bf16_f32 v84, v84, v85
    v_cvt_pk_bf16_f32 v85, v86, v87
    v_cvt_pk_bf16_f32 v86, v88, v89
    v_cvt_pk_bf16_f32 v87, v90, v91
    ds_write_b128 v224, v[84:87] offset:1024
    v_cvt_pk_bf16_f32 v92, v92, v93
    v_cvt_pk_bf16_f32 v93, v94, v95
    ds_write_b64 v224, v[92:93] offset:2048
    s_waitcnt vmcnt(4)
    v_lshlrev_b32 v156, 16, v192
    v_and_b32 v157, 0xffff0000, v192
    v_pk_mul_f32 v[156:157], v[156:157], v[200:201]
    v_cvt_pk_bf16_f32 v192, v156, v157
    v_lshlrev_b32_e64 v158, 16, v193
    v_and_b32 v159, 0xffff0000, v193
    v_pk_mul_f32 v[158:159], v[158:159], v[202:203]
    v_cvt_pk_bf16_f32 v193, v158, v159
    v_lshlrev_b32_e64 v156, 16, v194
    v_and_b32 v157, 0xffff0000, v194
    v_pk_mul_f32 v[156:157], v[156:157], v[204:205]
    v_cvt_pk_bf16_f32 v194, v156, v157
    v_lshlrev_b32_e64 v158, 16, v195
    v_and_b32 v159, 0xffff0000, v195
    v_pk_mul_f32 v[158:159], v[158:159], v[206:207]
    v_cvt_pk_bf16_f32 v195, v158, v159
    v_lshlrev_b32_e64 v156, 16, v196
    v_and_b32 v157, 0xffff0000, v196
    v_pk_mul_f32 v[156:157], v[156:157], v[208:209]
    v_cvt_pk_bf16_f32 v196, v156, v157
    v_lshlrev_b32_e64 v158, 16, v197
    v_and_b32 v159, 0xffff0000, v197
    v_pk_mul_f32 v[158:159], v[158:159], v[210:211]
    v_cvt_pk_bf16_f32 v197, v158, v159
    v_lshlrev_b32_e64 v156, 16, v198
    v_and_b32 v157, 0xffff0000, v198
    v_pk_mul_f32 v[156:157], v[156:157], v[212:213]
    v_cvt_pk_bf16_f32 v198, v156, v157
    v_lshlrev_b32_e64 v158, 16, v199
    v_and_b32 v159, 0xffff0000, v199
    v_pk_mul_f32 v[158:159], v[158:159], v[214:215]
    v_cvt_pk_bf16_f32 v199, v158, v159
    ds_write_b128 v233, v[192:195] offset:0
    ds_write_b128 v233, v[196:199] offset:512
    s_waitcnt lgkmcnt(0)
    s_barrier
    s_mov_b32 s98, 0x3f80
    s_mov_b32 s99, 0x3f800000
    s_nop 0
    ds_read_b128 v[36:39], v225 offset:0
    ds_read_b128 v[56:59], v225 offset:5120
    ds_read_b128 v[76:79], v225 offset:10240
    ds_read_b128 v[44:47], v225 offset:1024
    ds_read_b128 v[64:67], v225 offset:6144
    ds_read_b128 v[84:87], v225 offset:11264
    ds_read_b64 v[52:53], v225 offset:2048
    ds_read_b64 v[72:73], v225 offset:7168
    ds_read_b64 v[92:93], v225 offset:12288
    s_add_u32 m0, s33, 4096
    s_add_u32 s54, s101, 1
    s_mul_i32 s54, s54, 131072
    s_add_u32 s54, s54, s34
    buffer_load_dwordx4 v3, s[4:7], s54 offen offset:0  lds
    buffer_load_dwordx4 v4, s[4:7], s54 offen offset:1024  lds
    s_waitcnt lgkmcnt(6)
    v_dot2c_f32_bf16 v16, s98, v36
    v_dot2c_f32_bf16 v18, s98, v37
    v_dot2c_f32_bf16 v17, s99, v36
    v_dot2c_f32_bf16 v19, s99, v37
    v_dot2c_f32_bf16 v16, s98, v56
    v_dot2c_f32_bf16 v18, s98, v57
    v_dot2c_f32_bf16 v17, s99, v56
    v_dot2c_f32_bf16 v19, s99, v57
    v_dot2c_f32_bf16 v16, s98, v76
    v_dot2c_f32_bf16 v18, s98, v77
    v_dot2c_f32_bf16 v17, s99, v76
    v_dot2c_f32_bf16 v19, s99, v77
    s_nop 1
    v_pk_mul_f32 v[108:109], v[16:17], v[16:17]
    v_pk_mul_f32 v[110:111], v[18:19], v[18:19]
    buffer_load_dwordx4 v252, s[4:7], s54 offen offset:2048  lds
    buffer_load_dwordx4 v253, s[4:7], s54 offen offset:3072  lds
    v_pk_fma_f32 v[108:109], v[108:109], s[60:61], s[60:61] op_sel:[0,1,0] op_sel_hi:[1,1,0]
    v_pk_fma_f32 v[110:111], v[110:111], s[60:61], s[60:61] op_sel:[0,1,0] op_sel_hi:[1,1,0]
    v_pk_mul_f32 v[108:109], v[108:109], v[16:17]
    v_pk_mul_f32 v[110:111], v[110:111], v[18:19]
    v_exp_f32 v108, v108
    v_exp_f32 v110, v110
    v_exp_f32 v109, v109
    v_exp_f32 v111, v111
    v_pk_add_f32 v[108:109], v[108:109], 1.0 op_sel_hi:[1,0]
    v_pk_add_f32 v[110:111], v[110:111], 1.0 op_sel_hi:[1,0]
    v_rcp_f32 v108, v108
    v_rcp_f32 v110, v110
    v_rcp_f32 v109, v109
    v_rcp_f32 v111, v111
    v_pk_mul_f32 v[16:17], v[16:17], v[108:109]
    s_add_u32 m0, s33, 8192
    s_add_u32 s54, s101, 2
    s_mul_i32 s54, s54, 131072
    s_add_u32 s54, s54, s34
    buffer_load_dwordx4 v3, s[4:7], s54 offen offset:0  lds
    buffer_load_dwordx4 v4, s[4:7], s54 offen offset:1024  lds
    v_pk_mul_f32 v[18:19], v[18:19], v[110:111]
    v_cvt_pk_bf16_f32 v192, v16, v17
    v_cvt_pk_bf16_f32 v193, v18, v19
    s_waitcnt lgkmcnt(6)
    v_dot2c_f32_bf16 v20, s98, v38
    v_dot2c_f32_bf16 v22, s98, v39
    v_dot2c_f32_bf16 v21, s99, v38
    v_dot2c_f32_bf16 v23, s99, v39
    v_dot2c_f32_bf16 v20, s98, v58
    v_dot2c_f32_bf16 v22, s98, v59
    v_dot2c_f32_bf16 v21, s99, v58
    v_dot2c_f32_bf16 v23, s99, v59
    v_dot2c_f32_bf16 v20, s98, v78
    v_dot2c_f32_bf16 v22, s98, v79
    v_dot2c_f32_bf16 v21, s99, v78
    buffer_load_dwordx4 v252, s[4:7], s54 offen offset:2048  lds
    buffer_load_dwordx4 v253, s[4:7], s54 offen offset:3072  lds
    v_dot2c_f32_bf16 v23, s99, v79
    v_pk_mul_f32 v[108:109], v[20:21], v[20:21]
    s_nop 1
    v_pk_mul_f32 v[110:111], v[22:23], v[22:23]
    v_pk_fma_f32 v[108:109], v[108:109], s[60:61], s[60:61] op_sel:[0,1,0] op_sel_hi:[1,1,0]
    v_pk_fma_f32 v[110:111], v[110:111], s[60:61], s[60:61] op_sel:[0,1,0] op_sel_hi:[1,1,0]
    v_pk_mul_f32 v[108:109], v[108:109], v[20:21]
    v_pk_mul_f32 v[110:111], v[110:111], v[22:23]
    v_exp_f32 v108, v108
    v_exp_f32 v110, v110
    v_exp_f32 v109, v109
    v_exp_f32 v111, v111
    v_pk_add_f32 v[108:109], v[108:109], 1.0 op_sel_hi:[1,0]
    v_pk_add_f32 v[110:111], v[110:111], 1.0 op_sel_hi:[1,0]
    v_rcp_f32 v108, v108
    v_rcp_f32 v110, v110
    s_add_u32 m0, s33, 12288
    s_add_u32 s54, s101, 3
    s_mul_i32 s54, s54, 131072
    s_add_u32 s54, s54, s34
    buffer_load_dwordx4 v3, s[4:7], s54 offen offset:0  lds
    buffer_load_dwordx4 v4, s[4:7], s54 offen offset:1024  lds
    v_rcp_f32 v109, v109
    v_rcp_f32 v111, v111
    v_pk_mul_f32 v[20:21], v[20:21], v[108:109]
    v_pk_mul_f32 v[22:23], v[22:23], v[110:111]
    v_cvt_pk_bf16_f32 v194, v20, v21
    v_cvt_pk_bf16_f32 v195, v22, v23
    s_nop 0
    v_permlane32_swap_b32 v192, v194
    v_permlane32_swap_b32 v193, v195
    s_waitcnt lgkmcnt(3)
    v_dot2c_f32_bf16 v24, s98, v44
    v_dot2c_f32_bf16 v26, s98, v45
    v_dot2c_f32_bf16 v25, s99, v44
    v_dot2c_f32_bf16 v27, s99, v45
    v_dot2c_f32_bf16 v24, s98, v64
    v_dot2c_f32_bf16 v26, s98, v65
    buffer_load_dwordx4 v252, s[4:7], s54 offen offset:2048  lds
    buffer_load_dwordx4 v253, s[4:7], s54 offen offset:3072  lds
    v_dot2c_f32_bf16 v25, s99, v64
    v_dot2c_f32_bf16 v27, s99, v65
    v_dot2c_f32_bf16 v24, s98, v84
    v_dot2c_f32_bf16 v26, s98, v85
    v_dot2c_f32_bf16 v25, s99, v84
    v_dot2c_f32_bf16 v27, s99, v85
    s_nop 1
    s_nop 0
    v_pk_mul_f32 v[108:109], v[24:25], v[24:25]
    v_pk_mul_f32 v[110:111], v[26:27], v[26:27]
    v_pk_fma_f32 v[108:109], v[108:109], s[60:61], s[60:61] op_sel:[0,1,0] op_sel_hi:[1,1,0]
    v_pk_fma_f32 v[110:111], v[110:111], s[60:61], s[60:61] op_sel:[0,1,0] op_sel_hi:[1,1,0]
    v_pk_mul_f32 v[108:109], v[108:109], v[24:25]
    v_pk_mul_f32 v[110:111], v[110:111], v[26:27]
    v_exp_f32 v108, v108
    v_exp_f32 v110, v110
    v_exp_f32 v109, v109
    v_exp_f32 v111, v111
    v_pk_add_f32 v[108:109], v[108:109], 1.0 op_sel_hi:[1,0]
    v_pk_add_f32 v[110:111], v[110:111], 1.0 op_sel_hi:[1,0]
    v_rcp_f32 v108, v108
    v_rcp_f32 v110, v110
    v_rcp_f32 v109, v109
    v_rcp_f32 v111, v111
    v_pk_mul_f32 v[24:25], v[24:25], v[108:109]
    v_pk_mul_f32 v[26:27], v[26:27], v[110:111]
    v_cvt_pk_bf16_f32 v196, v24, v25
    v_cvt_pk_bf16_f32 v197, v26, v27
    s_waitcnt lgkmcnt(3)
    v_dot2c_f32_bf16 v28, s98, v46
    v_dot2c_f32_bf16 v30, s98, v47
    v_dot2c_f32_bf16 v29, s99, v46
    v_dot2c_f32_bf16 v31, s99, v47
    v_dot2c_f32_bf16 v28, s98, v66
    v_dot2c_f32_bf16 v30, s98, v67
    v_dot2c_f32_bf16 v29, s99, v66
    v_dot2c_f32_bf16 v31, s99, v67
    v_dot2c_f32_bf16 v28, s98, v86
    v_dot2c_f32_bf16 v30, s98, v87
    v_dot2c_f32_bf16 v29, s99, v86
    v_dot2c_f32_bf16 v31, s99, v87
    s_nop 1
    v_pk_mul_f32 v[108:109], v[28:29], v[28:29]
    v_pk_mul_f32 v[110:111], v[30:31], v[30:31]
    v_pk_fma_f32 v[108:109], v[108:109], s[60:61], s[60:61] op_sel:[0,1,0] op_sel_hi:[1,1,0]
    v_pk_fma_f32 v[110:111], v[110:111], s[60:61], s[60:61] op_sel:[0,1,0] op_sel_hi:[1,1,0]
    v_pk_mul_f32 v[108:109], v[108:109], v[28:29]
    v_pk_mul_f32 v[110:111], v[110:111], v[30:31]
    v_exp_f32 v108, v108
    v_exp_f32 v110, v110
    v_exp_f32 v109, v109
    v_exp_f32 v111, v111
    v_pk_add_f32 v[108:109], v[108:109], 1.0 op_sel_hi:[1,0]
    v_pk_add_f32 v[110:111], v[110:111], 1.0 op_sel_hi:[1,0]
    v_rcp_f32 v108, v108
    v_rcp_f32 v110, v110
    v_rcp_f32 v109, v109
    v_rcp_f32 v111, v111
    v_pk_mul_f32 v[28:29], v[28:29], v[108:109]
    v_pk_mul_f32 v[30:31], v[30:31], v[110:111]
    v_cvt_pk_bf16_f32 v198, v28, v29
    v_cvt_pk_bf16_f32 v199, v30, v31
    s_nop 0
    v_permlane32_swap_b32 v196, v198
    v_permlane32_swap_b32 v197, v199
    s_waitcnt lgkmcnt(0)
    v_dot2c_f32_bf16 v32, s98, v52
    v_dot2c_f32_bf16 v34, s98, v53
    v_dot2c_f32_bf16 v33, s99, v52
    v_dot2c_f32_bf16 v35, s99, v53
    v_dot2c_f32_bf16 v32, s98, v72
    v_dot2c_f32_bf16 v34, s98, v73
    v_dot2c_f32_bf16 v33, s99, v72
    v_dot2c_f32_bf16 v35, s99, v73
    v_dot2c_f32_bf16 v32, s98, v92
    v_dot2c_f32_bf16 v34, s98, v93
    v_dot2c_f32_bf16 v33, s99, v92
    v_dot2c_f32_bf16 v35, s99, v93
    s_nop 1
    s_nop 0
    v_pk_mul_f32 v[108:109], v[32:33], v[32:33]
    v_pk_mul_f32 v[110:111], v[34:35], v[34:35]
    v_pk_fma_f32 v[108:109], v[108:109], s[60:61], s[60:61] op_sel:[0,1,0] op_sel_hi:[1,1,0]
    v_pk_fma_f32 v[110:111], v[110:111], s[60:61], s[60:61] op_sel:[0,1,0] op_sel_hi:[1,1,0]
    v_pk_mul_f32 v[108:109], v[108:109], v[32:33]
    v_pk_mul_f32 v[110:111], v[110:111], v[34:35]
    v_exp_f32 v108, v108
    v_exp_f32 v110, v110
    v_exp_f32 v109, v109
    v_exp_f32 v111, v111
    v_pk_add_f32 v[108:109], v[108:109], 1.0 op_sel_hi:[1,0]
    v_pk_add_f32 v[110:111], v[110:111], 1.0 op_sel_hi:[1,0]
    v_rcp_f32 v108, v108
    v_rcp_f32 v110, v110
    v_rcp_f32 v109, v109
    v_rcp_f32 v111, v111
    v_pk_mul_f32 v[32:33], v[32:33], v[108:109]
    v_pk_mul_f32 v[34:35], v[34:35], v[110:111]
    v_cvt_pk_bf16_f32 v200, v32, v33
    v_cvt_pk_bf16_f32 v201, v34, v35
    s_nop 0
    v_permlane32_swap_b32 v200, v202
    v_permlane32_swap_b32 v201, v203
    buffer_store_dwordx4 v[192:195], v230, s[8:11], s46 offen offset:0 sc1
    buffer_store_dwordx4 v[196:199], v230, s[8:11], s46 offen offset:2048 sc1
    s_mov_b32 exec_hi, 0
    buffer_store_dwordx4 v[200:203], v230, s[8:11], s47 offen sc1
    s_mov_b64 exec, -1
    buffer_load_dwordx4 v[180:183], v246, s[12:15], s39 offen offset:0
    buffer_load_dwordx4 v[184:187], v246, s[12:15], s39 offen offset:64
    buffer_load_dwordx2 v[188:189], v249, s[12:15], s39 offen offset:128
    global_load_ushort v190, v247, s[86:87]
    s_waitcnt vmcnt(19)
    ds_read_b64_tr_b16 a[0:1], v10 offset:0
    ds_read_b64_tr_b16 a[2:3], v10 offset:1024
    ds_read_b64_tr_b16 a[4:5], v11 offset:0
    ds_read_b64_tr_b16 a[6:7], v11 offset:1024
    ds_read_b64_tr_b16 a[8:9], v12 offset:0
    ds_read_b64_tr_b16 a[10:11], v12 offset:1024
    ds_read_b64_tr_b16 a[12:13], v13 offset:0
    ds_read_b64_tr_b16 a[14:15], v13 offset:1024
    s_waitcnt vmcnt(15)
    s_nop 0
    ds_read_b64_tr_b16 a[16:17], v10 offset:4096
    ds_read_b64_tr_b16 a[18:19], v10 offset:5120
    ds_read_b64_tr_b16 a[20:21], v11 offset:4096
    ds_read_b64_tr_b16 a[22:23], v11 offset:5120
    ds_read_b64_tr_b16 a[24:25], v12 offset:4096
    ds_read_b64_tr_b16 a[26:27], v12 offset:5120
    ds_read_b64_tr_b16 a[28:29], v13 offset:4096
    ds_read_b64_tr_b16 a[30:31], v13 offset:5120
    s_waitcnt vmcnt(11)
    s_nop 0
    ds_read_b64_tr_b16 a[32:33], v10 offset:8192
    ds_read_b64_tr_b16 a[34:35], v10 offset:9216
    ds_read_b64_tr_b16 a[36:37], v11 offset:8192
    ds_read_b64_tr_b16 a[38:39], v11 offset:9216
    ds_read_b64_tr_b16 a[40:41], v12 offset:8192
    ds_read_b64_tr_b16 a[42:43], v12 offset:9216
    ds_read_b64_tr_b16 a[44:45], v13 offset:8192
    ds_read_b64_tr_b16 a[46:47], v13 offset:9216
    s_waitcnt vmcnt(7)
    s_nop 0
    ds_read_b64_tr_b16 a[48:49], v10 offset:12288
    ds_read_b64_tr_b16 a[50:51], v10 offset:13312
    ds_read_b64_tr_b16 a[52:53], v11 offset:12288
    ds_read_b64_tr_b16 a[54:55], v11 offset:13312
    ds_read_b64_tr_b16 a[56:57], v12 offset:12288
    ds_read_b64_tr_b16 a[58:59], v12 offset:13312
    ds_read_b64_tr_b16 a[60:61], v13 offset:12288
    ds_read_b64_tr_b16 a[62:63], v13 offset:13312
    ds_read2_b32 v[48:49], v235 offset0:176 offset1:177
    ds_read2_b32 v[50:51], v235 offset0:178 offset1:179
    ds_read_b128 v[80:83], v239 offset:192
    ds_read2_b32 v[52:53], v235 offset0:48 offset1:49
    ds_read2_b32 v[54:55], v235 offset0:50 offset1:51
    ds_read_b128 v[84:87], v239 offset:704
    ds_read2_b32 v[56:57], v236 offset0:176 offset1:177
    ds_read2_b32 v[58:59], v236 offset0:178 offset1:179
    ds_read_b128 v[88:91], v239 offset:1216
    ds_read2_b32 v[60:61], v236 offset0:48 offset1:49
    ds_read2_b32 v[62:63], v236 offset0:50 offset1:51
    ds_read_b128 v[92:95], v239 offset:1728
    ds_read2_b32 v[64:65], v237 offset0:176 offset1:177
    ds_read2_b32 v[66:67], v237 offset0:178 offset1:179
    ds_read_b128 v[96:99], v239 offset:2240
    ds_read2_b32 v[68:69], v237 offset0:48 offset1:49
    ds_read2_b32 v[70:71], v237 offset0:50 offset1:51
    ds_read_b128 v[100:103], v239 offset:2752
    ds_read2_b32 v[72:73], v238 offset0:176 offset1:177
    ds_read2_b32 v[74:75], v238 offset0:178 offset1:179
    ds_read_b128 v[104:107], v239 offset:3264
    ds_read2_b32 v[76:77], v238 offset0:48 offset1:49
    ds_read2_b32 v[78:79], v238 offset0:50 offset1:51
    ds_read_b128 v[108:111], v239 offset:3776
    s_waitcnt lgkmcnt(0)
    v_mfma_f32_16x16x32_bf16 v[16:19], v[48:51], v[80:83], 0
    ds_read2_b32 v[112:113], v235 offset0:160 offset1:161
    v_mfma_f32_16x16x32_bf16 v[20:23], v[48:51], v[84:87], 0
    ds_read2_b32 v[114:115], v235 offset0:162 offset1:163
    v_mfma_f32_16x16x32_bf16 v[24:27], v[48:51], v[88:91], 0
    ds_read_b128 v[144:147], v239 offset:128
    v_mfma_f32_16x16x32_bf16 v[28:31], v[48:51], v[92:95], 0
    ds_read2_b32 v[116:117], v235 offset0:32 offset1:33
    v_mfma_f32_16x16x32_bf16 v[32:35], v[48:51], v[96:99], 0
    ds_read2_b32 v[118:119], v235 offset0:34 offset1:35
    v_mfma_f32_16x16x32_bf16 v[36:39], v[48:51], v[100:103], 0
    ds_read_b128 v[148:151], v239 offset:640
    v_mfma_f32_16x16x32_bf16 v[40:43], v[48:51], v[104:107], 0
    ds_read2_b32 v[120:121], v236 offset0:160 offset1:161
    v_mfma_f32_16x16x32_bf16 v[44:47], v[48:51], v[108:111], 0
    ds_read2_b32 v[122:123], v236 offset0:162 offset1:163
    v_mfma_f32_16x16x32_bf16 v[20:23], v[52:55], v[80:83], v[20:23]
    ds_read_b128 v[152:155], v239 offset:1152
    v_mfma_f32_16x16x32_bf16 v[24:27], v[52:55], v[84:87], v[24:27]
    ds_read2_b32 v[124:125], v236 offset0:32 offset1:33
    v_mfma_f32_16x16x32_bf16 v[28:31], v[52:55], v[88:91], v[28:31]
    ds_read2_b32 v[126:127], v236 offset0:34 offset1:35
    v_mfma_f32_16x16x32_bf16 v[32:35], v[52:55], v[92:95], v[32:35]
    ds_read_b128 v[156:159], v239 offset:1664
    v_mfma_f32_16x16x32_bf16 v[36:39], v[52:55], v[96:99], v[36:39]
    ds_read2_b32 v[128:129], v237 offset0:160 offset1:161
    v_mfma_f32_16x16x32_bf16 v[40:43], v[52:55], v[100:103], v[40:43]
    ds_read2_b32 v[130:131], v237 offset0:162 offset1:163
    v_mfma_f32_16x16x32_bf16 v[44:47], v[52:55], v[104:107], v[44:47]
    ds_read_b128 v[160:163], v239 offset:2176
    v_mfma_f32_16x16x32_bf16 v[24:27], v[56:59], v[80:83], v[24:27]
    ds_read2_b32 v[132:133], v237 offset0:32 offset1:33
    v_mfma_f32_16x16x32_bf16 v[28:31], v[56:59], v[84:87], v[28:31]
    ds_read2_b32 v[134:135], v237 offset0:34 offset1:35
    v_mfma_f32_16x16x32_bf16 v[32:35], v[56:59], v[88:91], v[32:35]
    ds_read_b128 v[164:167], v239 offset:2688
    v_mfma_f32_16x16x32_bf16 v[36:39], v[56:59], v[92:95], v[36:39]
    ds_read2_b32 v[136:137], v238 offset0:160 offset1:161
    v_mfma_f32_16x16x32_bf16 v[40:43], v[56:59], v[96:99], v[40:43]
    ds_read2_b32 v[138:139], v238 offset0:162 offset1:163
    v_mfma_f32_16x16x32_bf16 v[44:47], v[56:59], v[100:103], v[44:47]
    ds_read_b128 v[168:171], v239 offset:3200
    v_mfma_f32_16x16x32_bf16 v[28:31], v[60:63], v[80:83], v[28:31]
    ds_read2_b32 v[140:141], v238 offset0:32 offset1:33
    v_mfma_f32_16x16x32_bf16 v[32:35], v[60:63], v[84:87], v[32:35]
    ds_read2_b32 v[142:143], v238 offset0:34 offset1:35
    v_mfma_f32_16x16x32_bf16 v[36:39], v[60:63], v[88:91], v[36:39]
    ds_read_b128 v[172:175], v239 offset:3712
    v_mfma_f32_16x16x32_bf16 v[40:43], v[60:63], v[92:95], v[40:43]
    v_mfma_f32_16x16x32_bf16 v[44:47], v[60:63], v[96:99], v[44:47]
    v_mfma_f32_16x16x32_bf16 v[32:35], v[64:67], v[80:83], v[32:35]
    v_mfma_f32_16x16x32_bf16 v[36:39], v[64:67], v[84:87], v[36:39]
    v_mfma_f32_16x16x32_bf16 v[40:43], v[64:67], v[88:91], v[40:43]
    v_mfma_f32_16x16x32_bf16 v[44:47], v[64:67], v[92:95], v[44:47]
    v_mfma_f32_16x16x32_bf16 v[36:39], v[68:71], v[80:83], v[36:39]
    v_mfma_f32_16x16x32_bf16 v[40:43], v[68:71], v[84:87], v[40:43]
    v_mfma_f32_16x16x32_bf16 v[44:47], v[68:71], v[88:91], v[44:47]
    v_mfma_f32_16x16x32_bf16 v[40:43], v[72:75], v[80:83], v[40:43]
    v_mfma_f32_16x16x32_bf16 v[44:47], v[72:75], v[84:87], v[44:47]
    v_mfma_f32_16x16x32_bf16 v[44:47], v[76:79], v[80:83], v[44:47]
    s_waitcnt vmcnt(4)
    s_barrier
    s_cmp_eq_u32 s3, 0
    s_cbranch_scc0 L_nf2
    s_mov_b64 exec, 1
    v_mov_b32 v242, s30
    v_mov_b32 v243, s31
    v_mov_b32 v244, 0
    buffer_store_dwordx2 v[242:243], v244, s[8:11], s48 offen sc1
    s_mov_b64 exec, -1
L_nf2:
    s_waitcnt lgkmcnt(0)
    v_mfma_f32_16x16x32_bf16 v[16:19], v[112:115], v[144:147], v[16:19]
    s_add_u32 m0, s32, 0
    s_add_u32 s54, s101, 4
    s_mul_i32 s54, s54, 131072
    s_add_u32 s54, s54, s34
    buffer_load_dwordx4 v3, s[4:7], s54 offen offset:0  lds
    buffer_load_dwordx4 v4, s[4:7], s54 offen offset:1024  lds
    ds_read2_b32 v[48:49], v235 offset0:144 offset1:145
    v_mfma_f32_16x16x32_bf16 v[20:23], v[112:115], v[148:151], v[20:23]
    ds_read2_b32 v[50:51], v235 offset0:146 offset1:147
    v_mfma_f32_16x16x32_bf16 v[24:27], v[112:115], v[152:155], v[24:27]
    ds_read_b128 v[80:83], v239 offset:64
    v_mfma_f32_16x16x32_bf16 v[28:31], v[112:115], v[156:159], v[28:31]
    ds_read2_b32 v[52:53], v235 offset0:16 offset1:17
    v_mfma_f32_16x16x32_bf16 v[32:35], v[112:115], v[160:163], v[32:35]
    ds_read2_b32 v[54:55], v235 offset0:18 offset1:19
    v_mfma_f32_16x16x32_bf16 v[36:39], v[112:115], v[164:167], v[36:39]
    ds_read_b128 v[84:87], v239 offset:576
    buffer_load_dwordx4 v252, s[4:7], s54 offen offset:2048  lds
    buffer_load_dwordx4 v253, s[4:7], s54 offen offset:3072  lds
    v_mfma_f32_16x16x32_bf16 v[40:43], v[112:115], v[168:171], v[40:43]
    ds_read2_b32 v[56:57], v236 offset0:144 offset1:145
    v_mfma_f32_16x16x32_bf16 v[44:47], v[112:115], v[172:175], v[44:47]
    ds_read2_b32 v[58:59], v236 offset0:146 offset1:147
    v_mfma_f32_16x16x32_bf16 v[20:23], v[116:119], v[144:147], v[20:23]
    ds_read_b128 v[88:91], v239 offset:1088
    v_mfma_f32_16x16x32_bf16 v[24:27], v[116:119], v[148:151], v[24:27]
    ds_read2_b32 v[60:61], v236 offset0:16 offset1:17
    v_mfma_f32_16x16x32_bf16 v[28:31], v[116:119], v[152:155], v[28:31]
    ds_read2_b32 v[62:63], v236 offset0:18 offset1:19
    v_mfma_f32_16x16x32_bf16 v[32:35], v[116:119], v[156:159], v[32:35]
    ds_read_b128 v[92:95], v239 offset:1600
    s_add_u32 m0, s32, 4096
    s_add_u32 s54, s101, 5
    s_mul_i32 s54, s54, 131072
    s_add_u32 s54, s54, s34
    buffer_load_dwordx4 v3, s[4:7], s54 offen offset:0  lds
    buffer_load_dwordx4 v4, s[4:7], s54 offen offset:1024  lds
    v_mfma_f32_16x16x32_bf16 v[36:39], v[116:119], v[160:163], v[36:39]
    ds_read2_b32 v[64:65], v237 offset0:144 offset1:145
    v_mfma_f32_16x16x32_bf16 v[40:43], v[116:119], v[164:167], v[40:43]
    ds_read2_b32 v[66:67], v237 offset0:146 offset1:147
    v_mfma_f32_16x16x32_bf16 v[44:47], v[116:119], v[168:171], v[44:47]
    ds_read_b128 v[96:99], v239 offset:2112
    v_mfma_f32_16x16x32_bf16 v[24:27], v[120:123], v[144:147], v[24:27]
    ds_read2_b32 v[68:69], v237 offset0:16 offset1:17
    v_mfma_f32_16x16x32_bf16 v[28:31], v[120:123], v[148:151], v[28:31]
    ds_read2_b32 v[70:71], v237 offset0:18 offset1:19
    v_mfma_f32_16x16x32_bf16 v[32:35], v[120:123], v[152:155], v[32:35]
    ds_read_b128 v[100:103], v239 offset:2624
    buffer_load_dwordx4 v252, s[4:7], s54 offen offset:2048  lds
    buffer_load_dwordx4 v253, s[4:7], s54 offen offset:3072  lds
    v_mfma_f32_16x16x32_bf16 v[36:39], v[120:123], v[156:159], v[36:39]
    ds_read2_b32 v[72:73], v238 offset0:144 offset1:145
    v_mfma_f32_16x16x32_bf16 v[40:43], v[120:123], v[160:163], v[40:43]
    ds_read2_b32 v[74:75], v238 offset0:146 offset1:147
    v_mfma_f32_16x16x32_bf16 v[44:47], v[120:123], v[164:167], v[44:47]
    ds_read_b128 v[104:107], v239 offset:3136
    v_mfma_f32_16x16x32_bf16 v[28:31], v[124:127], v[144:147], v[28:31]
    ds_read2_b32 v[76:77], v238 offset0:16 offset1:17
    v_mfma_f32_16x16x32_bf16 v[32:35], v[124:127], v[148:151], v[32:35]
    ds_read2_b32 v[78:79], v238 offset0:18 offset1:19
    v_mfma_f32_16x16x32_bf16 v[36:39], v[124:127], v[152:155], v[36:39]
    ds_read_b128 v[108:111], v239 offset:3648
    s_add_u32 m0, s32, 8192
    s_sub_u32 s54, 6, s101
    s_mul_i32 s54, s54, 131072
    s_add_u32 s54, s54, s34
    buffer_load_dwordx4 v3, s[4:7], s54 offen offset:0  lds
    buffer_load_dwordx4 v4, s[4:7], s54 offen offset:1024  lds
    v_mfma_f32_16x16x32_bf16 v[40:43], v[124:127], v[156:159], v[40:43]
    v_mfma_f32_16x16x32_bf16 v[44:47], v[124:127], v[160:163], v[44:47]
    v_mfma_f32_16x16x32_bf16 v[32:35], v[128:131], v[144:147], v[32:35]
    v_mfma_f32_16x16x32_bf16 v[36:39], v[128:131], v[148:151], v[36:39]
    v_mfma_f32_16x16x32_bf16 v[40:43], v[128:131], v[152:155], v[40:43]
    v_mfma_f32_16x16x32_bf16 v[44:47], v[128:131], v[156:159], v[44:47]
    v_mfma_f32_16x16x32_bf16 v[36:39], v[132:135], v[144:147], v[36:39]
    v_mfma_f32_16x16x32_bf16 v[40:43], v[132:135], v[148:151], v[40:43]
    v_mfma_f32_16x16x32_bf16 v[44:47], v[132:135], v[152:155], v[44:47]
    v_mfma_f32_16x16x32_bf16 v[40:43], v[136:139], v[144:147], v[40:43]
    v_mfma_f32_16x16x32_bf16 v[44:47], v[136:139], v[148:151], v[44:47]
    v_mfma_f32_16x16x32_bf16 v[44:47], v[140:143], v[144:147], v[44:47]
    s_waitcnt lgkmcnt(0)
    v_mfma_f32_16x16x32_bf16 v[16:19], v[48:51], v[80:83], v[16:19]
    buffer_load_dwordx4 v252, s[4:7], s54 offen offset:2048  lds
    buffer_load_dwordx4 v253, s[4:7], s54 offen offset:3072  lds
    ds_read2_b32 v[112:113], v235 offset0:128 offset1:129
    v_mfma_f32_16x16x32_bf16 v[20:23], v[48:51], v[84:87], v[20:23]
    ds_read2_b32 v[114:115], v235 offset0:130 offset1:131
    v_mfma_f32_16x16x32_bf16 v[24:27], v[48:51], v[88:91], v[24:27]
    ds_read_b128 v[144:147], v239 offset:0
    v_mfma_f32_16x16x32_bf16 v[28:31], v[48:51], v[92:95], v[28:31]
    ds_read2_b32 v[116:117], v235 offset0:0 offset1:1
    v_mfma_f32_16x16x32_bf16 v[32:35], v[48:51], v[96:99], v[32:35]
    ds_read2_b32 v[118:119], v235 offset0:2 offset1:3
    v_mfma_f32_16x16x32_bf16 v[36:39], v[48:51], v[100:103], v[36:39]
    ds_read_b128 v[148:151], v239 offset:512
    s_add_u32 m0, s32, 12288
    s_sub_u32 s54, 7, s101
    s_mul_i32 s54, s54, 131072
    s_add_u32 s54, s54, s34
    buffer_load_dwordx4 v3, s[4:7], s54 offen offset:0  lds
    buffer_load_dwordx4 v4, s[4:7], s54 offen offset:1024  lds
    v_mfma_f32_16x16x32_bf16 v[40:43], v[48:51], v[104:107], v[40:43]
    ds_read2_b32 v[120:121], v236 offset0:128 offset1:129
    v_mfma_f32_16x16x32_bf16 v[44:47], v[48:51], v[108:111], v[44:47]
    ds_read2_b32 v[122:123], v236 offset0:130 offset1:131
    v_mfma_f32_16x16x32_bf16 v[20:23], v[52:55], v[80:83], v[20:23]
    ds_read_b128 v[152:155], v239 offset:1024
    v_mfma_f32_16x16x32_bf16 v[24:27], v[52:55], v[84:87], v[24:27]
    ds_read2_b32 v[124:125], v236 offset0:0 offset1:1
    v_mfma_f32_16x16x32_bf16 v[28:31], v[52:55], v[88:91], v[28:31]
    ds_read2_b32 v[126:127], v236 offset0:2 offset1:3
    v_mfma_f32_16x16x32_bf16 v[32:35], v[52:55], v[92:95], v[32:35]
    ds_read_b128 v[156:159], v239 offset:1536
    buffer_load_dwordx4 v252, s[4:7], s54 offen offset:2048  lds
    buffer_load_dwordx4 v253, s[4:7], s54 offen offset:3072  lds
    v_mfma_f32_16x16x32_bf16 v[36:39], v[52:55], v[96:99], v[36:39]
    ds_read2_b32 v[128:129], v237 offset0:128 offset1:129
    v_mfma_f32_16x16x32_bf16 v[40:43], v[52:55], v[100:103], v[40:43]
    ds_read2_b32 v[130:131], v237 offset0:130 offset1:131
    v_mfma_f32_16x16x32_bf16 v[44:47], v[52:55], v[104:107], v[44:47]
    ds_read_b128 v[160:163], v239 offset:2048
    v_mfma_f32_16x16x32_bf16 v[24:27], v[56:59], v[80:83], v[24:27]
    ds_read2_b32 v[132:133], v237 offset0:0 offset1:1
    v_mfma_f32_16x16x32_bf16 v[28:31], v[56:59], v[84:87], v[28:31]
    ds_read2_b32 v[134:135], v237 offset0:2 offset1:3
    v_mfma_f32_16x16x32_bf16 v[32:35], v[56:59], v[88:91], v[32:35]
    ds_read_b128 v[164:167], v239 offset:2560
    s_add_u32 m0, s33, 0
    s_sub_u32 s54, 8, s101
    s_mul_i32 s54, s54, 131072
    s_add_u32 s54, s54, s34
    buffer_load_dwordx4 v3, s[4:7], s54 offen offset:0  lds
    buffer_load_dwordx4 v4, s[4:7], s54 offen offset:1024  lds
    v_mfma_f32_16x16x32_bf16 v[36:39], v[56:59], v[92:95], v[36:39]
    ds_read2_b32 v[136:137], v238 offset0:128 offset1:129
    v_mfma_f32_16x16x32_bf16 v[40:43], v[56:59], v[96:99], v[40:43]
    ds_read2_b32 v[138:139], v238 offset0:130 offset1:131
    v_mfma_f32_16x16x32_bf16 v[44:47], v[56:59], v[100:103], v[44:47]
    ds_read_b128 v[168:171], v239 offset:3072
    v_mfma_f32_16x16x32_bf16 v[28:31], v[60:63], v[80:83], v[28:31]
    ds_read2_b32 v[140:141], v238 offset0:0 offset1:1
    v_mfma_f32_16x16x32_bf16 v[32:35], v[60:63], v[84:87], v[32:35]
    ds_read2_b32 v[142:143], v238 offset0:2 offset1:3
    v_mfma_f32_16x16x32_bf16 v[36:39], v[60:63], v[88:91], v[36:39]
    ds_read_b128 v[172:175], v239 offset:3584
    buffer_load_dwordx4 v252, s[4:7], s54 offen offset:2048  lds
    buffer_load_dwordx4 v253, s[4:7], s54 offen offset:3072  lds
    v_mfma_f32_16x16x32_bf16 v[40:43], v[60:63], v[92:95], v[40:43]
    v_mfma_f32_16x16x32_bf16 v[44:47], v[60:63], v[96:99], v[44:47]
    v_mfma_f32_16x16x32_bf16 v[32:35], v[64:67], v[80:83], v[32:35]
    v_mfma_f32_16x16x32_bf16 v[36:39], v[64:67], v[84:87], v[36:39]
    v_mfma_f32_16x16x32_bf16 v[40:43], v[64:67], v[88:91], v[40:43]
    v_mfma_f32_16x16x32_bf16 v[44:47], v[64:67], v[92:95], v[44:47]
    v_mfma_f32_16x16x32_bf16 v[36:39], v[68:71], v[80:83], v[36:39]
    v_mfma_f32_16x16x32_bf16 v[40:43], v[68:71], v[84:87], v[40:43]
    v_mfma_f32_16x16x32_bf16 v[44:47], v[68:71], v[88:91], v[44:47]
    v_mfma_f32_16x16x32_bf16 v[40:43], v[72:75], v[80:83], v[40:43]
    v_mfma_f32_16x16x32_bf16 v[44:47], v[72:75], v[84:87], v[44:47]
    v_mfma_f32_16x16x32_bf16 v[44:47], v[76:79], v[80:83], v[44:47]
    s_waitcnt lgkmcnt(0)
    v_mfma_f32_16x16x32_bf16 v[16:19], v[112:115], v[144:147], v[16:19]
    s_and_b32 s42, s3, 1
    s_add_u32 m0, s33, 4096
    s_sub_u32 s54, 9, s101
    s_mul_i32 s54, s54, 131072
    s_add_u32 s54, s54, s34
    buffer_load_dwordx4 v3, s[4:7], s54 offen offset:0  lds
    buffer_load_dwordx4 v4, s[4:7], s54 offen offset:1024  lds
    v_mfma_f32_16x16x32_bf16 v[20:23], v[112:115], v[148:151], v[20:23]
    s_mul_i32 s42, s42, 8320
    v_mfma_f32_16x16x32_bf16 v[24:27], v[112:115], v[152:155], v[24:27]
    s_add_u32 s42, s42, 131072
    v_mfma_f32_16x16x32_bf16 v[28:31], v[112:115], v[156:159], v[28:31]
    v_add_u32 v176, s42, v1
    v_mfma_f32_16x16x32_bf16 v[32:35], v[112:115], v[160:163], v[32:35]
    s_lshl_b32 s37, s35, 12
    buffer_load_dwordx4 v252, s[4:7], s54 offen offset:2048  lds
    buffer_load_dwordx4 v253, s[4:7], s54 offen offset:3072  lds
    v_mfma_f32_16x16x32_bf16 v[36:39], v[112:115], v[164:167], v[36:39]
    s_add_u32 s37, s37, 0x700000
    v_mfma_f32_16x16x32_bf16 v[40:43], v[112:115], v[168:171], v[40:43]
    s_lshr_b32 s42, s3, 1
    v_mfma_f32_16x16x32_bf16 v[44:47], v[112:115], v[172:175], v[44:47]
    s_lshl_b32 s42, s42, 11
    v_mfma_f32_16x16x32_bf16 v[20:23], v[116:119], v[144:147], v[20:23]
    s_add_u32 s37, s37, s42
    s_add_u32 m0, s33, 8192
    s_sub_u32 s54, 10, s101
    s_mul_i32 s54, s54, 131072
    s_add_u32 s54, s54, s34
    buffer_load_dwordx4 v3, s[4:7], s54 offen offset:0  lds
    buffer_load_dwordx4 v4, s[4:7], s54 offen offset:1024  lds
    v_mfma_f32_16x16x32_bf16 v[24:27], v[116:119], v[148:151], v[24:27]
    v_mul_u32_u24 v250, 64, v0
    v_mfma_f32_16x16x32_bf16 v[28:31], v[116:119], v[152:155], v[28:31]
    s_mul_i32 s42, s24, 2048
    v_mfma_f32_16x16x32_bf16 v[32:35], v[116:119], v[156:159], v[32:35]
    s_add_u32 s42, s42, 0xa10000
    v_mfma_f32_16x16x32_bf16 v[36:39], v[116:119], v[160:163], v[36:39]
    s_mul_i32 s43, s3, 384
    buffer_load_dwordx4 v252, s[4:7], s54 offen offset:2048  lds
    buffer_load_dwordx4 v253, s[4:7], s54 offen offset:3072  lds
    v_mfma_f32_16x16x32_bf16 v[40:43], v[116:119], v[164:167], v[40:43]
    s_add_u32 s42, s42, s43
    v_mfma_f32_16x16x32_bf16 v[44:47], v[116:119], v[168:171], v[44:47]
    v_and_b32 v216, 15, v0
    v_mfma_f32_16x16x32_bf16 v[24:27], v[120:123], v[144:147], v[24:27]
    v_lshlrev_b32 v216, 5, v216
    v_mfma_f32_16x16x32_bf16 v[28:31], v[120:123], v[148:151], v[28:31]
    v_bfe_u32 v217, v0, 4, 1
    s_add_u32 m0, s33, 12288
    s_sub_u32 s54, 11, s101
    s_mul_i32 s54, s54, 131072
    s_add_u32 s54, s54, s34
    buffer_load_dwordx4 v3, s[4:7], s54 offen offset:0  lds
    buffer_load_dwordx4 v4, s[4:7], s54 offen offset:1024  lds
    v_mfma_f32_16x16x32_bf16 v[32:35], v[120:123], v[152:155], v[32:35]
    v_lshl_add_u32 v216, v217, 9, v216
    v_mfma_f32_16x16x32_bf16 v[36:39], v[120:123], v[156:159], v[36:39]
    v_lshrrev_b32 v217, 5, v0
    v_mfma_f32_16x16x32_bf16 v[40:43], v[120:123], v[160:163], v[40:43]
    v_lshl_add_u32 v216, v217, 4, v216
    v_mfma_f32_16x16x32_bf16 v[44:47], v[120:123], v[164:167], v[44:47]
    buffer_load_dwordx4 v252, s[4:7], s54 offen offset:2048  lds
    buffer_load_dwordx4 v253, s[4:7], s54 offen offset:3072  lds
    v_mfma_f32_16x16x32_bf16 v[28:31], v[124:127], v[144:147], v[28:31]
    v_mfma_f32_16x16x32_bf16 v[32:35], v[124:127], v[148:151], v[32:35]
    v_mfma_f32_16x16x32_bf16 v[36:39], v[124:127], v[152:155], v[36:39]
    v_mfma_f32_16x16x32_bf16 v[40:43], v[124:127], v[156:159], v[40:43]
    v_mfma_f32_16x16x32_bf16 v[44:47], v[124:127], v[160:163], v[44:47]
    v_mfma_f32_16x16x32_bf16 v[32:35], v[128:131], v[144:147], v[32:35]
    v_mfma_f32_16x16x32_bf16 v[36:39], v[128:131], v[148:151], v[36:39]
    v_mfma_f32_16x16x32_bf16 v[40:43], v[128:131], v[152:155], v[40:43]
    v_mfma_f32_16x16x32_bf16 v[44:47], v[128:131], v[156:159], v[44:47]
    v_mfma_f32_16x16x32_bf16 v[36:39], v[132:135], v[144:147], v[36:39]
    v_mfma_f32_16x16x32_bf16 v[40:43], v[132:135], v[148:151], v[40:43]
    v_mfma_f32_16x16x32_bf16 v[44:47], v[132:135], v[152:155], v[44:47]
    v_mfma_f32_16x16x32_bf16 v[40:43], v[136:139], v[144:147], v[40:43]
    v_mfma_f32_16x16x32_bf16 v[44:47], v[136:139], v[148:151], v[44:47]
    v_mfma_f32_16x16x32_bf16 v[44:47], v[140:143], v[144:147], v[44:47]
    s_barrier
    s_mov_b64 exec, 63
    buffer_load_dwordx2 v[240:241], v250, s[8:11], s42 offen sc1
    s_mov_b64 exec, -1
    s_cmp_lt_u32 s3, 2
    s_cbranch_scc0 L_cx1
    ds_write_b128 v176, v[32:35] offset:0
    ds_write_b128 v176, v[36:39] offset:1024
    ds_write_b128 v176, v[40:43] offset:2048
    ds_write_b128 v176, v[44:47] offset:3072
    s_branch L_cx2
L_cx1:
    ds_write_b128 v176, v[16:19] offset:4096
    ds_write_b128 v176, v[20:23] offset:5120
    ds_write_b128 v176, v[24:27] offset:6144
    ds_write_b128 v176, v[28:31] offset:7168
L_cx2:
    s_waitcnt lgkmcnt(0)
    s_barrier
    s_mov_b32 s38, 1
    s_waitcnt vmcnt(0)
    s_branch L_G2
L_F:
    s_add_u32 s35, s28, s3
    s_mul_i32 s42, s35, 384
    v_lshl_add_u32 v7, v0, 1, s42
    s_lshl_b32 s42, s35, 1
    v_mov_b32 v8, s42
    global_load_ushort v108, v8, s[74:75]
    global_load_ushort v161, v8, s[76:77]
    global_load_ushort v96, v7, s[66:67] offset:0
    global_load_ushort v97, v7, s[68:69] offset:0
    global_load_ushort v98, v7, s[70:71] offset:0
    global_load_ushort v99, v7, s[72:73] offset:0
    global_load_ushort v100, v7, s[66:67] offset:128
    global_load_ushort v101, v7, s[68:69] offset:128
    global_load_ushort v102, v7, s[70:71] offset:128
    global_load_ushort v103, v7, s[72:73] offset:128
    global_load_ushort v104, v7, s[66:67] offset:256
    global_load_ushort v105, v7, s[68:69] offset:256
    global_load_ushort v106, v7, s[70:71] offset:256
    global_load_ushort v107, v7, s[72:73] offset:256
    v_mov_b32 v76, 81536
    v_mov_b32 v78, 0
    v_mov_b32 v79, 0
    ds_write_b64 v76, v[78:79]
    v_add_u32_e64 v110, s32, v1
    v_bfe_u32 v76, v0, 2, 1
    v_bfe_u32 v77, v0, 4, 1
    v_lshl_or_b32 v76, v76, 1, v77
    v_bfe_u32 v77, v0, 1, 1
    v_lshl_or_b32 v76, v76, 1, v77
    v_mul_u32_u24 v76, 1056, v76
    v_lshrrev_b32_e64 v77, 5, v0
    v_lshl_add_u32 v76, v77, 6, v76
    v_bfe_u32 v77, v0, 3, 1
    v_lshl_add_u32 v76, v77, 4, v76
    v_and_b32 v77, 1, v0
    v_lshl_add_u32 v76, v77, 3, v76
    v_add_u32 v160, s32, v76
    v_lshrrev_b32 v64, 5, v0
    s_lshl_b32 s42, s3, 1
    v_add_u32 v64, s42, v64
    v_lshlrev_b32 v69, 2, v64
    v_mul_u32_u24 v64, 1344, v64
    v_add_u32 v64, 131072, v64
    v_and_b32_e64 v65, 31, v0
    v_lshl_add_u32 v64, v65, 3, v64
    v_lshl_add_u32 v65, v65, 3, v64
    v_add_u32 v69, 141824, v69
    v_bfe_u32 v66, v0, 2, 2
    v_mul_u32_u24 v66, 1344, v66
    v_lshrrev_b32 v67, 4, v0
    v_lshl_add_u32 v66, v67, 5, v66
    v_and_b32 v56, 3, v0
    v_lshl_add_u32 v66, v56, 3, v66
    v_add_u32 v66, 131072, v66
    v_lshlrev_b32 v67, 10, v67
    v_and_b32 v56, 15, v0
    v_lshl_add_u32 v67, v56, 4, v67
    s_lshr_b32 s43, s2, 2
    s_mul_i32 s43, s43, 40960
    s_and_b32 s44, s2, 3
    s_lshl_b32 s44, s44, 8
    s_add_u32 s43, s43, s44
    s_lshl_b32 s45, s2, 5
    s_add_u32 s45, s45, 0xa30000
    v_add_u32 v68, 141824, v1
    s_mov_b32 s42, 0x3acccccd
    v_mov_b32 v61, 0x3727c5ac
    s_cmp_eq_u32 s3, 3
    s_cbranch_scc0 L_tw15
    s_cmp_eq_u32 s2, 0
    s_cbranch_scc0 L_tw17
    s_memrealtime s[30:31]
    v_mov_b32 v72, 0
    s_waitcnt lgkmcnt(0)
    s_or_b32 s31, s31, 0x40000000
    v_mov_b32 v70, s30
    v_mov_b32 v71, s31
    s_mov_b64 exec, 1
    global_store_dwordx2 v72, v[70:71], s[90:91] sc1
    s_mov_b64 exec, -1
    v_mul_u32_u24 v74, 43, v0
    v_lshrrev_b32 v74, 8, v74
    v_mul_u32_u24 v74, 2304, v74
    v_lshl_add_u32 v74, v0, 7, v74
    s_lshr_b32 s29, s41, 3
    s_lshl_b32 s29, s29, 5
    s_and_b32 s55, s41, 7
    s_add_u32 s29, s29, s55
    s_lshl_b32 s55, s100, 1
    s_add_u32 s29, s29, s55
    s_mul_i32 s29, s29, 49152
    s_lshr_b32 s55, s40, 1
    s_mul_i32 s55, s55, 768
    s_add_u32 s29, s29, s55
    s_mov_b32 exec_hi, 0xffff
    buffer_load_dword v254, v74, s[16:19], s29 offen
    s_add_u32 s29, s29, 24576
    buffer_load_dword v254, v74, s[16:19], s29 offen
    s_mov_b64 exec, -1
    s_waitcnt vmcnt(17)
    s_branch L_tw16
L_tw17:
    v_mul_u32_u24 v74, 43, v0
    v_lshrrev_b32 v74, 8, v74
    v_mul_u32_u24 v74, 2304, v74
    v_lshl_add_u32 v74, v0, 7, v74
    s_lshr_b32 s29, s41, 3
    s_lshl_b32 s29, s29, 5
    s_and_b32 s55, s41, 7
    s_add_u32 s29, s29, s55
    s_lshl_b32 s55, s100, 1
    s_add_u32 s29, s29, s55
    s_mul_i32 s29, s29, 49152
    s_lshr_b32 s55, s40, 1
    s_mul_i32 s55, s55, 768
    s_add_u32 s29, s29, s55
    s_mov_b32 exec_hi, 0xffff
    buffer_load_dword v254, v74, s[16:19], s29 offen
    s_add_u32 s29, s29, 24576
    buffer_load_dword v254, v74, s[16:19], s29 offen
    s_mov_b64 exec, -1
    s_waitcnt vmcnt(16)
    s_branch L_tw16
L_tw15:
    s_waitcnt vmcnt(14)
L_tw16:
    v_lshlrev_b32 v36, 16, v16
    v_and_b32 v37, 0xffff0000, v16
    v_lshlrev_b32 v38, 16, v17
    v_and_b32 v39, 0xffff0000, v17
    v_lshlrev_b32 v40, 16, v18
    v_and_b32 v41, 0xffff0000, v18
    v_lshlrev_b32 v42, 16, v19
    v_and_b32 v43, 0xffff0000, v19
    v_lshlrev_b32 v44, 16, v20
    v_and_b32 v45, 0xffff0000, v20
    v_lshlrev_b32 v46, 16, v21
    v_and_b32 v47, 0xffff0000, v21
    v_lshlrev_b32 v48, 16, v22
    v_and_b32 v49, 0xffff0000, v22
    v_lshlrev_b32 v50, 16, v23
    v_and_b32 v51, 0xffff0000, v23
    v_lshlrev_b32 v52, 16, v24
    v_and_b32 v53, 0xffff0000, v24
    v_lshlrev_b32_e64 v54, 16, v25
    v_and_b32 v55, 0xffff0000, v25
    v_pk_add_f32 v[56:57], v[36:37], v[38:39]
    v_pk_add_f32 v[58:59], v[40:41], v[42:43]
    v_pk_add_f32 v[56:57], v[56:57], v[44:45]
    v_pk_add_f32 v[58:59], v[58:59], v[46:47]
    v_pk_add_f32 v[56:57], v[56:57], v[48:49]
    v_pk_add_f32 v[58:59], v[58:59], v[50:51]
    v_pk_add_f32 v[56:57], v[56:57], v[52:53]
    v_pk_add_f32 v[58:59], v[58:59], v[54:55]
    v_pk_add_f32 v[56:57], v[56:57], v[58:59]
    v_add_f32 v56, v56, v57
    s_nop 1
    v_add_f32_dpp v56, v56, v56 quad_perm:[1,0,3,2] row_mask:0xf bank_mask:0xf
    s_nop 1
    v_add_f32_dpp v56, v56, v56 quad_perm:[2,3,0,1] row_mask:0xf bank_mask:0xf
    s_nop 1
    v_add_f32_dpp v56, v56, v56 row_half_mirror row_mask:0xf bank_mask:0xf
    s_nop 1
    v_add_f32_dpp v56, v56, v56 row_mirror row_mask:0xf bank_mask:0xf
    v_mov_b32 v57, v56
    s_nop 1
    v_permlane16_swap_b32 v56, v57
    v_add_f32_e64 v56, v56, v57
    v_mul_f32 v60, 0xbacccccd, v56
    v_pk_add_f32 v[36:37], v[36:37], v[60:61] op_sel_hi:[1,0]
    v_pk_add_f32 v[38:39], v[38:39], v[60:61] op_sel_hi:[1,0]
    v_pk_add_f32 v[40:41], v[40:41], v[60:61] op_sel_hi:[1,0]
    v_pk_add_f32 v[42:43], v[42:43], v[60:61] op_sel_hi:[1,0]
    v_pk_add_f32 v[44:45], v[44:45], v[60:61] op_sel_hi:[1,0]
    v_pk_add_f32 v[46:47], v[46:47], v[60:61] op_sel_hi:[1,0]
    v_pk_add_f32 v[48:49], v[48:49], v[60:61] op_sel_hi:[1,0]
    v_pk_add_f32 v[50:51], v[50:51], v[60:61] op_sel_hi:[1,0]
    v_pk_add_f32 v[52:53], v[52:53], v[60:61] op_sel_hi:[1,0]
    v_pk_add_f32 v[54:55], v[54:55], v[60:61] op_sel_hi:[1,0]
    v_pk_mul_f32 v[56:57], v[36:37], v[36:37]
    v_pk_mul_f32 v[58:59], v[38:39], v[38:39]
    v_pk_fma_f32 v[56:57], v[40:41], v[40:41], v[56:57]
    v_pk_fma_f32 v[58:59], v[42:43], v[42:43], v[58:59]
    v_pk_fma_f32 v[56:57], v[44:45], v[44:45], v[56:57]
    v_pk_fma_f32 v[58:59], v[46:47], v[46:47], v[58:59]
    v_pk_fma_f32 v[56:57], v[48:49], v[48:49], v[56:57]
    v_pk_fma_f32 v[58:59], v[50:51], v[50:51], v[58:59]
    v_pk_fma_f32 v[56:57], v[52:53], v[52:53], v[56:57]
    v_pk_fma_f32 v[58:59], v[54:55], v[54:55], v[58:59]
    v_pk_add_f32 v[56:57], v[56:57], v[58:59]
    v_add_f32 v56, v56, v57
    s_nop 1
    v_add_f32_dpp v56, v56, v56 quad_perm:[1,0,3,2] row_mask:0xf bank_mask:0xf
    s_nop 1
    v_add_f32_dpp v56, v56, v56 quad_perm:[2,3,0,1] row_mask:0xf bank_mask:0xf
    s_nop 1
    v_add_f32_dpp v56, v56, v56 row_half_mirror row_mask:0xf bank_mask:0xf
    s_nop 1
    v_add_f32_dpp v56, v56, v56 row_mirror row_mask:0xf bank_mask:0xf
    v_mov_b32 v57, v56
    s_nop 1
    v_permlane16_swap_b32 v56, v57
    v_add_f32 v56, v56, v57
    v_mul_f32 v56, s42, v56
    v_add_f32 v58, v56, v61
    v_rsq_f32 v58, v58
    s_nop 0
    v_mul_f32 v56, v56, v58
    v_fma_f32 v56, v56, v58, v61
    v_rsq_f32 v57, v56
    s_nop 0
    v_mul_f32 v58, v57, v58
    v_mul_f32 v56, v56, v57
    v_pk_mul_f32 v[70:71], v[36:37], v[58:59] op_sel_hi:[1,0]
    v_cvt_pk_bf16_f32 v26, v70, v71
    v_pk_mul_f32 v[72:73], v[38:39], v[58:59] op_sel_hi:[1,0]
    v_cvt_pk_bf16_f32 v27, v72, v73
    v_pk_mul_f32 v[70:71], v[40:41], v[58:59] op_sel_hi:[1,0]
    v_cvt_pk_bf16_f32 v28, v70, v71
    v_pk_mul_f32 v[72:73], v[42:43], v[58:59] op_sel_hi:[1,0]
    v_cvt_pk_bf16_f32 v29, v72, v73
    v_pk_mul_f32 v[70:71], v[44:45], v[58:59] op_sel_hi:[1,0]
    v_cvt_pk_bf16_f32 v30, v70, v71
    v_pk_mul_f32 v[72:73], v[46:47], v[58:59] op_sel_hi:[1,0]
    v_cvt_pk_bf16_f32 v31, v72, v73
    v_pk_mul_f32 v[70:71], v[48:49], v[58:59] op_sel_hi:[1,0]
    v_cvt_pk_bf16_f32 v32, v70, v71
    v_pk_mul_f32 v[72:73], v[50:51], v[58:59] op_sel_hi:[1,0]
    v_cvt_pk_bf16_f32 v33, v72, v73
    v_pk_mul_f32 v[70:71], v[52:53], v[58:59] op_sel_hi:[1,0]
    v_cvt_pk_bf16_f32 v34, v70, v71
    v_pk_mul_f32 v[72:73], v[54:55], v[58:59] op_sel_hi:[1,0]
    v_cvt_pk_bf16_f32 v35, v72, v73
    ds_write_b128 v65, v[26:29]
    ds_write_b128 v65, v[30:33] offset:512
    ds_write_b64 v64, v[34:35] offset:1024
    ds_write_b32 v69, v56
    s_waitcnt lgkmcnt(0)
    s_barrier
    s_cmp_eq_u32 s3, 2
    s_cbranch_scc0 L_ln18
    ds_read_b64_tr_b16 v[16:17], v66 offset:0
    ds_read_b64_tr_b16 v[18:19], v66 offset:5376
    ds_read_b64_tr_b16 v[20:21], v66 offset:128
    ds_read_b64_tr_b16 v[22:23], v66 offset:5504
    ds_read_b64_tr_b16 v[24:25], v66 offset:256
    ds_read_b64_tr_b16 v[26:27], v66 offset:5632
    ds_read_b64_tr_b16 v[28:29], v66 offset:384
    ds_read_b64_tr_b16 v[30:31], v66 offset:5760
    ds_read_b64_tr_b16 v[32:33], v66 offset:512
    ds_read_b64_tr_b16 v[34:35], v66 offset:5888
    ds_read_b64_tr_b16 v[36:37], v66 offset:640
    ds_read_b64_tr_b16 v[38:39], v66 offset:6016
    ds_read_b64_tr_b16 v[40:41], v66 offset:768
    ds_read_b64_tr_b16 v[42:43], v66 offset:6144
    s_waitcnt vmcnt(0)
    s_waitcnt lgkmcnt(12)
    buffer_store_dwordx4 v[16:19], v67, s[8:11], s43 offen sc1
    s_add_u32 s43, s43, 4096
    ds_read_b64_tr_b16 v[44:45], v66 offset:896
    ds_read_b64_tr_b16 v[46:47], v66 offset:6272
    s_waitcnt lgkmcnt(12)
    buffer_store_dwordx4 v[20:23], v67, s[8:11], s43 offen sc1
    s_add_u32 s43, s43, 4096
    ds_read_b64_tr_b16 v[48:49], v66 offset:1024
    ds_read_b64_tr_b16 v[50:51], v66 offset:6400
    s_waitcnt lgkmcnt(12)
    buffer_store_dwordx4 v[24:27], v67, s[8:11], s43 offen sc1
    s_add_u32 s43, s43, 4096
    ds_read_b64_tr_b16 v[52:53], v66 offset:1152
    ds_read_b64_tr_b16 v[54:55], v66 offset:6528
    s_waitcnt lgkmcnt(12)
    buffer_store_dwordx4 v[28:31], v67, s[8:11], s43 offen sc1
    s_add_u32 s43, s43, 4096
    s_waitcnt lgkmcnt(10)
    buffer_store_dwordx4 v[32:35], v67, s[8:11], s43 offen sc1
    s_add_u32 s43, s43, 4096
    s_waitcnt lgkmcnt(8)
    buffer_store_dwordx4 v[36:39], v67, s[8:11], s43 offen sc1
    s_add_u32 s43, s43, 4096
    s_waitcnt lgkmcnt(6)
    buffer_store_dwordx4 v[40:43], v67, s[8:11], s43 offen sc1
    s_add_u32 s43, s43, 4096
    s_waitcnt lgkmcnt(4)
    buffer_store_dwordx4 v[44:47], v67, s[8:11], s43 offen sc1
    s_add_u32 s43, s43, 4096
    s_waitcnt lgkmcnt(2)
    buffer_store_dwordx4 v[48:51], v67, s[8:11], s43 offen sc1
    s_add_u32 s43, s43, 4096
    s_waitcnt lgkmcnt(0)
    buffer_store_dwordx4 v[52:55], v67, s[8:11], s43 offen sc1
    s_add_u32 s43, s43, 4096
    s_mov_b64 exec, 3
    ds_read_b128 v[56:59], v68
    s_waitcnt lgkmcnt(0)
    buffer_store_dwordx4 v[56:59], v1, s[8:11], s45 offen sc1
    s_mov_b64 exec, -1
    v_mov_b32 v242, 0
    global_load_dwordx2 v[240:241], v242, s[90:91] sc1
    s_branch L_ln20
L_ln18:
    s_cmp_eq_u32 s3, 3
    s_cbranch_scc1 L_ln19
    s_waitcnt vmcnt(0)
    s_branch L_ln20
L_ln19:
    s_cmp_eq_u32 s2, 0
    s_cbranch_scc1 L_ln21
    s_waitcnt vmcnt(2)
L_ln21:
    s_waitcnt vmcnt(3)
L_ln20:
    v_mov_b32 v80, 0
    v_mov_b32 v81, 0
    v_mov_b32 v82, 0
    v_mov_b32 v83, 0
    v_add_u32 v111, s33, v1
    v_lshlrev_b32 v108, 16, v108
    v_lshlrev_b32 v161, 16, v161
    v_mul_f32 v73, s56, v108
    v_fma_f32 v74, v108, s56, -v73
    v_fma_f32 v74, v108, s57, v74
    v_exp_f32 v72, v73
    v_mul_f32 v74, s58, v74
    v_fma_f32 v72, v72, v74, v72
    v_cvt_pk_bf16_f32 v108, v72, v72
    v_and_b32 v108, 0xffff0000, v108
    v_add_f32 v109, v108, v108
    v_lshlrev_b32 v96, 16, v96
    v_lshlrev_b32 v97, 16, v97
    v_lshlrev_b32 v98, 16, v98
    v_lshlrev_b32 v99, 16, v99
    v_mul_f32 v30, s56, v96
    v_fma_f32 v31, v96, s56, -v30
    v_fma_f32 v31, v96, s57, v31
    v_exp_f32 v16, v30
    v_mul_f32 v31, s58, v31
    v_fma_f32 v16, v16, v31, v16
    v_pk_mul_f32 v[18:19], v[98:99], v[108:109] op_sel:[0,1] op_sel_hi:[1,1]
    v_cvt_pk_bf16_f32 v16, v16, v16
    v_and_b32 v16, 0xffff0000, v16
    v_mul_f32 v17, v97, v108
    v_mul_f32 v16, v16, v108
    v_mul_f32 v17, 0.15915494, v17
    v_mul_f32 v16, 0xbfb8aa3b, v16
    v_fract_f32 v31, v17
    v_exp_f32 v30, v16
    v_cos_f32 v20, v31
    s_and_b32 s43, s41, 7
    s_lshl_b32 s43, s43, 2
    s_add_u32 s43, s43, s3
    s_mul_i32 s43, s43, 96
    s_add_u32 s43, s43, 3072
    s_lshr_b32 s37, s40, 1
    s_mul_i32 s37, s37, 768
    v_add_u32 v85, s43, v0
    s_add_u32 s43, s43, 48
    s_mov_b32 s55, 715827883
    v_mul_hi_u32 v86, s55, v85
    v_mul_u32_u24 v87, 6, v86
    v_sub_u32 v85, v85, v87
    v_bfe_u32 v87, v86, 7, 2
    v_mul_u32_u24 v87, 384, v87
    v_add_u32 v87, v87, v86
    v_lshrrev_b32 v86, 9, v86
    v_mul_u32_u24 v86, 384, v86
    v_sub_u32 v86, v87, v86
    s_and_b32 s55, s40, 1
    s_xor_b32 s55, s55, 0
    v_mov_b32 v87, s55
    v_lshl_add_u32 v86, v87, 8, v86
    v_mul_u32_u24 v86, 3072, v86
    v_lshl_add_u32 v85, v85, 7, v86
    s_mov_b32 exec_hi, 0xffff
    buffer_load_dword v254, v85, s[16:19], s37 offen
    s_mov_b64 exec, -1
    v_add_u32 v85, s43, v0
    s_add_u32 s43, s43, 48
    s_mov_b32 s55, 715827883
    v_mul_hi_u32 v86, s55, v85
    v_mul_u32_u24 v87, 6, v86
    v_sub_u32 v85, v85, v87
    v_bfe_u32 v87, v86, 7, 2
    v_mul_u32_u24 v87, 384, v87
    v_add_u32 v87, v87, v86
    v_lshrrev_b32 v86, 9, v86
    v_mul_u32_u24 v86, 384, v86
    v_sub_u32 v86, v87, v86
    s_and_b32 s55, s40, 1
    s_xor_b32 s55, s55, 0
    v_mov_b32_e64 v87, s55
    v_lshl_add_u32 v86, v87, 8, v86
    v_mul_u32_u24 v86, 3072, v86
    v_lshl_add_u32 v85, v85, 7, v86
    s_mov_b32 exec_hi, 0xffff
    buffer_load_dword v254, v85, s[16:19], s37 offen
    s_mov_b64 exec, -1
    v_sin_f32 v21, v31
    s_nop 0
    v_pk_mul_f32 v[20:21], v[20:21], v[30:31] op_sel_hi:[1,0]
    v_mul_f32 v30, 0x43800000, v16
    v_mul_f32 v31, 0x43800000, v17
    v_fract_f32 v31, v31
    v_exp_f32 v30, v30
    v_cos_f32 v28, v31
    v_sin_f32 v29, v31
    s_nop 0
    v_pk_mul_f32 v[28:29], v[28:29], v[30:31] op_sel_hi:[1,0]
    v_mul_f32 v30, 0x41000000, v16
    v_mul_f32 v31, 0x41000000, v17
    s_and_b32 s43, s41, 7
    v_fract_f32 v31, v31
    v_exp_f32 v30, v30
    v_cos_f32 v26, v31
    s_lshl_b32 s43, s43, 2
    v_sin_f32 v27, v31
    s_nop 0
    v_pk_mul_f32 v[26:27], v[26:27], v[30:31] op_sel_hi:[1,0]
    v_pk_mul_f32 v[30:31], v[20:21], v[20:21] op_sel_hi:[1,0]
    v_pk_fma_f32 v[22:23], v[20:21], v[20:21], v[30:31] op_sel:[1,1,0] op_sel_hi:[0,1,1] neg_lo:[1,0,0]
    s_add_u32 s43, s43, s3
    v_pk_mul_f32 v[30:31], v[22:23], v[22:23] op_sel_hi:[1,0]
    v_pk_fma_f32 v[24:25], v[22:23], v[22:23], v[30:31] op_sel:[1,1,0] op_sel_hi:[0,1,1] neg_lo:[1,0,0]
    v_pk_mul_f32 v[30:31], v[18:19], v[20:21] op_sel_hi:[1,0]
    v_pk_fma_f32 v[34:35], v[18:19], v[20:21], v[30:31] op_sel:[1,1,0] op_sel_hi:[0,1,1] neg_lo:[1,0,0]
    s_lshl_b32 s43, s43, 6
    v_cvt_pk_bf16_f32 v38, v18, v34
    v_cvt_pk_bf16_f32 v42, -v19, -v35
    v_pk_mul_f32 v[30:31], v[34:35], v[20:21] op_sel_hi:[1,0]
    v_add_u32 v88, s43, v0
    v_pk_fma_f32 v[32:33], v[34:35], v[20:21], v[30:31] op_sel:[1,1,0] op_sel_hi:[0,1,1] neg_lo:[1,0,0]
    v_pk_mul_f32 v[30:31], v[32:33], v[20:21] op_sel_hi:[1,0]
    v_pk_fma_f32 v[34:35], v[32:33], v[20:21], v[30:31] op_sel:[1,1,0] op_sel_hi:[0,1,1] neg_lo:[1,0,0]
    v_cvt_pk_bf16_f32 v39, v32, v34
    s_and_b32 s43, s41, 7
    v_cvt_pk_bf16_f32 v43, -v33, -v35
    v_pk_mul_f32 v[30:31], v[34:35], v[20:21] op_sel_hi:[1,0]
    v_pk_fma_f32 v[32:33], v[34:35], v[20:21], v[30:31] op_sel:[1,1,0] op_sel_hi:[0,1,1] neg_lo:[1,0,0]
    v_pk_mul_f32 v[30:31], v[32:33], v[20:21] op_sel_hi:[1,0]
    s_lshl_b32 s43, s43, 2
    v_pk_fma_f32 v[34:35], v[32:33], v[20:21], v[30:31] op_sel:[1,1,0] op_sel_hi:[0,1,1] neg_lo:[1,0,0]
    v_cvt_pk_bf16_f32 v40, v32, v34
    v_cvt_pk_bf16_f32 v44, -v33, -v35
    s_add_u32 s43, s43, s3
    s_nop 0
    v_pk_mul_f32 v[30:31], v[34:35], v[20:21] op_sel_hi:[1,0]
    v_pk_fma_f32 v[32:33], v[34:35], v[20:21], v[30:31] op_sel:[1,1,0] op_sel_hi:[0,1,1] neg_lo:[1,0,0]
    v_pk_mul_f32 v[30:31], v[32:33], v[20:21] op_sel_hi:[1,0]
    v_pk_fma_f32 v[34:35], v[32:33], v[20:21], v[30:31] op_sel:[1,1,0] op_sel_hi:[0,1,1] neg_lo:[1,0,0]
    s_mul_i32 s43, s43, 96
    v_cvt_pk_bf16_f32 v41, v32, v34
    v_cvt_pk_bf16_f32 v45, -v33, -v35
    ds_write_b128 v110, v[38:41] offset:8448
    ds_write_b128 v110, v[42:45] offset:12672
    s_add_u32 s43, s43, 3072
    v_pk_mul_f32 v[30:31], v[18:19], v[28:29] op_sel_hi:[1,0]
    v_pk_fma_f32 v[36:37], v[18:19], v[28:29], v[30:31] op_sel:[1,1,0] op_sel_hi:[0,1,1] neg_lo:[1,0,0]
    v_pk_mul_f32 v[30:31], v[36:37], v[22:23] op_sel_hi:[1,0]
    v_add_u32_e64 v85, s43, v0
    v_pk_fma_f32 v[34:35], v[36:37], v[22:23], v[30:31] op_sel:[1,1,0] op_sel_hi:[0,1,1] neg_lo:[1,0,0]
    v_cvt_pk_bf16_f32 v46, v36, v34
    v_cvt_pk_bf16_f32 v50, -v37, -v35
    v_pk_mul_f32 v[30:31], v[34:35], v[22:23] op_sel_hi:[1,0]
    s_add_u32 s43, s43, 48
    s_nop 0
    v_pk_fma_f32 v[32:33], v[34:35], v[22:23], v[30:31] op_sel:[1,1,0] op_sel_hi:[0,1,1] neg_lo:[1,0,0]
    v_pk_mul_f32 v[30:31], v[32:33], v[22:23] op_sel_hi:[1,0]
    v_pk_fma_f32 v[34:35], v[32:33], v[22:23], v[30:31] op_sel:[1,1,0] op_sel_hi:[0,1,1] neg_lo:[1,0,0]
    v_cvt_pk_bf16_f32 v47, v32, v34
    s_mov_b32 s55, 715827883
    v_cvt_pk_bf16_f32 v51, -v33, -v35
    v_pk_mul_f32 v[30:31], v[36:37], v[28:29] op_sel_hi:[1,0]
    v_pk_fma_f32 v[36:37], v[36:37], v[28:29], v[30:31] op_sel:[1,1,0] op_sel_hi:[0,1,1] neg_lo:[1,0,0]
    v_mul_hi_u32 v86, s55, v85
    v_pk_mul_f32 v[30:31], v[36:37], v[24:25] op_sel_hi:[1,0]
    v_pk_fma_f32 v[34:35], v[36:37], v[24:25], v[30:31] op_sel:[1,1,0] op_sel_hi:[0,1,1] neg_lo:[1,0,0]
    v_cvt_pk_bf16_f32 v48, v36, v34
    v_cvt_pk_bf16_f32 v52, -v37, -v35
    v_mul_u32_u24_e64 v87, 6, v86
    v_pk_mul_f32 v[30:31], v[36:37], v[28:29] op_sel_hi:[1,0]
    v_pk_fma_f32 v[36:37], v[36:37], v[28:29], v[30:31] op_sel:[1,1,0] op_sel_hi:[0,1,1] neg_lo:[1,0,0]
    v_pk_mul_f32 v[30:31], v[36:37], v[24:25] op_sel_hi:[1,0]
    v_pk_fma_f32 v[34:35], v[36:37], v[24:25], v[30:31] op_sel:[1,1,0] op_sel_hi:[0,1,1] neg_lo:[1,0,0]
    v_sub_u32_e64 v215, v85, v87
    v_cvt_pk_bf16_f32 v49, v36, v34
    v_cvt_pk_bf16_f32 v53, -v37, -v35
    ds_write_b128 v110, v[46:49] offset:9504
    ds_write_b128 v110, v[50:53] offset:13728
    v_bfe_u32 v87, v86, 7, 2
    v_pk_mul_f32 v[30:31], v[36:37], v[28:29] op_sel_hi:[1,0]
    v_pk_fma_f32 v[32:33], v[36:37], v[28:29], v[30:31] op_sel:[1,1,0] op_sel_hi:[0,1,1] neg_lo:[1,0,0]
    v_pk_mul_f32 v[30:31], v[32:33], v[28:29] op_sel_hi:[1,0]
    v_mul_u32_u24 v87, 384, v87
    v_pk_fma_f32 v[34:35], v[32:33], v[28:29], v[30:31] op_sel:[1,1,0] op_sel_hi:[0,1,1] neg_lo:[1,0,0]
    v_cvt_pk_bf16_f32 v38, v32, v34
    v_cvt_pk_bf16_f32 v42, -v33, -v35
    v_pk_mul_f32 v[30:31], v[34:35], v[28:29] op_sel_hi:[1,0]
    v_add_u32_e64 v87, v87, v86
    v_pk_fma_f32 v[32:33], v[34:35], v[28:29], v[30:31] op_sel:[1,1,0] op_sel_hi:[0,1,1] neg_lo:[1,0,0]
    v_pk_mul_f32 v[30:31], v[32:33], v[28:29] op_sel_hi:[1,0]
    v_pk_fma_f32 v[34:35], v[32:33], v[28:29], v[30:31] op_sel:[1,1,0] op_sel_hi:[0,1,1] neg_lo:[1,0,0]
    v_cvt_pk_bf16_f32 v39, v32, v34
    v_lshrrev_b32_e64 v86, 9, v86
    v_cvt_pk_bf16_f32 v43, -v33, -v35
    v_pk_mul_f32 v[30:31], v[34:35], v[28:29] op_sel_hi:[1,0]
    v_pk_fma_f32 v[32:33], v[34:35], v[28:29], v[30:31] op_sel:[1,1,0] op_sel_hi:[0,1,1] neg_lo:[1,0,0]
    v_mul_u32_u24 v86, 384, v86
    v_cvt_pk_bf16_f32 v40, v32, 0
    v_cvt_pk_bf16_f32 v44, -v33, 0
    ds_write_b128 v110, v[38:41] offset:10560
    ds_write_b128 v110, v[42:45] offset:14784
    v_sub_u32_e64 v86, v87, v86
    v_cvt_pk_bf16_f32 v46, 1.0, v26
    v_cvt_pk_bf16_f32 v50, 0, v27
    v_pk_mul_f32 v[30:31], v[26:27], v[26:27] op_sel_hi:[1,0]
    v_pk_fma_f32 v[32:33], v[26:27], v[26:27], v[30:31] op_sel:[1,1,0] op_sel_hi:[0,1,1] neg_lo:[1,0,0]
    s_and_b32 s55, s40, 1
    v_pk_mul_f32 v[30:31], v[32:33], v[26:27] op_sel_hi:[1,0]
    v_pk_fma_f32 v[34:35], v[32:33], v[26:27], v[30:31] op_sel:[1,1,0] op_sel_hi:[0,1,1] neg_lo:[1,0,0]
    v_cvt_pk_bf16_f32 v47, v32, v34
    s_xor_b32 s55, s55, 1
    v_cvt_pk_bf16_f32 v51, v33, v35
    v_pk_mul_f32 v[30:31], v[34:35], v[26:27] op_sel_hi:[1,0]
    v_pk_fma_f32 v[32:33], v[34:35], v[26:27], v[30:31] op_sel:[1,1,0] op_sel_hi:[0,1,1] neg_lo:[1,0,0]
    v_pk_mul_f32 v[30:31], v[32:33], v[26:27] op_sel_hi:[1,0]
    v_mov_b32_e64 v87, s55
    v_pk_fma_f32 v[34:35], v[32:33], v[26:27], v[30:31] op_sel:[1,1,0] op_sel_hi:[0,1,1] neg_lo:[1,0,0]
    v_cvt_pk_bf16_f32 v48, v32, v34
    v_cvt_pk_bf16_f32 v52, v33, v35
    v_pk_mul_f32 v[30:31], v[34:35], v[26:27] op_sel_hi:[1,0]
    v_lshl_add_u32 v86, v87, 8, v86
    v_pk_fma_f32 v[32:33], v[34:35], v[26:27], v[30:31] op_sel:[1,1,0] op_sel_hi:[0,1,1] neg_lo:[1,0,0]
    v_pk_mul_f32 v[30:31], v[32:33], v[26:27] op_sel_hi:[1,0]
    v_pk_fma_f32 v[34:35], v[32:33], v[26:27], v[30:31] op_sel:[1,1,0] op_sel_hi:[0,1,1] neg_lo:[1,0,0]
    v_mul_u32_u24 v86, 3072, v86
    v_cvt_pk_bf16_f32 v49, v32, v34
    v_cvt_pk_bf16_f32 v53, v33, v35
    ds_write_b128 v110, v[46:49] offset:0
    ds_write_b128 v110, v[50:53] offset:4224
    v_lshl_add_u32 v215, v215, 7, v86
    v_pk_mul_f32 v[30:31], v[34:35], v[26:27] op_sel_hi:[1,0]
    v_pk_fma_f32 v[32:33], v[34:35], v[26:27], v[30:31] op_sel:[1,1,0] op_sel_hi:[0,1,1] neg_lo:[1,0,0]
    v_pk_mul_f32 v[30:31], v[32:33], v[26:27] op_sel_hi:[1,0]
    v_pk_fma_f32 v[34:35], v[32:33], v[26:27], v[30:31] op_sel:[1,1,0] op_sel_hi:[0,1,1] neg_lo:[1,0,0]
    v_add_u32_e64 v85, s43, v0
    v_cvt_pk_bf16_f32 v38, v32, v34
    v_cvt_pk_bf16_f32 v42, v33, v35
    v_pk_mul_f32 v[30:31], v[34:35], v[26:27] op_sel_hi:[1,0]
    s_add_u32 s43, s43, 48
    s_nop 0
    v_pk_fma_f32 v[32:33], v[34:35], v[26:27], v[30:31] op_sel:[1,1,0] op_sel_hi:[0,1,1] neg_lo:[1,0,0]
    v_pk_mul_f32 v[30:31], v[32:33], v[26:27] op_sel_hi:[1,0]
    v_pk_fma_f32 v[34:35], v[32:33], v[26:27], v[30:31] op_sel:[1,1,0] op_sel_hi:[0,1,1] neg_lo:[1,0,0]
    v_cvt_pk_bf16_f32 v39, v32, v34
    s_mov_b32 s55, 715827883
    v_cvt_pk_bf16_f32 v43, v33, v35
    v_pk_mul_f32 v[30:31], v[34:35], v[26:27] op_sel_hi:[1,0]
    v_pk_fma_f32 v[32:33], v[34:35], v[26:27], v[30:31] op_sel:[1,1,0] op_sel_hi:[0,1,1] neg_lo:[1,0,0]
    v_pk_mul_f32 v[30:31], v[32:33], v[26:27] op_sel_hi:[1,0]
    v_mul_hi_u32 v86, s55, v85
    v_pk_fma_f32 v[34:35], v[32:33], v[26:27], v[30:31] op_sel:[1,1,0] op_sel_hi:[0,1,1] neg_lo:[1,0,0]
    v_cvt_pk_bf16_f32 v40, v32, v34
    v_cvt_pk_bf16_f32 v44, v33, v35
    v_pk_mul_f32 v[30:31], v[34:35], v[26:27] op_sel_hi:[1,0]
    v_mul_u32_u24_e64 v87, 6, v86
    v_pk_fma_f32 v[32:33], v[34:35], v[26:27], v[30:31] op_sel:[1,1,0] op_sel_hi:[0,1,1] neg_lo:[1,0,0]
    v_pk_mul_f32 v[30:31], v[32:33], v[26:27] op_sel_hi:[1,0]
    v_pk_fma_f32 v[34:35], v[32:33], v[26:27], v[30:31] op_sel:[1,1,0] op_sel_hi:[0,1,1] neg_lo:[1,0,0]
    v_sub_u32_e64 v216, v85, v87
    v_cvt_pk_bf16_f32 v41, v32, v34
    v_cvt_pk_bf16_f32 v45, v33, v35
    ds_write_b128 v110, v[38:41] offset:1056
    ds_write_b128 v110, v[42:45] offset:5280
    v_bfe_u32 v87, v86, 7, 2
    v_pk_mul_f32 v[30:31], v[34:35], v[26:27] op_sel_hi:[1,0]
    v_pk_fma_f32 v[32:33], v[34:35], v[26:27], v[30:31] op_sel:[1,1,0] op_sel_hi:[0,1,1] neg_lo:[1,0,0]
    v_pk_mul_f32 v[30:31], v[32:33], v[26:27] op_sel_hi:[1,0]
    v_pk_fma_f32 v[34:35], v[32:33], v[26:27], v[30:31] op_sel:[1,1,0] op_sel_hi:[0,1,1] neg_lo:[1,0,0]
    v_mul_u32_u24 v87, 384, v87
    v_cvt_pk_bf16_f32 v46, v32, v34
    v_cvt_pk_bf16_f32 v50, v33, v35
    v_pk_mul_f32 v[30:31], v[34:35], v[26:27] op_sel_hi:[1,0]
    v_add_u32_e64 v87, v87, v86
    v_pk_fma_f32 v[32:33], v[34:35], v[26:27], v[30:31] op_sel:[1,1,0] op_sel_hi:[0,1,1] neg_lo:[1,0,0]
    v_pk_mul_f32 v[30:31], v[32:33], v[26:27] op_sel_hi:[1,0]
    v_pk_fma_f32 v[34:35], v[32:33], v[26:27], v[30:31] op_sel:[1,1,0] op_sel_hi:[0,1,1] neg_lo:[1,0,0]
    v_cvt_pk_bf16_f32 v47, v32, v34
    v_lshrrev_b32_e64 v86, 9, v86
    v_cvt_pk_bf16_f32 v51, v33, v35
    v_pk_mul_f32 v[30:31], v[34:35], v[26:27] op_sel_hi:[1,0]
    v_pk_fma_f32 v[32:33], v[34:35], v[26:27], v[30:31] op_sel:[1,1,0] op_sel_hi:[0,1,1] neg_lo:[1,0,0]
    v_pk_mul_f32 v[30:31], v[32:33], v[26:27] op_sel_hi:[1,0]
    v_mul_u32_u24 v86, 384, v86
    v_pk_fma_f32 v[34:35], v[32:33], v[26:27], v[30:31] op_sel:[1,1,0] op_sel_hi:[0,1,1] neg_lo:[1,0,0]
    v_cvt_pk_bf16_f32 v48, v32, v34
    v_cvt_pk_bf16_f32 v52, v33, v35
    v_sub_u32_e64 v86, v87, v86
    v_pk_mul_f32 v[30:31], v[34:35], v[26:27] op_sel_hi:[1,0]
    v_pk_fma_f32 v[32:33], v[34:35], v[26:27], v[30:31] op_sel:[1,1,0] op_sel_hi:[0,1,1] neg_lo:[1,0,0]
    v_pk_mul_f32 v[30:31], v[32:33], v[26:27] op_sel_hi:[1,0]
    v_pk_fma_f32 v[34:35], v[32:33], v[26:27], v[30:31] op_sel:[1,1,0] op_sel_hi:[0,1,1] neg_lo:[1,0,0]
    s_and_b32 s55, s40, 1
    v_cvt_pk_bf16_f32 v49, v32, v34
    v_cvt_pk_bf16_f32 v53, v33, v35
    ds_write_b128 v110, v[46:49] offset:2112
    ds_write_b128 v110, v[50:53] offset:6336
    s_xor_b32 s55, s55, 1
    v_pk_mul_f32 v[30:31], v[34:35], v[26:27] op_sel_hi:[1,0]
    v_pk_fma_f32 v[32:33], v[34:35], v[26:27], v[30:31] op_sel:[1,1,0] op_sel_hi:[0,1,1] neg_lo:[1,0,0]
    v_pk_mul_f32 v[30:31], v[32:33], v[26:27] op_sel_hi:[1,0]
    v_mov_b32_e64 v87, s55
    v_pk_fma_f32 v[34:35], v[32:33], v[26:27], v[30:31] op_sel:[1,1,0] op_sel_hi:[0,1,1] neg_lo:[1,0,0]
    v_cvt_pk_bf16_f32 v38, v32, v34
    v_cvt_pk_bf16_f32 v42, v33, v35
    v_pk_mul_f32 v[30:31], v[34:35], v[26:27] op_sel_hi:[1,0]
    v_lshl_add_u32 v86, v87, 8, v86
    v_pk_fma_f32 v[32:33], v[34:35], v[26:27], v[30:31] op_sel:[1,1,0] op_sel_hi:[0,1,1] neg_lo:[1,0,0]
    v_pk_mul_f32 v[30:31], v[32:33], v[26:27] op_sel_hi:[1,0]
    v_pk_fma_f32 v[34:35], v[32:33], v[26:27], v[30:31] op_sel:[1,1,0] op_sel_hi:[0,1,1] neg_lo:[1,0,0]
    v_cvt_pk_bf16_f32 v39, v32, v34
    v_mul_u32_u24 v86, 3072, v86
    v_cvt_pk_bf16_f32 v43, v33, v35
    v_pk_mul_f32 v[30:31], v[34:35], v[26:27] op_sel_hi:[1,0]
    v_pk_fma_f32 v[32:33], v[34:35], v[26:27], v[30:31] op_sel:[1,1,0] op_sel_hi:[0,1,1] neg_lo:[1,0,0]
    v_lshl_add_u32 v216, v216, 7, v86
    v_pk_mul_f32 v[30:31], v[32:33], v[26:27] op_sel_hi:[1,0]
    v_pk_fma_f32 v[34:35], v[32:33], v[26:27], v[30:31] op_sel:[1,1,0] op_sel_hi:[0,1,1] neg_lo:[1,0,0]
    v_cvt_pk_bf16_f32 v40, v32, v34
    v_cvt_pk_bf16_f32 v44, v33, v35
    s_lshr_b32 s37, s40, 1
    s_nop 0
    v_pk_mul_f32 v[30:31], v[34:35], v[26:27] op_sel_hi:[1,0]
    v_pk_fma_f32 v[32:33], v[34:35], v[26:27], v[30:31] op_sel:[1,1,0] op_sel_hi:[0,1,1] neg_lo:[1,0,0]
    v_pk_mul_f32 v[30:31], v[32:33], v[26:27] op_sel_hi:[1,0]
    v_pk_fma_f32 v[34:35], v[32:33], v[26:27], v[30:31] op_sel:[1,1,0] op_sel_hi:[0,1,1] neg_lo:[1,0,0]
    s_mul_i32 s37, s37, 768
    v_cvt_pk_bf16_f32 v41, v32, v34
    v_cvt_pk_bf16_f32 v45, v33, v35
    ds_write_b128 v110, v[38:41] offset:3168
    ds_write_b128 v110, v[42:45] offset:7392
    s_cmp_eq_u32 s3, 2
    s_cbranch_scc0 L_es23
    s_waitcnt vmcnt(2)
    s_cmp_eq_u32 s3, 2
    s_cbranch_scc0 L_es23
    s_mov_b32 s29, 0
L_nz24:
    v_readfirstlane_b32 s30, v240
    v_readfirstlane_b32 s31, v241
    s_nop 0
    s_cmp_lg_u32 s31, 0
    s_cbranch_scc1 L_nz25
    s_add_u32 s29, s29, 1
    s_cmp_gt_u32 s29, 262144
    s_cbranch_scc1 L_nz25
    v_mov_b32 v242, 0
    global_load_dwordx2 v[240:241], v242, s[90:91] sc1
    s_waitcnt vmcnt(0)
    s_branch L_nz24
L_nz25:
    v_mov_b32 v242, 81552
    ds_write_b64 v242, v[240:241]
L_es23:
    s_waitcnt lgkmcnt(0)
    s_barrier
    s_cmp_eq_u32 s3, 2
    s_cbranch_scc0 L_es26
    s_mul_i32 s43, s2, 64
    s_add_u32 s43, s43, 0xa00000
    s_mov_b64 exec, 1
    v_mov_b32 v242, s30
    v_mov_b32 v243, s31
    v_mov_b32 v244, 0
    buffer_store_dwordx2 v[242:243], v244, s[8:11], s43 offen sc1
    s_mov_b64 exec, -1
L_es26:
    s_mov_b32 exec_hi, 0xffff
    buffer_load_dword v254, v215, s[16:19], s37 offen
    s_mov_b64 exec, -1
    s_mov_b32 s4, s84
    s_mov_b32 s5, s85
    s_mov_b32 s6, 0x600000
    s_mov_b32 s7, 0x20000
    v_lshrrev_b32 v84, 3, v0
    v_lshlrev_b32 v3, 12, v84
    v_lshrrev_b32 v84, 1, v84
    v_bfe_u32 v85, v0, 1, 2
    v_xor_b32 v85, v85, v84
    v_lshl_add_u32 v3, v85, 5, v3
    v_and_b32 v84, 1, v0
    v_lshl_add_u32 v3, v84, 4, v3
    v_add_u32 v4, 31744, v3
    v_add_u32 v252, 63488, v3
    v_add_u32 v253, 95232, v3
    s_mul_i32 s34, s3, 1572864
    s_lshl_b32 s42, s26, 7
    s_add_u32 s34, s34, s42
    v_bfe_u32 v84, v0, 2, 2
    v_bfe_u32 v85, v0, 4, 1
    v_lshrrev_b32 v86, 5, v0
    v_lshl_add_u32 v86, v86, 4, v84
    v_lshl_add_u32 v86, v85, 2, v86
    v_lshlrev_b32 v86, 7, v86
    v_lshrrev_b32 v84, 1, v84
    v_lshl_or_b32 v84, v85, 1, v84
    v_xor_b32 v84, s3, v84
    v_lshl_add_u32 v86, v84, 5, v86
    v_and_b32 v84, 3, v0
    v_lshl_add_u32 v86, v84, 3, v86
    v_add_u32 v10, s32, v86
    v_xor_b32 v11, 32, v10
    v_xor_b32 v12, 64, v10
    v_xor_b32 v13, 96, v10
    s_lshr_b32 s63, s40, 1
    s_lshl_b32 s63, s63, 10
    s_and_b32 s43, s40, 1
    v_lshrrev_b32 v86, 9, v88
    v_mul_u32_u24 v86, 384, v86
    v_bfe_u32 v87, v88, 3, 6
    v_add_u32 v86, v86, v87
    v_add_u32 v86, 0, v86
    v_lshlrev_b32 v86, 12, v86
    v_and_b32 v85, 7, v88
    v_lshl_add_u32 v86, v85, 7, v86
    v_add_u32 v87, 1, v85
    v_lshrrev_b32 v87, 3, v87
    v_lshrrev_b32 v85, 2, v85
    v_xor_b32 v85, v87, v85
    v_xor_b32 v85, s43, v85
    v_xor_b32 v87, 1, v85
    s_mov_b32 s44, 786432
    v_mad_u32_u24 v212, v85, s44, v86
    v_mad_u32_u24 v218, v87, s44, v86
    v_lshrrev_b32 v86, 9, v88
    v_mul_u32_u24 v86, 384, v86
    v_bfe_u32 v87, v88, 3, 6
    v_add_u32 v86, v86, v87
    v_add_u32 v86, 64, v86
    v_lshlrev_b32 v86, 12, v86
    v_and_b32 v85, 7, v88
    v_lshl_add_u32 v86, v85, 7, v86
    v_add_u32 v87, 1, v85
    v_lshrrev_b32 v87, 3, v87
    v_lshrrev_b32 v85, 2, v85
    v_xor_b32 v85, v87, v85
    v_xor_b32 v85, s43, v85
    v_xor_b32_e64 v87, 1, v85
    s_mov_b32 s44, 786432
    v_mad_u32_u24 v213, v85, s44, v86
    v_mad_u32_u24 v219, v87, s44, v86
    v_lshrrev_b32 v86, 9, v88
    v_mul_u32_u24 v86, 384, v86
    v_bfe_u32 v87, v88, 3, 6
    v_add_u32 v86, v86, v87
    v_add_u32 v86, 128, v86
    v_lshlrev_b32 v86, 12, v86
    v_and_b32 v85, 7, v88
    v_lshl_add_u32 v86, v85, 7, v86
    v_add_u32 v87, 1, v85
    v_lshrrev_b32 v87, 3, v87
    v_lshrrev_b32 v85, 2, v85
    v_xor_b32 v85, v87, v85
    v_xor_b32 v85, s43, v85
    v_xor_b32 v87, 1, v85
    s_mov_b32 s44, 786432
    v_mad_u32_u24 v214, v85, s44, v86
    v_mad_u32_u24 v220, v87, s44, v86
    v_add_u32_e64 v85, 0, v88
    v_min_u32 v85, 10239, v85
    s_mov_b32 s44, 107374183
    v_mul_hi_u32 v86, s44, v85
    v_mul_u32_u24 v87, 40, v86
    v_sub_u32 v85, v85, v87
    v_lshlrev_b32 v85, 7, v85
    v_and_b32 v87, 3, v86
    v_mul_u32_u24 v89, 5120, v87
    v_add_u32 v85, v85, v89
    v_lshrrev_b32 v89, 4, v86
    v_add_u32 v89, 0, v89
    s_mov_b32 exec_hi, 0xffff
    buffer_load_dword v254, v216, s[16:19], s37 offen
    s_mov_b64 exec, -1
    v_and_b32 v87, 7, v89
    v_and_b32 v89, 8, v89
    s_and_b32 s44, s40, 1
    s_lshl_b32 s44, s44, 3
    v_xor_b32 v89, s44, v89
    v_or_b32 v87, v87, v89
    v_bfe_u32 v86, v86, 2, 2
    v_lshl_add_u32 v87, v86, 4, v87
    v_mul_u32_u24 v87, 40960, v87
    v_add_u32_e64 v221, v85, v87
    v_add_u32 v85, 2048, v88
    v_min_u32 v85, 10239, v85
    s_mov_b32 s44, 107374183
    v_mul_hi_u32 v86, s44, v85
    v_mul_u32_u24 v87, 40, v86
    v_sub_u32 v85, v85, v87
    v_lshlrev_b32 v85, 7, v85
    v_and_b32 v87, 3, v86
    v_mul_u32_u24 v89, 5120, v87
    v_add_u32 v85, v85, v89
    v_lshrrev_b32 v89, 4, v86
    v_add_u32 v89, 0, v89
    v_and_b32 v87, 7, v89
    v_and_b32 v89, 8, v89
    s_and_b32 s44, s40, 1
    s_lshl_b32 s44, s44, 3
    v_xor_b32 v89, s44, v89
    v_or_b32_e64 v87, v87, v89
    v_bfe_u32 v86, v86, 2, 2
    v_lshl_add_u32 v87, v86, 4, v87
    v_mul_u32_u24 v87, 40960, v87
    v_add_u32_e64 v222, v85, v87
    v_add_u32 v85, 4096, v88
    v_min_u32 v85, 10239, v85
    s_mov_b32 s44, 107374183
    v_mul_hi_u32 v86, s44, v85
    v_mul_u32_u24 v87, 40, v86
    v_sub_u32 v85, v85, v87
    v_lshlrev_b32 v85, 7, v85
    v_and_b32 v87, 3, v86
    v_mul_u32_u24 v89, 5120, v87
    v_add_u32 v85, v85, v89
    v_lshrrev_b32 v89, 4, v86
    v_add_u32 v89, 0, v89
    v_and_b32 v87, 7, v89
    v_and_b32 v89, 8, v89
    s_and_b32 s44, s40, 1
    s_lshl_b32 s44, s44, 3
    v_xor_b32 v89, s44, v89
    v_or_b32_e64 v87, v87, v89
    v_bfe_u32 v86, v86, 2, 2
    v_lshl_add_u32 v87, v86, 4, v87
    v_mul_u32_u24 v87, 40960, v87
    v_add_u32_e64 v223, v85, v87
    v_add_u32 v85, 6144, v88
    v_min_u32 v85, 10239, v85
    s_mov_b32 s44, 107374183
    v_mul_hi_u32 v86, s44, v85
    v_mul_u32_u24 v87, 40, v86
    v_sub_u32 v85, v85, v87
    v_lshlrev_b32 v85, 7, v85
    v_and_b32 v87, 3, v86
    v_mul_u32_u24 v89, 5120, v87
    v_add_u32 v85, v85, v89
    v_lshrrev_b32 v89, 4, v86
    v_add_u32 v89, 0, v89
    v_and_b32 v87, 7, v89
    v_and_b32 v89, 8, v89
    s_and_b32 s44, s40, 1
    s_lshl_b32 s44, s44, 3
    v_xor_b32 v89, s44, v89
    v_or_b32_e64 v87, v87, v89
    v_bfe_u32 v86, v86, 2, 2
    v_lshl_add_u32 v87, v86, 4, v87
    v_mul_u32_u24 v87, 40960, v87
    v_add_u32_e64 v224, v85, v87
    v_add_u32 v85, 8192, v88
    v_min_u32 v85, 10239, v85
    s_mov_b32 s44, 107374183
    v_mul_hi_u32 v86, s44, v85
    v_mul_u32_u24 v87, 40, v86
    v_sub_u32 v85, v85, v87
    v_lshlrev_b32 v85, 7, v85
    v_and_b32 v87, 3, v86
    v_mul_u32_u24 v89, 5120, v87
    v_add_u32 v85, v85, v89
    v_lshrrev_b32 v89, 4, v86
    v_add_u32 v89, 0, v89
    v_and_b32 v87, 7, v89
    v_and_b32 v89, 8, v89
    s_and_b32 s44, s40, 1
    s_lshl_b32 s44, s44, 3
    v_xor_b32 v89, s44, v89
    v_or_b32_e64 v87, v87, v89
    v_bfe_u32 v86, v86, 2, 2
    v_lshl_add_u32 v87, v86, 4, v87
    v_mul_u32_u24 v87, 40960, v87
    v_add_u32 v225, v85, v87
    s_and_b32 s49, s40, 1
    s_mul_i32 s49, s49, 20480
    s_waitcnt lgkmcnt(0)
    buffer_load_dword v254, v212, s[4:7], s63 offen
    ds_read_b64_tr_b16 v[180:181], v160 offset:8448
    ds_read_b64_tr_b16 v[182:183], v160 offset:8480
    ds_read_b64_tr_b16 v[184:185], v160 offset:0
    ds_read_b64_tr_b16 v[186:187], v160 offset:32
    v_lshlrev_b32 v100, 16, v100
    v_lshlrev_b32 v101, 16, v101
    v_lshlrev_b32 v102, 16, v102
    v_lshlrev_b32 v103, 16, v103
    v_mul_f32 v30, s56, v100
    v_fma_f32 v31, v100, s56, -v30
    s_waitcnt lgkmcnt(0)
    ds_read_b64_tr_b16 v[188:189], v160 offset:8576
    ds_read_b64_tr_b16 v[190:191], v160 offset:8608
    ds_read_b64_tr_b16 v[192:193], v160 offset:128
    ds_read_b64_tr_b16 v[194:195], v160 offset:160
    v_mfma_f32_32x32x16_bf16 v[164:179], v[180:183], v[184:187], 0
    v_fma_f32 v31, v100, s57, v31
    v_exp_f32 v16, v30
    v_mul_f32_e64 v31, s58, v31
    v_fma_f32 v16, v16, v31, v16
    v_pk_mul_f32 v[18:19], v[102:103], v[108:109] op_sel:[0,1] op_sel_hi:[1,1]
    v_cvt_pk_bf16_f32 v16, v16, v16
    s_waitcnt lgkmcnt(0)
    ds_read_b64_tr_b16 v[180:181], v160 offset:8704
    ds_read_b64_tr_b16 v[182:183], v160 offset:8736
    ds_read_b64_tr_b16 v[184:185], v160 offset:256
    ds_read_b64_tr_b16 v[186:187], v160 offset:288
    v_mfma_f32_32x32x16_bf16 v[164:179], v[188:191], v[192:195], v[164:179]
    v_and_b32 v16, 0xffff0000, v16
    v_mul_f32 v17, v101, v108
    v_mul_f32 v16, v16, v108
    v_mul_f32 v17, 0.15915494, v17
    v_mul_f32 v16, 0xbfb8aa3b, v16
    v_fract_f32 v31, v17
    v_exp_f32 v30, v16
    s_waitcnt lgkmcnt(0)
    ds_read_b64_tr_b16 v[188:189], v160 offset:8832
    ds_read_b64_tr_b16 v[190:191], v160 offset:8864
    ds_read_b64_tr_b16 v[192:193], v160 offset:384
    ds_read_b64_tr_b16 v[194:195], v160 offset:416
    v_mfma_f32_32x32x16_bf16 v[164:179], v[180:183], v[184:187], v[164:179]
    v_cos_f32 v20, v31
    v_sin_f32 v21, v31
    s_nop 0
    v_pk_mul_f32 v[20:21], v[20:21], v[30:31] op_sel_hi:[1,0]
    v_mul_f32 v30, 0x43800000, v16
    v_mul_f32 v31, 0x43800000, v17
    v_fract_f32 v31, v31
    s_waitcnt lgkmcnt(0)
    ds_read_b64_tr_b16 v[180:181], v160 offset:8960
    ds_read_b64_tr_b16 v[182:183], v160 offset:8992
    ds_read_b64_tr_b16 v[184:185], v160 offset:512
    ds_read_b64_tr_b16 v[186:187], v160 offset:544
    v_mfma_f32_32x32x16_bf16 v[164:179], v[188:191], v[192:195], v[164:179]
    v_exp_f32 v30, v30
    v_cos_f32 v28, v31
    v_sin_f32 v29, v31
    s_nop 0
    v_pk_mul_f32 v[28:29], v[28:29], v[30:31] op_sel_hi:[1,0]
    v_mul_f32 v30, 0x41000000, v16
    v_mul_f32 v31, 0x41000000, v17
    v_fract_f32 v31, v31
    s_waitcnt lgkmcnt(0)
    ds_read_b64_tr_b16 v[188:189], v160 offset:9088
    ds_read_b64_tr_b16 v[190:191], v160 offset:9120
    ds_read_b64_tr_b16 v[192:193], v160 offset:640
    ds_read_b64_tr_b16 v[194:195], v160 offset:672
    v_mfma_f32_32x32x16_bf16 v[164:179], v[180:183], v[184:187], v[164:179]
    v_exp_f32 v30, v30
    v_cos_f32 v26, v31
    v_sin_f32 v27, v31
    s_nop 0
    v_pk_mul_f32 v[26:27], v[26:27], v[30:31] op_sel_hi:[1,0]
    v_pk_mul_f32 v[30:31], v[20:21], v[20:21] op_sel_hi:[1,0]
    v_pk_fma_f32 v[22:23], v[20:21], v[20:21], v[30:31] op_sel:[1,1,0] op_sel_hi:[0,1,1] neg_lo:[1,0,0]
    s_waitcnt lgkmcnt(0)
    ds_read_b64_tr_b16 v[180:181], v160 offset:9216
    ds_read_b64_tr_b16 v[182:183], v160 offset:9248
    ds_read_b64_tr_b16 v[184:185], v160 offset:768
    ds_read_b64_tr_b16 v[186:187], v160 offset:800
    v_mfma_f32_32x32x16_bf16 v[164:179], v[188:191], v[192:195], v[164:179]
    s_nop 0
    v_pk_mul_f32 v[30:31], v[22:23], v[22:23] op_sel_hi:[1,0]
    v_pk_fma_f32 v[24:25], v[22:23], v[22:23], v[30:31] op_sel:[1,1,0] op_sel_hi:[0,1,1] neg_lo:[1,0,0]
    v_add_u32 v6, 9216, v1
    global_load_dwordx4 v[148:151], v6, s[50:51] offset:0
    global_load_dwordx4 v[152:155], v6, s[50:51] offset:1024
    global_load_dwordx4 v[156:159], v6, s[50:51] offset:2048
    v_pk_mul_f32 v[30:31], v[18:19], v[20:21] op_sel_hi:[1,0]
    v_pk_fma_f32 v[34:35], v[18:19], v[20:21], v[30:31] op_sel:[1,1,0] op_sel_hi:[0,1,1] neg_lo:[1,0,0]
    v_cvt_pk_bf16_f32 v38, v18, v34
    v_cvt_pk_bf16_f32 v42, -v19, -v35
    v_pk_mul_f32 v[30:31], v[34:35], v[20:21] op_sel_hi:[1,0]
    s_waitcnt lgkmcnt(0)
    ds_read_b64_tr_b16 v[188:189], v160 offset:9344
    ds_read_b64_tr_b16 v[190:191], v160 offset:9376
    ds_read_b64_tr_b16 v[192:193], v160 offset:896
    ds_read_b64_tr_b16 v[194:195], v160 offset:928
    v_mfma_f32_32x32x16_bf16 v[164:179], v[180:183], v[184:187], v[164:179]
    s_nop 0
    v_pk_fma_f32 v[32:33], v[34:35], v[20:21], v[30:31] op_sel:[1,1,0] op_sel_hi:[0,1,1] neg_lo:[1,0,0]
    v_pk_mul_f32 v[30:31], v[32:33], v[20:21] op_sel_hi:[1,0]
    v_pk_fma_f32 v[34:35], v[32:33], v[20:21], v[30:31] op_sel:[1,1,0] op_sel_hi:[0,1,1] neg_lo:[1,0,0]
    v_cvt_pk_bf16_f32 v39, v32, v34
    v_cvt_pk_bf16_f32 v43, -v33, -v35
    v_pk_mul_f32 v[30:31], v[34:35], v[20:21] op_sel_hi:[1,0]
    s_waitcnt lgkmcnt(0)
    v_mfma_f32_32x32x16_bf16 v[164:179], v[188:191], v[192:195], v[164:179]
    s_nop 0
    v_pk_fma_f32 v[32:33], v[34:35], v[20:21], v[30:31] op_sel:[1,1,0] op_sel_hi:[0,1,1] neg_lo:[1,0,0]
    v_pk_mul_f32 v[30:31], v[32:33], v[20:21] op_sel_hi:[1,0]
    v_pk_fma_f32 v[34:35], v[32:33], v[20:21], v[30:31] op_sel:[1,1,0] op_sel_hi:[0,1,1] neg_lo:[1,0,0]
    v_cvt_pk_bf16_f32 v40, v32, v34
    v_cvt_pk_bf16_f32 v44, -v33, -v35
    v_pk_mul_f32 v[30:31], v[34:35], v[20:21] op_sel_hi:[1,0]
    v_pk_fma_f32 v[32:33], v[34:35], v[20:21], v[30:31] op_sel:[1,1,0] op_sel_hi:[0,1,1] neg_lo:[1,0,0]
    v_pk_mul_f32 v[30:31], v[32:33], v[20:21] op_sel_hi:[1,0]
    v_pk_fma_f32 v[34:35], v[32:33], v[20:21], v[30:31] op_sel:[1,1,0] op_sel_hi:[0,1,1] neg_lo:[1,0,0]
    v_cvt_pk_bf16_f32 v41, v32, v34
    v_cvt_pk_bf16_f32 v45, -v33, -v35
    ds_write_b128 v110, v[38:41] offset:8448
    ds_write_b128 v110, v[42:45] offset:12672
    v_pk_mul_f32 v[30:31], v[18:19], v[28:29] op_sel_hi:[1,0]
    v_pk_fma_f32 v[36:37], v[18:19], v[28:29], v[30:31] op_sel:[1,1,0] op_sel_hi:[0,1,1] neg_lo:[1,0,0]
    v_pk_mul_f32 v[30:31], v[36:37], v[22:23] op_sel_hi:[1,0]
    v_pk_fma_f32 v[34:35], v[36:37], v[22:23], v[30:31] op_sel:[1,1,0] op_sel_hi:[0,1,1] neg_lo:[1,0,0]
    v_cvt_pk_bf16_f32 v46, v36, v34
    v_cvt_pk_bf16_f32 v50, -v37, -v35
    v_pk_mul_f32 v[30:31], v[34:35], v[22:23] op_sel_hi:[1,0]
    v_pk_fma_f32 v[32:33], v[34:35], v[22:23], v[30:31] op_sel:[1,1,0] op_sel_hi:[0,1,1] neg_lo:[1,0,0]
    v_pk_mul_f32 v[30:31], v[32:33], v[22:23] op_sel_hi:[1,0]
    v_pk_fma_f32 v[34:35], v[32:33], v[22:23], v[30:31] op_sel:[1,1,0] op_sel_hi:[0,1,1] neg_lo:[1,0,0]
    v_cvt_pk_bf16_f32 v47, v32, v34
    v_cvt_pk_bf16_f32 v51, -v33, -v35
    v_pk_mul_f32 v[30:31], v[36:37], v[28:29] op_sel_hi:[1,0]
    v_pk_fma_f32 v[36:37], v[36:37], v[28:29], v[30:31] op_sel:[1,1,0] op_sel_hi:[0,1,1] neg_lo:[1,0,0]
    v_pk_mul_f32 v[30:31], v[36:37], v[24:25] op_sel_hi:[1,0]
    v_pk_fma_f32 v[34:35], v[36:37], v[24:25], v[30:31] op_sel:[1,1,0] op_sel_hi:[0,1,1] neg_lo:[1,0,0]
    v_cvt_pk_bf16_f32 v48, v36, v34
    v_cvt_pk_bf16_f32 v52, -v37, -v35
    v_pk_mul_f32 v[30:31], v[36:37], v[28:29] op_sel_hi:[1,0]
    v_pk_fma_f32 v[36:37], v[36:37], v[28:29], v[30:31] op_sel:[1,1,0] op_sel_hi:[0,1,1] neg_lo:[1,0,0]
    v_pk_mul_f32 v[30:31], v[36:37], v[24:25] op_sel_hi:[1,0]
    v_pk_fma_f32 v[34:35], v[36:37], v[24:25], v[30:31] op_sel:[1,1,0] op_sel_hi:[0,1,1] neg_lo:[1,0,0]
    v_cvt_pk_bf16_f32 v49, v36, v34
    v_cvt_pk_bf16_f32 v53, -v37, -v35
    ds_write_b128 v110, v[46:49] offset:9504
    ds_write_b128 v110, v[50:53] offset:13728
    v_pk_mul_f32 v[30:31], v[36:37], v[28:29] op_sel_hi:[1,0]
    v_pk_fma_f32 v[32:33], v[36:37], v[28:29], v[30:31] op_sel:[1,1,0] op_sel_hi:[0,1,1] neg_lo:[1,0,0]
    v_pk_mul_f32 v[30:31], v[32:33], v[28:29] op_sel_hi:[1,0]
    v_pk_fma_f32 v[34:35], v[32:33], v[28:29], v[30:31] op_sel:[1,1,0] op_sel_hi:[0,1,1] neg_lo:[1,0,0]
    v_cvt_pk_bf16_f32 v38, v32, v34
    v_cvt_pk_bf16_f32 v42, -v33, -v35
    v_pk_mul_f32 v[30:31], v[34:35], v[28:29] op_sel_hi:[1,0]
    v_pk_fma_f32 v[32:33], v[34:35], v[28:29], v[30:31] op_sel:[1,1,0] op_sel_hi:[0,1,1] neg_lo:[1,0,0]
    v_pk_mul_f32 v[30:31], v[32:33], v[28:29] op_sel_hi:[1,0]
    v_pk_fma_f32 v[34:35], v[32:33], v[28:29], v[30:31] op_sel:[1,1,0] op_sel_hi:[0,1,1] neg_lo:[1,0,0]
    v_cvt_pk_bf16_f32 v39, v32, v34
    v_cvt_pk_bf16_f32 v43, -v33, -v35
    v_pk_mul_f32 v[30:31], v[34:35], v[28:29] op_sel_hi:[1,0]
    v_pk_fma_f32 v[32:33], v[34:35], v[28:29], v[30:31] op_sel:[1,1,0] op_sel_hi:[0,1,1] neg_lo:[1,0,0]
    v_cvt_pk_bf16_f32 v40, v32, 0
    v_cvt_pk_bf16_f32 v44, -v33, 0
    ds_write_b128 v110, v[38:41] offset:10560
    ds_write_b128 v110, v[42:45] offset:14784
    v_cvt_pk_bf16_f32 v46, 1.0, v26
    v_cvt_pk_bf16_f32 v50, 0, v27
    v_pk_mul_f32 v[30:31], v[26:27], v[26:27] op_sel_hi:[1,0]
    v_pk_fma_f32 v[32:33], v[26:27], v[26:27], v[30:31] op_sel:[1,1,0] op_sel_hi:[0,1,1] neg_lo:[1,0,0]
    v_pk_mul_f32 v[30:31], v[32:33], v[26:27] op_sel_hi:[1,0]
    v_pk_fma_f32 v[34:35], v[32:33], v[26:27], v[30:31] op_sel:[1,1,0] op_sel_hi:[0,1,1] neg_lo:[1,0,0]
    v_cvt_pk_bf16_f32 v47, v32, v34
    v_cvt_pk_bf16_f32 v51, v33, v35
    v_pk_mul_f32 v[30:31], v[34:35], v[26:27] op_sel_hi:[1,0]
    v_pk_fma_f32 v[32:33], v[34:35], v[26:27], v[30:31] op_sel:[1,1,0] op_sel_hi:[0,1,1] neg_lo:[1,0,0]
    v_pk_mul_f32 v[30:31], v[32:33], v[26:27] op_sel_hi:[1,0]
    v_pk_fma_f32 v[34:35], v[32:33], v[26:27], v[30:31] op_sel:[1,1,0] op_sel_hi:[0,1,1] neg_lo:[1,0,0]
    v_cvt_pk_bf16_f32 v48, v32, v34
    v_cvt_pk_bf16_f32 v52, v33, v35
    v_pk_mul_f32 v[30:31], v[34:35], v[26:27] op_sel_hi:[1,0]
    v_pk_fma_f32 v[32:33], v[34:35], v[26:27], v[30:31] op_sel:[1,1,0] op_sel_hi:[0,1,1] neg_lo:[1,0,0]
    v_pk_mul_f32 v[30:31], v[32:33], v[26:27] op_sel_hi:[1,0]
    v_pk_fma_f32 v[34:35], v[32:33], v[26:27], v[30:31] op_sel:[1,1,0] op_sel_hi:[0,1,1] neg_lo:[1,0,0]
    v_cvt_pk_bf16_f32 v49, v32, v34
    v_cvt_pk_bf16_f32 v53, v33, v35
    ds_write_b128 v110, v[46:49] offset:0
    ds_write_b128 v110, v[50:53] offset:4224
    v_pk_mul_f32 v[30:31], v[34:35], v[26:27] op_sel_hi:[1,0]
    v_pk_fma_f32 v[32:33], v[34:35], v[26:27], v[30:31] op_sel:[1,1,0] op_sel_hi:[0,1,1] neg_lo:[1,0,0]
    v_pk_mul_f32 v[30:31], v[32:33], v[26:27] op_sel_hi:[1,0]
    v_pk_fma_f32 v[34:35], v[32:33], v[26:27], v[30:31] op_sel:[1,1,0] op_sel_hi:[0,1,1] neg_lo:[1,0,0]
    v_cvt_pk_bf16_f32 v38, v32, v34
    v_cvt_pk_bf16_f32 v42, v33, v35
    v_pk_mul_f32 v[30:31], v[34:35], v[26:27] op_sel_hi:[1,0]
    v_pk_fma_f32 v[32:33], v[34:35], v[26:27], v[30:31] op_sel:[1,1,0] op_sel_hi:[0,1,1] neg_lo:[1,0,0]
    v_pk_mul_f32 v[30:31], v[32:33], v[26:27] op_sel_hi:[1,0]
    v_pk_fma_f32 v[34:35], v[32:33], v[26:27], v[30:31] op_sel:[1,1,0] op_sel_hi:[0,1,1] neg_lo:[1,0,0]
    v_cvt_pk_bf16_f32 v39, v32, v34
    v_cvt_pk_bf16_f32 v43, v33, v35
    v_pk_mul_f32 v[30:31], v[34:35], v[26:27] op_sel_hi:[1,0]
    v_pk_fma_f32 v[32:33], v[34:35], v[26:27], v[30:31] op_sel:[1,1,0] op_sel_hi:[0,1,1] neg_lo:[1,0,0]
    v_pk_mul_f32 v[30:31], v[32:33], v[26:27] op_sel_hi:[1,0]
    v_pk_fma_f32 v[34:35], v[32:33], v[26:27], v[30:31] op_sel:[1,1,0] op_sel_hi:[0,1,1] neg_lo:[1,0,0]
    v_cvt_pk_bf16_f32 v40, v32, v34
    v_cvt_pk_bf16_f32 v44, v33, v35
    v_pk_mul_f32 v[30:31], v[34:35], v[26:27] op_sel_hi:[1,0]
    v_pk_fma_f32 v[32:33], v[34:35], v[26:27], v[30:31] op_sel:[1,1,0] op_sel_hi:[0,1,1] neg_lo:[1,0,0]
    v_pk_mul_f32 v[30:31], v[32:33], v[26:27] op_sel_hi:[1,0]
    v_pk_fma_f32 v[34:35], v[32:33], v[26:27], v[30:31] op_sel:[1,1,0] op_sel_hi:[0,1,1] neg_lo:[1,0,0]
    v_cvt_pk_bf16_f32 v41, v32, v34
    v_cvt_pk_bf16_f32 v45, v33, v35
    ds_write_b128 v110, v[38:41] offset:1056
    ds_write_b128 v110, v[42:45] offset:5280
    v_pk_mul_f32 v[30:31], v[34:35], v[26:27] op_sel_hi:[1,0]
    v_pk_fma_f32 v[32:33], v[34:35], v[26:27], v[30:31] op_sel:[1,1,0] op_sel_hi:[0,1,1] neg_lo:[1,0,0]
    v_pk_mul_f32 v[30:31], v[32:33], v[26:27] op_sel_hi:[1,0]
    v_pk_fma_f32 v[34:35], v[32:33], v[26:27], v[30:31] op_sel:[1,1,0] op_sel_hi:[0,1,1] neg_lo:[1,0,0]
    v_cvt_pk_bf16_f32 v46, v32, v34
    v_cvt_pk_bf16_f32 v50, v33, v35
    v_pk_mul_f32 v[30:31], v[34:35], v[26:27] op_sel_hi:[1,0]
    v_pk_fma_f32 v[32:33], v[34:35], v[26:27], v[30:31] op_sel:[1,1,0] op_sel_hi:[0,1,1] neg_lo:[1,0,0]
    v_pk_mul_f32 v[30:31], v[32:33], v[26:27] op_sel_hi:[1,0]
    v_pk_fma_f32 v[34:35], v[32:33], v[26:27], v[30:31] op_sel:[1,1,0] op_sel_hi:[0,1,1] neg_lo:[1,0,0]
    v_cvt_pk_bf16_f32 v47, v32, v34
    v_cvt_pk_bf16_f32 v51, v33, v35
    v_pk_mul_f32 v[30:31], v[34:35], v[26:27] op_sel_hi:[1,0]
    v_pk_fma_f32 v[32:33], v[34:35], v[26:27], v[30:31] op_sel:[1,1,0] op_sel_hi:[0,1,1] neg_lo:[1,0,0]
    v_pk_mul_f32 v[30:31], v[32:33], v[26:27] op_sel_hi:[1,0]
    v_pk_fma_f32 v[34:35], v[32:33], v[26:27], v[30:31] op_sel:[1,1,0] op_sel_hi:[0,1,1] neg_lo:[1,0,0]
    v_cvt_pk_bf16_f32 v48, v32, v34
    v_cvt_pk_bf16_f32 v52, v33, v35
    v_pk_mul_f32 v[30:31], v[34:35], v[26:27] op_sel_hi:[1,0]
    v_pk_fma_f32 v[32:33], v[34:35], v[26:27], v[30:31] op_sel:[1,1,0] op_sel_hi:[0,1,1] neg_lo:[1,0,0]
    v_pk_mul_f32 v[30:31], v[32:33], v[26:27] op_sel_hi:[1,0]
    v_pk_fma_f32 v[34:35], v[32:33], v[26:27], v[30:31] op_sel:[1,1,0] op_sel_hi:[0,1,1] neg_lo:[1,0,0]
    v_cvt_pk_bf16_f32 v49, v32, v34
    v_cvt_pk_bf16_f32 v53, v33, v35
    ds_write_b128 v110, v[46:49] offset:2112
    ds_write_b128 v110, v[50:53] offset:6336
    v_pk_mul_f32 v[30:31], v[34:35], v[26:27] op_sel_hi:[1,0]
    v_pk_fma_f32 v[32:33], v[34:35], v[26:27], v[30:31] op_sel:[1,1,0] op_sel_hi:[0,1,1] neg_lo:[1,0,0]
    v_pk_mul_f32 v[30:31], v[32:33], v[26:27] op_sel_hi:[1,0]
    v_pk_fma_f32 v[34:35], v[32:33], v[26:27], v[30:31] op_sel:[1,1,0] op_sel_hi:[0,1,1] neg_lo:[1,0,0]
    v_cvt_pk_bf16_f32 v38, v32, v34
    v_cvt_pk_bf16_f32 v42, v33, v35
    v_pk_mul_f32 v[30:31], v[34:35], v[26:27] op_sel_hi:[1,0]
    v_pk_fma_f32 v[32:33], v[34:35], v[26:27], v[30:31] op_sel:[1,1,0] op_sel_hi:[0,1,1] neg_lo:[1,0,0]
    v_pk_mul_f32 v[30:31], v[32:33], v[26:27] op_sel_hi:[1,0]
    v_pk_fma_f32 v[34:35], v[32:33], v[26:27], v[30:31] op_sel:[1,1,0] op_sel_hi:[0,1,1] neg_lo:[1,0,0]
    v_cvt_pk_bf16_f32 v39, v32, v34
    v_cvt_pk_bf16_f32 v43, v33, v35
    v_pk_mul_f32 v[30:31], v[34:35], v[26:27] op_sel_hi:[1,0]
    v_pk_fma_f32 v[32:33], v[34:35], v[26:27], v[30:31] op_sel:[1,1,0] op_sel_hi:[0,1,1] neg_lo:[1,0,0]
    v_pk_mul_f32 v[30:31], v[32:33], v[26:27] op_sel_hi:[1,0]
    v_pk_fma_f32 v[34:35], v[32:33], v[26:27], v[30:31] op_sel:[1,1,0] op_sel_hi:[0,1,1] neg_lo:[1,0,0]
    v_cvt_pk_bf16_f32 v40, v32, v34
    v_cvt_pk_bf16_f32 v44, v33, v35
    v_pk_mul_f32 v[30:31], v[34:35], v[26:27] op_sel_hi:[1,0]
    v_pk_fma_f32 v[32:33], v[34:35], v[26:27], v[30:31] op_sel:[1,1,0] op_sel_hi:[0,1,1] neg_lo:[1,0,0]
    v_pk_mul_f32 v[30:31], v[32:33], v[26:27] op_sel_hi:[1,0]
    v_pk_fma_f32 v[34:35], v[32:33], v[26:27], v[30:31] op_sel:[1,1,0] op_sel_hi:[0,1,1] neg_lo:[1,0,0]
    v_cvt_pk_bf16_f32 v41, v32, v34
    v_cvt_pk_bf16_f32 v45, v33, v35
    ds_write_b128 v110, v[38:41] offset:3168
    ds_write_b128 v110, v[42:45] offset:7392
    s_waitcnt lgkmcnt(0)
    s_lshl_b32 s42, s3, 6
    v_add_u32 v84, s42, v0
    v_mul_u32_u24 v84, 64, v84
    s_mov_b32 s45, 0xa00000
    v_lshrrev_b32 v72, 2, v0
    s_lshl_b32 s42, s3, 6
    v_add_u32 v72, s42, v72
    v_lshrrev_b32 v73, 2, v72
    v_mul_u32_u24 v73, 40960, v73
    v_and_b32 v75, 3, v72
    v_lshl_add_u32 v73, v75, 8, v73
    v_and_b32 v75, 3, v0
    v_lshl_add_u32 v73, v75, 4, v73
    v_mul_u32_u24 v75, 16384, v75
    v_lshl_add_u32 v74, v72, 4, v75
    v_add_u32 v74, 77408, v74
    v_lshlrev_b32 v72, 5, v72
    v_mov_b32 v242, 81552
    ds_read_b64 v[240:241], v242
    s_waitcnt lgkmcnt(0)
    v_readfirstlane_b32 s30, v240
    v_readfirstlane_b32 s31, v241
    s_mov_b32 s29, 0
L_pl27:
    buffer_load_dwordx2 v[242:243], v84, s[8:11], s45 offen sc1
    s_add_u32 s29, s29, 1
    s_cmp_gt_u32 s29, 262144
    s_cbranch_scc1 L_pl28
    s_waitcnt vmcnt(0)
    v_cmp_ne_u64 vcc, s[30:31], v[242:243]
    s_cbranch_vccz L_pl28
    s_branch L_pl27
L_pl28:
    s_barrier
    buffer_load_dword v254, v221, s[8:11], s49 offen sc1
    ds_read_b64_tr_b16 v[180:181], v160 offset:8448
    ds_read_b64_tr_b16 v[182:183], v160 offset:8480
    ds_read_b64_tr_b16 v[184:185], v160 offset:0
    ds_read_b64_tr_b16 v[186:187], v160 offset:32
    v_lshlrev_b32 v104, 16, v104
    v_lshlrev_b32 v105, 16, v105
    v_lshlrev_b32 v106, 16, v106
    v_lshlrev_b32 v107, 16, v107
    v_mul_f32 v30, s56, v104
    v_fma_f32 v31, v104, s56, -v30
    s_waitcnt lgkmcnt(0)
    ds_read_b64_tr_b16 v[188:189], v160 offset:8576
    ds_read_b64_tr_b16 v[190:191], v160 offset:8608
    ds_read_b64_tr_b16 v[192:193], v160 offset:128
    ds_read_b64_tr_b16 v[194:195], v160 offset:160
    v_mfma_f32_32x32x16_bf16 v[164:179], v[180:183], v[184:187], v[164:179]
    v_fma_f32 v31, v104, s57, v31
    v_exp_f32 v16, v30
    v_mul_f32 v31, s58, v31
    v_fma_f32 v16, v16, v31, v16
    v_pk_mul_f32 v[18:19], v[106:107], v[108:109] op_sel:[0,1] op_sel_hi:[1,1]
    v_cvt_pk_bf16_f32 v16, v16, v16
    s_waitcnt lgkmcnt(0)
    ds_read_b64_tr_b16 v[180:181], v160 offset:8704
    ds_read_b64_tr_b16 v[182:183], v160 offset:8736
    ds_read_b64_tr_b16 v[184:185], v160 offset:256
    ds_read_b64_tr_b16 v[186:187], v160 offset:288
    v_mfma_f32_32x32x16_bf16 v[164:179], v[188:191], v[192:195], v[164:179]
    v_and_b32 v16, 0xffff0000, v16
    v_mul_f32 v17, v105, v108
    v_mul_f32 v16, v16, v108
    v_mul_f32 v17, 0.15915494, v17
    v_mul_f32 v16, 0xbfb8aa3b, v16
    v_fract_f32 v31, v17
    v_exp_f32 v30, v16
    s_waitcnt lgkmcnt(0)
    ds_read_b64_tr_b16 v[188:189], v160 offset:8832
    ds_read_b64_tr_b16 v[190:191], v160 offset:8864
    ds_read_b64_tr_b16 v[192:193], v160 offset:384
    ds_read_b64_tr_b16 v[194:195], v160 offset:416
    v_mfma_f32_32x32x16_bf16 v[164:179], v[180:183], v[184:187], v[164:179]
    v_cos_f32 v20, v31
    v_sin_f32 v21, v31
    s_nop 0
    v_pk_mul_f32 v[20:21], v[20:21], v[30:31] op_sel_hi:[1,0]
    v_mul_f32 v30, 0x43800000, v16
    v_mul_f32 v31, 0x43800000, v17
    v_fract_f32 v31, v31
    s_waitcnt lgkmcnt(0)
    ds_read_b64_tr_b16 v[180:181], v160 offset:8960
    ds_read_b64_tr_b16 v[182:183], v160 offset:8992
    ds_read_b64_tr_b16 v[184:185], v160 offset:512
    ds_read_b64_tr_b16 v[186:187], v160 offset:544
    v_mfma_f32_32x32x16_bf16 v[164:179], v[188:191], v[192:195], v[164:179]
    v_exp_f32 v30, v30
    v_cos_f32 v28, v31
    v_sin_f32 v29, v31
    s_nop 0
    v_pk_mul_f32 v[28:29], v[28:29], v[30:31] op_sel_hi:[1,0]
    v_mul_f32 v30, 0x41000000, v16
    v_mul_f32 v31, 0x41000000, v17
    v_fract_f32 v31, v31
    s_waitcnt lgkmcnt(0)
    ds_read_b64_tr_b16 v[188:189], v160 offset:9088
    ds_read_b64_tr_b16 v[190:191], v160 offset:9120
    ds_read_b64_tr_b16 v[192:193], v160 offset:640
    ds_read_b64_tr_b16 v[194:195], v160 offset:672
    v_mfma_f32_32x32x16_bf16 v[164:179], v[180:183], v[184:187], v[164:179]
    v_exp_f32 v30, v30
    v_cos_f32 v26, v31
    v_sin_f32 v27, v31
    s_nop 0
    v_pk_mul_f32 v[26:27], v[26:27], v[30:31] op_sel_hi:[1,0]
    v_pk_mul_f32 v[30:31], v[20:21], v[20:21] op_sel_hi:[1,0]
    v_pk_fma_f32 v[22:23], v[20:21], v[20:21], v[30:31] op_sel:[1,1,0] op_sel_hi:[0,1,1] neg_lo:[1,0,0]
    s_waitcnt lgkmcnt(0)
    ds_read_b64_tr_b16 v[180:181], v160 offset:9216
    ds_read_b64_tr_b16 v[182:183], v160 offset:9248
    ds_read_b64_tr_b16 v[184:185], v160 offset:768
    ds_read_b64_tr_b16 v[186:187], v160 offset:800
    v_mfma_f32_32x32x16_bf16 v[164:179], v[188:191], v[192:195], v[164:179]
    v_pk_mul_f32 v[30:31], v[22:23], v[22:23] op_sel_hi:[1,0]
    v_pk_fma_f32 v[24:25], v[22:23], v[22:23], v[30:31] op_sel:[1,1,0] op_sel_hi:[0,1,1] neg_lo:[1,0,0]
    s_lshr_b32 s42, s28, 4
    s_lshl_b32 s42, s42, 10
    s_and_b32 s44, s28, 15
    s_lshl_b32 s44, s44, 4
    s_add_u32 s42, s42, s44
    s_mov_b32 s43, 0xa30000
    buffer_load_dwordx4 v[56:59], v73, s[8:11], s42 offen sc1
    s_add_u32 s42, s42, 163840
    buffer_load_dwordx4 v[60:63], v73, s[8:11], s42 offen sc1
    s_add_u32 s42, s42, 163840
    buffer_load_dwordx4 v[64:67], v73, s[8:11], s42 offen sc1
    s_add_u32 s42, s42, 163840
    buffer_load_dwordx4 v[68:71], v73, s[8:11], s42 offen sc1
    s_lshl_b32 s42, s3, 11
    s_add_u32 s43, s43, s42
    v_lshlrev_b32_e64 v91, 5, v0
    buffer_load_dwordx4 v[226:229], v91, s[8:11], s43 offen sc1
    buffer_load_dwordx4 v[230:233], v91, s[8:11], s43 offen offset:16 sc1
    v_pk_mul_f32 v[30:31], v[18:19], v[20:21] op_sel_hi:[1,0]
    v_pk_fma_f32 v[34:35], v[18:19], v[20:21], v[30:31] op_sel:[1,1,0] op_sel_hi:[0,1,1] neg_lo:[1,0,0]
    v_cvt_pk_bf16_f32 v38, v18, v34
    v_cvt_pk_bf16_f32 v42, -v19, -v35
    v_pk_mul_f32 v[30:31], v[34:35], v[20:21] op_sel_hi:[1,0]
    s_waitcnt lgkmcnt(0)
    ds_read_b64_tr_b16 v[188:189], v160 offset:9344
    ds_read_b64_tr_b16 v[190:191], v160 offset:9376
    ds_read_b64_tr_b16 v[192:193], v160 offset:896
    ds_read_b64_tr_b16 v[194:195], v160 offset:928
    v_mfma_f32_32x32x16_bf16 v[164:179], v[180:183], v[184:187], v[164:179]
    s_nop 0
    v_pk_fma_f32 v[32:33], v[34:35], v[20:21], v[30:31] op_sel:[1,1,0] op_sel_hi:[0,1,1] neg_lo:[1,0,0]
    v_pk_mul_f32 v[30:31], v[32:33], v[20:21] op_sel_hi:[1,0]
    v_pk_fma_f32 v[34:35], v[32:33], v[20:21], v[30:31] op_sel:[1,1,0] op_sel_hi:[0,1,1] neg_lo:[1,0,0]
    v_cvt_pk_bf16_f32 v39, v32, v34
    v_cvt_pk_bf16_f32 v43, -v33, -v35
    v_pk_mul_f32 v[30:31], v[34:35], v[20:21] op_sel_hi:[1,0]
    s_waitcnt lgkmcnt(0)
    v_mfma_f32_32x32x16_bf16 v[164:179], v[188:191], v[192:195], v[164:179]
    s_nop 0
    v_pk_fma_f32 v[32:33], v[34:35], v[20:21], v[30:31] op_sel:[1,1,0] op_sel_hi:[0,1,1] neg_lo:[1,0,0]
    v_pk_mul_f32 v[30:31], v[32:33], v[20:21] op_sel_hi:[1,0]
    v_pk_fma_f32 v[34:35], v[32:33], v[20:21], v[30:31] op_sel:[1,1,0] op_sel_hi:[0,1,1] neg_lo:[1,0,0]
    v_cvt_pk_bf16_f32 v40, v32, v34
    v_cvt_pk_bf16_f32 v44, -v33, -v35
    v_pk_mul_f32 v[30:31], v[34:35], v[20:21] op_sel_hi:[1,0]
    v_pk_fma_f32 v[32:33], v[34:35], v[20:21], v[30:31] op_sel:[1,1,0] op_sel_hi:[0,1,1] neg_lo:[1,0,0]
    v_pk_mul_f32 v[30:31], v[32:33], v[20:21] op_sel_hi:[1,0]
    v_pk_fma_f32 v[34:35], v[32:33], v[20:21], v[30:31] op_sel:[1,1,0] op_sel_hi:[0,1,1] neg_lo:[1,0,0]
    v_cvt_pk_bf16_f32 v41, v32, v34
    v_cvt_pk_bf16_f32 v45, -v33, -v35
    ds_write_b128 v110, v[38:41] offset:8448
    ds_write_b128 v110, v[42:45] offset:12672
    v_pk_mul_f32 v[30:31], v[18:19], v[28:29] op_sel_hi:[1,0]
    v_pk_fma_f32 v[36:37], v[18:19], v[28:29], v[30:31] op_sel:[1,1,0] op_sel_hi:[0,1,1] neg_lo:[1,0,0]
    v_pk_mul_f32 v[30:31], v[36:37], v[22:23] op_sel_hi:[1,0]
    v_pk_fma_f32 v[34:35], v[36:37], v[22:23], v[30:31] op_sel:[1,1,0] op_sel_hi:[0,1,1] neg_lo:[1,0,0]
    v_cvt_pk_bf16_f32 v46, v36, v34
    v_cvt_pk_bf16_f32 v50, -v37, -v35
    v_pk_mul_f32 v[30:31], v[34:35], v[22:23] op_sel_hi:[1,0]
    v_pk_fma_f32 v[32:33], v[34:35], v[22:23], v[30:31] op_sel:[1,1,0] op_sel_hi:[0,1,1] neg_lo:[1,0,0]
    v_pk_mul_f32 v[30:31], v[32:33], v[22:23] op_sel_hi:[1,0]
    v_pk_fma_f32 v[34:35], v[32:33], v[22:23], v[30:31] op_sel:[1,1,0] op_sel_hi:[0,1,1] neg_lo:[1,0,0]
    v_cvt_pk_bf16_f32 v47, v32, v34
    v_cvt_pk_bf16_f32 v51, -v33, -v35
    v_pk_mul_f32 v[30:31], v[36:37], v[28:29] op_sel_hi:[1,0]
    v_pk_fma_f32 v[36:37], v[36:37], v[28:29], v[30:31] op_sel:[1,1,0] op_sel_hi:[0,1,1] neg_lo:[1,0,0]
    v_pk_mul_f32 v[30:31], v[36:37], v[24:25] op_sel_hi:[1,0]
    v_pk_fma_f32 v[34:35], v[36:37], v[24:25], v[30:31] op_sel:[1,1,0] op_sel_hi:[0,1,1] neg_lo:[1,0,0]
    v_cvt_pk_bf16_f32 v48, v36, v34
    v_cvt_pk_bf16_f32 v52, -v37, -v35
    v_pk_mul_f32 v[30:31], v[36:37], v[28:29] op_sel_hi:[1,0]
    v_pk_fma_f32 v[36:37], v[36:37], v[28:29], v[30:31] op_sel:[1,1,0] op_sel_hi:[0,1,1] neg_lo:[1,0,0]
    v_pk_mul_f32 v[30:31], v[36:37], v[24:25] op_sel_hi:[1,0]
    v_pk_fma_f32 v[34:35], v[36:37], v[24:25], v[30:31] op_sel:[1,1,0] op_sel_hi:[0,1,1] neg_lo:[1,0,0]
    v_cvt_pk_bf16_f32 v49, v36, v34
    v_cvt_pk_bf16_f32 v53, -v37, -v35
    ds_write_b128 v110, v[46:49] offset:9504
    ds_write_b128 v110, v[50:53] offset:13728
    v_pk_mul_f32 v[30:31], v[36:37], v[28:29] op_sel_hi:[1,0]
    v_pk_fma_f32 v[32:33], v[36:37], v[28:29], v[30:31] op_sel:[1,1,0] op_sel_hi:[0,1,1] neg_lo:[1,0,0]
    v_pk_mul_f32 v[30:31], v[32:33], v[28:29] op_sel_hi:[1,0]
    v_pk_fma_f32 v[34:35], v[32:33], v[28:29], v[30:31] op_sel:[1,1,0] op_sel_hi:[0,1,1] neg_lo:[1,0,0]
    v_cvt_pk_bf16_f32 v38, v32, v34
    v_cvt_pk_bf16_f32 v42, -v33, -v35
    v_pk_mul_f32 v[30:31], v[34:35], v[28:29] op_sel_hi:[1,0]
    v_pk_fma_f32 v[32:33], v[34:35], v[28:29], v[30:31] op_sel:[1,1,0] op_sel_hi:[0,1,1] neg_lo:[1,0,0]
    v_pk_mul_f32 v[30:31], v[32:33], v[28:29] op_sel_hi:[1,0]
    v_pk_fma_f32 v[34:35], v[32:33], v[28:29], v[30:31] op_sel:[1,1,0] op_sel_hi:[0,1,1] neg_lo:[1,0,0]
    v_cvt_pk_bf16_f32 v39, v32, v34
    v_cvt_pk_bf16_f32 v43, -v33, -v35
    v_pk_mul_f32 v[30:31], v[34:35], v[28:29] op_sel_hi:[1,0]
    v_pk_fma_f32 v[32:33], v[34:35], v[28:29], v[30:31] op_sel:[1,1,0] op_sel_hi:[0,1,1] neg_lo:[1,0,0]
    v_cvt_pk_bf16_f32 v40, v32, 0
    v_cvt_pk_bf16_f32 v44, -v33, 0
    ds_write_b128 v110, v[38:41] offset:10560
    ds_write_b128 v110, v[42:45] offset:14784
    v_cvt_pk_bf16_f32 v46, 1.0, v26
    v_cvt_pk_bf16_f32 v50, 0, v27
    v_pk_mul_f32 v[30:31], v[26:27], v[26:27] op_sel_hi:[1,0]
    v_pk_fma_f32 v[32:33], v[26:27], v[26:27], v[30:31] op_sel:[1,1,0] op_sel_hi:[0,1,1] neg_lo:[1,0,0]
    buffer_load_dword v254, v222, s[8:11], s49 offen sc1
    v_pk_mul_f32 v[30:31], v[32:33], v[26:27] op_sel_hi:[1,0]
    v_pk_fma_f32 v[34:35], v[32:33], v[26:27], v[30:31] op_sel:[1,1,0] op_sel_hi:[0,1,1] neg_lo:[1,0,0]
    v_cvt_pk_bf16_f32 v47, v32, v34
    v_cvt_pk_bf16_f32 v51, v33, v35
    v_pk_mul_f32 v[30:31], v[34:35], v[26:27] op_sel_hi:[1,0]
    v_pk_fma_f32 v[32:33], v[34:35], v[26:27], v[30:31] op_sel:[1,1,0] op_sel_hi:[0,1,1] neg_lo:[1,0,0]
    v_pk_mul_f32 v[30:31], v[32:33], v[26:27] op_sel_hi:[1,0]
    v_pk_fma_f32 v[34:35], v[32:33], v[26:27], v[30:31] op_sel:[1,1,0] op_sel_hi:[0,1,1] neg_lo:[1,0,0]
    v_cvt_pk_bf16_f32 v48, v32, v34
    v_cvt_pk_bf16_f32 v52, v33, v35
    v_pk_mul_f32 v[30:31], v[34:35], v[26:27] op_sel_hi:[1,0]
    v_pk_fma_f32 v[32:33], v[34:35], v[26:27], v[30:31] op_sel:[1,1,0] op_sel_hi:[0,1,1] neg_lo:[1,0,0]
    v_pk_mul_f32 v[30:31], v[32:33], v[26:27] op_sel_hi:[1,0]
    v_pk_fma_f32 v[34:35], v[32:33], v[26:27], v[30:31] op_sel:[1,1,0] op_sel_hi:[0,1,1] neg_lo:[1,0,0]
    v_cvt_pk_bf16_f32 v49, v32, v34
    v_cvt_pk_bf16_f32 v53, v33, v35
    ds_write_b128 v110, v[46:49] offset:0
    ds_write_b128 v110, v[50:53] offset:4224
    v_pk_mul_f32 v[30:31], v[34:35], v[26:27] op_sel_hi:[1,0]
    v_pk_fma_f32 v[32:33], v[34:35], v[26:27], v[30:31] op_sel:[1,1,0] op_sel_hi:[0,1,1] neg_lo:[1,0,0]
    v_pk_mul_f32 v[30:31], v[32:33], v[26:27] op_sel_hi:[1,0]
    v_pk_fma_f32 v[34:35], v[32:33], v[26:27], v[30:31] op_sel:[1,1,0] op_sel_hi:[0,1,1] neg_lo:[1,0,0]
    v_cvt_pk_bf16_f32 v38, v32, v34
    v_cvt_pk_bf16_f32 v42, v33, v35
    v_pk_mul_f32 v[30:31], v[34:35], v[26:27] op_sel_hi:[1,0]
    v_pk_fma_f32 v[32:33], v[34:35], v[26:27], v[30:31] op_sel:[1,1,0] op_sel_hi:[0,1,1] neg_lo:[1,0,0]
    v_pk_mul_f32 v[30:31], v[32:33], v[26:27] op_sel_hi:[1,0]
    v_pk_fma_f32 v[34:35], v[32:33], v[26:27], v[30:31] op_sel:[1,1,0] op_sel_hi:[0,1,1] neg_lo:[1,0,0]
    v_cvt_pk_bf16_f32 v39, v32, v34
    v_cvt_pk_bf16_f32 v43, v33, v35
    v_pk_mul_f32 v[30:31], v[34:35], v[26:27] op_sel_hi:[1,0]
    v_pk_fma_f32 v[32:33], v[34:35], v[26:27], v[30:31] op_sel:[1,1,0] op_sel_hi:[0,1,1] neg_lo:[1,0,0]
    v_pk_mul_f32 v[30:31], v[32:33], v[26:27] op_sel_hi:[1,0]
    v_pk_fma_f32 v[34:35], v[32:33], v[26:27], v[30:31] op_sel:[1,1,0] op_sel_hi:[0,1,1] neg_lo:[1,0,0]
    v_cvt_pk_bf16_f32 v40, v32, v34
    v_cvt_pk_bf16_f32 v44, v33, v35
    v_pk_mul_f32 v[30:31], v[34:35], v[26:27] op_sel_hi:[1,0]
    v_pk_fma_f32 v[32:33], v[34:35], v[26:27], v[30:31] op_sel:[1,1,0] op_sel_hi:[0,1,1] neg_lo:[1,0,0]
    v_pk_mul_f32 v[30:31], v[32:33], v[26:27] op_sel_hi:[1,0]
    v_pk_fma_f32 v[34:35], v[32:33], v[26:27], v[30:31] op_sel:[1,1,0] op_sel_hi:[0,1,1] neg_lo:[1,0,0]
    v_cvt_pk_bf16_f32 v41, v32, v34
    v_cvt_pk_bf16_f32 v45, v33, v35
    ds_write_b128 v110, v[38:41] offset:1056
    ds_write_b128 v110, v[42:45] offset:5280
    v_pk_mul_f32 v[30:31], v[34:35], v[26:27] op_sel_hi:[1,0]
    v_pk_fma_f32 v[32:33], v[34:35], v[26:27], v[30:31] op_sel:[1,1,0] op_sel_hi:[0,1,1] neg_lo:[1,0,0]
    v_pk_mul_f32 v[30:31], v[32:33], v[26:27] op_sel_hi:[1,0]
    v_pk_fma_f32 v[34:35], v[32:33], v[26:27], v[30:31] op_sel:[1,1,0] op_sel_hi:[0,1,1] neg_lo:[1,0,0]
    v_cvt_pk_bf16_f32 v46, v32, v34
    v_cvt_pk_bf16_f32 v50, v33, v35
    v_pk_mul_f32 v[30:31], v[34:35], v[26:27] op_sel_hi:[1,0]
    v_pk_fma_f32 v[32:33], v[34:35], v[26:27], v[30:31] op_sel:[1,1,0] op_sel_hi:[0,1,1] neg_lo:[1,0,0]
    v_pk_mul_f32 v[30:31], v[32:33], v[26:27] op_sel_hi:[1,0]
    v_pk_fma_f32 v[34:35], v[32:33], v[26:27], v[30:31] op_sel:[1,1,0] op_sel_hi:[0,1,1] neg_lo:[1,0,0]
    v_cvt_pk_bf16_f32 v47, v32, v34
    v_cvt_pk_bf16_f32 v51, v33, v35
    v_pk_mul_f32 v[30:31], v[34:35], v[26:27] op_sel_hi:[1,0]
    v_pk_fma_f32 v[32:33], v[34:35], v[26:27], v[30:31] op_sel:[1,1,0] op_sel_hi:[0,1,1] neg_lo:[1,0,0]
    v_pk_mul_f32 v[30:31], v[32:33], v[26:27] op_sel_hi:[1,0]
    v_pk_fma_f32 v[34:35], v[32:33], v[26:27], v[30:31] op_sel:[1,1,0] op_sel_hi:[0,1,1] neg_lo:[1,0,0]
    v_cvt_pk_bf16_f32 v48, v32, v34
    v_cvt_pk_bf16_f32 v52, v33, v35
    v_pk_mul_f32 v[30:31], v[34:35], v[26:27] op_sel_hi:[1,0]
    v_pk_fma_f32 v[32:33], v[34:35], v[26:27], v[30:31] op_sel:[1,1,0] op_sel_hi:[0,1,1] neg_lo:[1,0,0]
    v_pk_mul_f32 v[30:31], v[32:33], v[26:27] op_sel_hi:[1,0]
    v_pk_fma_f32 v[34:35], v[32:33], v[26:27], v[30:31] op_sel:[1,1,0] op_sel_hi:[0,1,1] neg_lo:[1,0,0]
    v_cvt_pk_bf16_f32 v49, v32, v34
    v_cvt_pk_bf16_f32 v53, v33, v35
    ds_write_b128 v110, v[46:49] offset:2112
    ds_write_b128 v110, v[50:53] offset:6336
    v_pk_mul_f32 v[30:31], v[34:35], v[26:27] op_sel_hi:[1,0]
    v_pk_fma_f32 v[32:33], v[34:35], v[26:27], v[30:31] op_sel:[1,1,0] op_sel_hi:[0,1,1] neg_lo:[1,0,0]
    v_pk_mul_f32 v[30:31], v[32:33], v[26:27] op_sel_hi:[1,0]
    v_pk_fma_f32 v[34:35], v[32:33], v[26:27], v[30:31] op_sel:[1,1,0] op_sel_hi:[0,1,1] neg_lo:[1,0,0]
    v_cvt_pk_bf16_f32 v38, v32, v34
    v_cvt_pk_bf16_f32 v42, v33, v35
    v_pk_mul_f32 v[30:31], v[34:35], v[26:27] op_sel_hi:[1,0]
    v_pk_fma_f32 v[32:33], v[34:35], v[26:27], v[30:31] op_sel:[1,1,0] op_sel_hi:[0,1,1] neg_lo:[1,0,0]
    v_pk_mul_f32 v[30:31], v[32:33], v[26:27] op_sel_hi:[1,0]
    v_pk_fma_f32 v[34:35], v[32:33], v[26:27], v[30:31] op_sel:[1,1,0] op_sel_hi:[0,1,1] neg_lo:[1,0,0]
    v_cvt_pk_bf16_f32 v39, v32, v34
    v_cvt_pk_bf16_f32 v43, v33, v35
    v_pk_mul_f32 v[30:31], v[34:35], v[26:27] op_sel_hi:[1,0]
    v_pk_fma_f32 v[32:33], v[34:35], v[26:27], v[30:31] op_sel:[1,1,0] op_sel_hi:[0,1,1] neg_lo:[1,0,0]
    v_pk_mul_f32 v[30:31], v[32:33], v[26:27] op_sel_hi:[1,0]
    v_pk_fma_f32 v[34:35], v[32:33], v[26:27], v[30:31] op_sel:[1,1,0] op_sel_hi:[0,1,1] neg_lo:[1,0,0]
    v_cvt_pk_bf16_f32 v40, v32, v34
    v_cvt_pk_bf16_f32 v44, v33, v35
    v_pk_mul_f32 v[30:31], v[34:35], v[26:27] op_sel_hi:[1,0]
    v_pk_fma_f32 v[32:33], v[34:35], v[26:27], v[30:31] op_sel:[1,1,0] op_sel_hi:[0,1,1] neg_lo:[1,0,0]
    v_pk_mul_f32 v[30:31], v[32:33], v[26:27] op_sel_hi:[1,0]
    v_pk_fma_f32 v[34:35], v[32:33], v[26:27], v[30:31] op_sel:[1,1,0] op_sel_hi:[0,1,1] neg_lo:[1,0,0]
    v_cvt_pk_bf16_f32 v41, v32, v34
    v_cvt_pk_bf16_f32 v45, v33, v35
    ds_write_b128 v110, v[38:41] offset:3168
    ds_write_b128 v110, v[42:45] offset:7392
    s_waitcnt lgkmcnt(0)
    s_waitcnt lgkmcnt(0)
    ds_read_b64_tr_b16 v[180:181], v160 offset:8448
    ds_read_b64_tr_b16 v[182:183], v160 offset:8480
    ds_read_b64_tr_b16 v[184:185], v160 offset:0
    ds_read_b64_tr_b16 v[186:187], v160 offset:32
    ds_read_b64_tr_b16 v[188:189], v160 offset:8576
    ds_read_b64_tr_b16 v[190:191], v160 offset:8608
    ds_read_b64_tr_b16 v[192:193], v160 offset:128
    ds_read_b64_tr_b16 v[194:195], v160 offset:160
    ds_read_b64_tr_b16 v[196:197], v160 offset:8704
    ds_read_b64_tr_b16 v[198:199], v160 offset:8736
    ds_read_b64_tr_b16 v[200:201], v160 offset:256
    ds_read_b64_tr_b16 v[202:203], v160 offset:288
    s_waitcnt lgkmcnt(8)
    v_mfma_f32_32x32x16_bf16 v[164:179], v[180:183], v[184:187], v[164:179]
    ds_read_b64_tr_b16 v[204:205], v160 offset:8832
    ds_read_b64_tr_b16 v[206:207], v160 offset:8864
    ds_read_b64_tr_b16 v[208:209], v160 offset:384
    ds_read_b64_tr_b16 v[210:211], v160 offset:416
    s_waitcnt lgkmcnt(8)
    v_mfma_f32_32x32x16_bf16 v[164:179], v[188:191], v[192:195], v[164:179]
    ds_read_b64_tr_b16 v[180:181], v160 offset:8960
    ds_read_b64_tr_b16 v[182:183], v160 offset:8992
    ds_read_b64_tr_b16 v[184:185], v160 offset:512
    ds_read_b64_tr_b16 v[186:187], v160 offset:544
    s_waitcnt lgkmcnt(8)
    v_mfma_f32_32x32x16_bf16 v[164:179], v[196:199], v[200:203], v[164:179]
    ds_read_b64_tr_b16 v[188:189], v160 offset:9088
    ds_read_b64_tr_b16 v[190:191], v160 offset:9120
    ds_read_b64_tr_b16 v[192:193], v160 offset:640
    ds_read_b64_tr_b16 v[194:195], v160 offset:672
    s_waitcnt lgkmcnt(8)
    v_mfma_f32_32x32x16_bf16 v[164:179], v[204:207], v[208:211], v[164:179]
    ds_read_b64_tr_b16 v[196:197], v160 offset:9216
    ds_read_b64_tr_b16 v[198:199], v160 offset:9248
    ds_read_b64_tr_b16 v[200:201], v160 offset:768
    ds_read_b64_tr_b16 v[202:203], v160 offset:800
    s_waitcnt lgkmcnt(8)
    v_mfma_f32_32x32x16_bf16 v[164:179], v[180:183], v[184:187], v[164:179]
    ds_read_b64_tr_b16 v[204:205], v160 offset:9344
    ds_read_b64_tr_b16 v[206:207], v160 offset:9376
    ds_read_b64_tr_b16 v[208:209], v160 offset:896
    ds_read_b64_tr_b16 v[210:211], v160 offset:928
    s_waitcnt lgkmcnt(8)
    v_mfma_f32_32x32x16_bf16 v[164:179], v[188:191], v[192:195], v[164:179]
    s_waitcnt lgkmcnt(4)
    v_mfma_f32_32x32x16_bf16 v[164:179], v[196:199], v[200:203], v[164:179]
    s_waitcnt lgkmcnt(0)
    v_mfma_f32_32x32x16_bf16 v[164:179], v[204:207], v[208:211], v[164:179]
    buffer_load_dword v254, v223, s[8:11], s49 offen sc1
    v_lshrrev_b32 v76, 5, v0
    v_lshlrev_b32 v76, 9, v76
    v_and_b32 v77, 31, v0
    v_lshl_add_u32 v76, v77, 2, v76
    v_add_u32 v76, s33, v76
    v_add_u32 v148, s33, v148
    v_add_u32 v149, s33, v149
    v_add_u32 v150, s33, v150
    v_add_u32 v151, s33, v151
    v_add_u32 v152, s33, v152
    v_add_u32 v153, s33, v153
    v_add_u32 v154, s33, v154
    v_add_u32 v155, s33, v155
    v_add_u32 v156, s33, v156
    v_lshlrev_b32 v112, 2, v0
    v_sub_u32 v112, s33, v112
    v_sub_u32 v113, 127, v0
    v_lshrrev_b32 v115, 5, v113
    v_lshlrev_b32 v115, 8, v115
    v_and_b32 v113, 31, v113
    v_lshl_add_u32 v113, v113, 2, v115
    v_add_u32 v113, s33, v113
    v_sub_u32 v114, 128, v0
    v_lshrrev_b32 v115, 5, v114
    v_lshlrev_b32 v115, 8, v115
    v_and_b32 v114, 31, v114
    v_lshl_add_u32 v114, v114, 2, v115
    v_add_u32 v114, s33, v114
    v_and_b32 v115, 1, v0
    v_cmp_eq_u32 s[46:47], 0, v115
    s_mov_b64 exec, 1
    v_add_f32 v164, v164, v161
    s_mov_b64 exec, -1
    s_nop 0
    ds_write_b32 v76, v164 offset:0
    ds_write_b32 v76, v165 offset:128
    ds_write_b32 v76, v166 offset:256
    ds_write_b32 v76, v167 offset:384
    ds_write_b32 v76, v168 offset:1024
    ds_write_b32 v76, v169 offset:1152
    ds_write_b32 v76, v170 offset:1280
    ds_write_b32 v76, v171 offset:1408
    ds_write_b32 v76, v172 offset:2048
    ds_write_b32 v76, v173 offset:2176
    ds_write_b32 v76, v174 offset:2304
    ds_write_b32 v76, v175 offset:2432
    s_mov_b32 exec_hi, 0
    ds_write_b128 v111, v[80:83] offset:11360
    s_mov_b64 exec, 3
    ds_write_b128 v111, v[80:83] offset:7168
    ds_write_b128 v111, v[80:83] offset:11328
    s_mov_b64 exec, -1
    s_waitcnt vmcnt(2)
    s_lshl_b32 s42, s3, 11
    s_add_u32 s42, s42, 131072
    v_add_u32 v91, s42, v91
    ds_write_b128 v91, v[226:229]
    ds_write_b128 v91, v[230:233] offset:16
    v_lshrrev_b32 v91, 2, v0
    v_lshlrev_b32 v91, 5, v91
    v_add_u32_e64 v91, s42, v91
    ds_read_b128 v[180:183], v91 offset:0
    ds_read_b128 v[184:187], v91 offset:16
    ds_read_b128 v[188:191], v91 offset:512
    ds_read_b128 v[192:195], v91 offset:528
    ds_read_b128 v[196:199], v91 offset:1024
    ds_read_b128 v[200:203], v91 offset:1040
    ds_read_b128 v[204:207], v91 offset:1536
    ds_read_b128 v[208:211], v91 offset:1552
    s_waitcnt lgkmcnt(0)
    s_nop 0
    ds_read_b32 v16, v112 offset:2556
    ds_read_b32 v17, v112 offset:2560
    ds_read_b32 v18, v112 offset:2300
    ds_read_b32 v19, v112 offset:2304
    ds_read_b32 v20, v113 offset:1024
    ds_read_b32 v21, v113 offset:1152
    ds_read_b32 v22, v114 offset:1024
    ds_read_b32 v36, v148 offset:0
    ds_read_b32 v37, v149 offset:0
    ds_read_b32 v38, v150 offset:0
    ds_read_b32 v39, v151 offset:0
    ds_read_b32 v40, v152 offset:0
    ds_read_b32 v41, v153 offset:0
    ds_read_b32 v42, v154 offset:0
    ds_read_b32 v43, v155 offset:0
    ds_read_b32 v44, v156 offset:0
    s_waitcnt lgkmcnt(9)
    s_nop 0
    v_cndmask_b32 v23, v16, v17, s[46:47]
    v_cvt_pk_bf16_f32 v24, v17, v17
    v_cvt_pk_bf16_f32 v28, v17, v17
    v_cvt_pk_bf16_f32 v25, v17, v23
    v_cvt_pk_bf16_f32 v29, v23, v16
    v_cvt_pk_bf16_f32 v26, v16, v16
    v_cvt_pk_bf16_f32 v30, v16, v16
    v_cvt_pk_bf16_f32 v27, v16, v16
    v_cvt_pk_bf16_f32 v31, v16, v16
    ds_write_b128 v111, v[24:27] offset:3072
    ds_write_b128 v111, v[28:31] offset:7232
    v_cndmask_b32 v23, v18, v19, s[46:47]
    v_cvt_pk_bf16_f32 v24, v19, v19
    v_cvt_pk_bf16_f32 v28, v19, v19
    v_cvt_pk_bf16_f32 v25, v19, v23
    v_cvt_pk_bf16_f32 v29, v23, v18
    v_cvt_pk_bf16_f32 v26, v18, v18
    v_cvt_pk_bf16_f32 v30, v18, v18
    v_cvt_pk_bf16_f32 v27, v18, v18
    v_cvt_pk_bf16_f32 v31, v18, v18
    ds_write_b128 v111, v[24:27] offset:4096
    ds_write_b128 v111, v[28:31] offset:8256
    buffer_load_dword v254, v224, s[8:11], s49 offen sc1
    v_cvt_pk_bf16_f32 v24, v22, v22
    v_cvt_pk_bf16_f32 v28, v22, v21
    v_cvt_pk_bf16_f32 v25, v21, v21
    v_cvt_pk_bf16_f32 v29, v21, v21
    v_cvt_pk_bf16_f32 v26, v21, v20
    v_cvt_pk_bf16_f32 v30, v20, v20
    v_cvt_pk_bf16_f32 v27, v20, v20
    v_cvt_pk_bf16_f32 v31, v20, v20
    ds_write_b128 v111, v[24:27] offset:5120
    ds_write_b128 v111, v[28:31] offset:9280
    s_waitcnt lgkmcnt(0)
    s_nop 0
    v_cvt_pk_bf16_f32 v46, v36, v37
    v_cvt_pk_bf16_f32 v50, v37, v38
    v_cvt_pk_bf16_f32 v47, v38, v39
    v_cvt_pk_bf16_f32 v51, v39, v40
    v_cvt_pk_bf16_f32 v48, v40, v41
    v_cvt_pk_bf16_f32 v52, v41, v42
    v_cvt_pk_bf16_f32 v49, v42, v43
    v_cvt_pk_bf16_f32 v53, v43, v44
    ds_write_b128 v111, v[46:49] offset:6144
    ds_write_b128 v111, v[50:53] offset:10304
    s_add_u32 s44, s33, 3072
    s_add_u32 s45, s33, 11872
    v_and_b32 v90, 15, v0
    v_bfe_u32 v91, v0, 4, 1
    v_lshrrev_b32 v92, 5, v0
    v_sub_u32 v93, 2047, v90
    v_lshl_add_u32 v93, v91, 3, v93
    v_lshlrev_b32 v94, 4, v92
    v_sub_u32 v93, v93, v94
    v_lshrrev_b32 v93, 1, v93
    v_lshlrev_b32 v93, 2, v93
    v_and_b32 v94, 1, v0
    v_mul_u32_u24 v94, 4160, v94
    v_sub_u32 v93, v93, v94
    v_add_u32_e64 v93, s44, v93
    v_add_u32 v176, 3200, v93
    v_add_u32 v177, 2176, v93
    v_add_u32 v178, 1152, v93
    v_add_u32 v179, 128, v93
    v_sub_u32 v93, v90, v92
    v_lshlrev_b32 v93, 5, v93
    v_lshl_add_u32 v93, v91, 4, v93
    v_add_u32 v93, s45, v93
    v_subrev_u32 v80, 448, v93
    s_waitcnt vmcnt(3)
    v_lshlrev_b32_e64 v90, 16, v56
    v_and_b32 v91, 0xffff0000, v56
    v_pk_mul_f32 v[90:91], v[90:91], v[180:181]
    v_cvt_pk_bf16_f32 v56, v90, v91
    v_lshlrev_b32_e64 v92, 16, v57
    v_and_b32 v93, 0xffff0000, v57
    v_pk_mul_f32 v[92:93], v[92:93], v[182:183]
    v_cvt_pk_bf16_f32 v57, v92, v93
    v_lshlrev_b32_e64 v90, 16, v58
    v_and_b32 v91, 0xffff0000, v58
    v_pk_mul_f32 v[90:91], v[90:91], v[184:185]
    v_cvt_pk_bf16_f32 v58, v90, v91
    v_lshlrev_b32_e64 v92, 16, v59
    v_and_b32 v93, 0xffff0000, v59
    v_pk_mul_f32 v[92:93], v[92:93], v[186:187]
    v_cvt_pk_bf16_f32 v59, v92, v93
    v_lshlrev_b32_e64 v90, 16, v60
    v_and_b32 v91, 0xffff0000, v60
    v_pk_mul_f32 v[90:91], v[90:91], v[188:189]
    v_cvt_pk_bf16_f32 v60, v90, v91
    v_lshlrev_b32_e64 v92, 16, v61
    v_and_b32 v93, 0xffff0000, v61
    v_pk_mul_f32 v[92:93], v[92:93], v[190:191]
    v_cvt_pk_bf16_f32 v61, v92, v93
    v_lshlrev_b32_e64 v90, 16, v62
    v_and_b32 v91, 0xffff0000, v62
    v_pk_mul_f32 v[90:91], v[90:91], v[192:193]
    v_cvt_pk_bf16_f32 v62, v90, v91
    v_lshlrev_b32_e64 v92, 16, v63
    v_and_b32 v93, 0xffff0000, v63
    v_pk_mul_f32 v[92:93], v[92:93], v[194:195]
    v_cvt_pk_bf16_f32 v63, v92, v93
    v_lshlrev_b32_e64 v90, 16, v64
    v_and_b32 v91, 0xffff0000, v64
    v_pk_mul_f32 v[90:91], v[90:91], v[196:197]
    v_cvt_pk_bf16_f32 v64, v90, v91
    v_lshlrev_b32_e64 v92, 16, v65
    v_and_b32 v93, 0xffff0000, v65
    v_pk_mul_f32 v[92:93], v[92:93], v[198:199]
    v_cvt_pk_bf16_f32 v65, v92, v93
    v_lshlrev_b32_e64 v90, 16, v66
    v_and_b32 v91, 0xffff0000, v66
    v_pk_mul_f32 v[90:91], v[90:91], v[200:201]
    v_cvt_pk_bf16_f32 v66, v90, v91
    v_lshlrev_b32_e64 v92, 16, v67
    v_and_b32 v93, 0xffff0000, v67
    v_pk_mul_f32 v[92:93], v[92:93], v[202:203]
    v_cvt_pk_bf16_f32 v67, v92, v93
    v_lshlrev_b32_e64 v90, 16, v68
    v_and_b32 v91, 0xffff0000, v68
    v_pk_mul_f32 v[90:91], v[90:91], v[204:205]
    v_cvt_pk_bf16_f32 v68, v90, v91
    v_lshlrev_b32_e64 v92, 16, v69
    v_and_b32 v93, 0xffff0000, v69
    v_pk_mul_f32 v[92:93], v[92:93], v[206:207]
    v_cvt_pk_bf16_f32 v69, v92, v93
    v_lshlrev_b32_e64 v90, 16, v70
    v_and_b32 v91, 0xffff0000, v70
    v_pk_mul_f32 v[90:91], v[90:91], v[208:209]
    v_cvt_pk_bf16_f32 v70, v90, v91
    v_lshlrev_b32_e64 v92, 16, v71
    v_and_b32 v93, 0xffff0000, v71
    v_pk_mul_f32 v[92:93], v[92:93], v[210:211]
    v_cvt_pk_bf16_f32 v71, v92, v93
    ds_write_b128 v74, v[56:59] offset:0
    ds_write_b128 v74, v[60:63] offset:256
    ds_write_b128 v74, v[64:67] offset:512
    ds_write_b128 v74, v[68:71] offset:768
    v_mov_b32 v211, v80
    buffer_load_dword v254, v225, s[8:11], s49 offen sc1
    s_waitcnt lgkmcnt(0)
    s_barrier
    s_nop 0
    ds_read2_b32 v[48:49], v176 offset0:240 offset1:241
    ds_read2_b32 v[50:51], v176 offset0:242 offset1:243
    ds_read_b128 v[80:83], v211 offset:448
    ds_read2_b32 v[52:53], v176 offset0:112 offset1:113
    ds_read2_b32 v[54:55], v176 offset0:114 offset1:115
    ds_read_b128 v[84:87], v211 offset:960
    ds_read2_b32 v[56:57], v177 offset0:240 offset1:241
    ds_read2_b32 v[58:59], v177 offset0:242 offset1:243
    ds_read_b128 v[88:91], v211 offset:1472
    ds_read2_b32 v[60:61], v177 offset0:112 offset1:113
    ds_read2_b32 v[62:63], v177 offset0:114 offset1:115
    ds_read_b128 v[92:95], v211 offset:1984
    ds_read2_b32 v[64:65], v178 offset0:240 offset1:241
    ds_read2_b32 v[66:67], v178 offset0:242 offset1:243
    ds_read_b128 v[96:99], v211 offset:2496
    ds_read2_b32 v[68:69], v178 offset0:112 offset1:113
    ds_read2_b32 v[70:71], v178 offset0:114 offset1:115
    ds_read_b128 v[100:103], v211 offset:3008
    ds_read2_b32 v[72:73], v179 offset0:240 offset1:241
    ds_read2_b32 v[74:75], v179 offset0:242 offset1:243
    ds_read_b128 v[104:107], v211 offset:3520
    ds_read2_b32 v[76:77], v179 offset0:112 offset1:113
    ds_read2_b32 v[78:79], v179 offset0:114 offset1:115
    ds_read_b128 v[108:111], v211 offset:4032
    s_waitcnt lgkmcnt(0)
    v_mfma_f32_16x16x32_bf16 v[16:19], v[48:51], v[80:83], 0
    buffer_load_dword v254, v213, s[4:7], s63 offen
    ds_read2_b32 v[112:113], v176 offset0:224 offset1:225
    v_mfma_f32_16x16x32_bf16 v[20:23], v[48:51], v[84:87], 0
    ds_read2_b32 v[114:115], v176 offset0:226 offset1:227
    v_mfma_f32_16x16x32_bf16 v[24:27], v[48:51], v[88:91], 0
    ds_read_b128 v[144:147], v211 offset:384
    v_mfma_f32_16x16x32_bf16 v[28:31], v[48:51], v[92:95], 0
    ds_read2_b32 v[116:117], v176 offset0:96 offset1:97
    v_mfma_f32_16x16x32_bf16 v[32:35], v[48:51], v[96:99], 0
    ds_read2_b32 v[118:119], v176 offset0:98 offset1:99
    v_mfma_f32_16x16x32_bf16 v[36:39], v[48:51], v[100:103], 0
    ds_read_b128 v[148:151], v211 offset:896
    v_mfma_f32_16x16x32_bf16 v[40:43], v[48:51], v[104:107], 0
    ds_read2_b32 v[120:121], v177 offset0:224 offset1:225
    v_mfma_f32_16x16x32_bf16 v[44:47], v[48:51], v[108:111], 0
    ds_read2_b32 v[122:123], v177 offset0:226 offset1:227
    v_mfma_f32_16x16x32_bf16 v[20:23], v[52:55], v[80:83], v[20:23]
    ds_read_b128 v[152:155], v211 offset:1408
    v_mfma_f32_16x16x32_bf16 v[24:27], v[52:55], v[84:87], v[24:27]
    ds_read2_b32 v[124:125], v177 offset0:96 offset1:97
    v_mfma_f32_16x16x32_bf16 v[28:31], v[52:55], v[88:91], v[28:31]
    ds_read2_b32 v[126:127], v177 offset0:98 offset1:99
    v_mfma_f32_16x16x32_bf16 v[32:35], v[52:55], v[92:95], v[32:35]
    ds_read_b128 v[156:159], v211 offset:1920
    v_mfma_f32_16x16x32_bf16 v[36:39], v[52:55], v[96:99], v[36:39]
    ds_read2_b32 v[128:129], v178 offset0:224 offset1:225
    v_mfma_f32_16x16x32_bf16 v[40:43], v[52:55], v[100:103], v[40:43]
    ds_read2_b32 v[130:131], v178 offset0:226 offset1:227
    v_mfma_f32_16x16x32_bf16 v[44:47], v[52:55], v[104:107], v[44:47]
    ds_read_b128 v[160:163], v211 offset:2432
    v_mfma_f32_16x16x32_bf16 v[24:27], v[56:59], v[80:83], v[24:27]
    ds_read2_b32 v[132:133], v178 offset0:96 offset1:97
    v_mfma_f32_16x16x32_bf16 v[28:31], v[56:59], v[84:87], v[28:31]
    ds_read2_b32 v[134:135], v178 offset0:98 offset1:99
    v_mfma_f32_16x16x32_bf16 v[32:35], v[56:59], v[88:91], v[32:35]
    ds_read_b128 v[164:167], v211 offset:2944
    v_mfma_f32_16x16x32_bf16 v[36:39], v[56:59], v[92:95], v[36:39]
    ds_read2_b32 v[136:137], v179 offset0:224 offset1:225
    v_mfma_f32_16x16x32_bf16 v[40:43], v[56:59], v[96:99], v[40:43]
    ds_read2_b32 v[138:139], v179 offset0:226 offset1:227
    v_mfma_f32_16x16x32_bf16 v[44:47], v[56:59], v[100:103], v[44:47]
    ds_read_b128 v[168:171], v211 offset:3456
    v_mfma_f32_16x16x32_bf16 v[28:31], v[60:63], v[80:83], v[28:31]
    ds_read2_b32 v[140:141], v179 offset0:96 offset1:97
    v_mfma_f32_16x16x32_bf16 v[32:35], v[60:63], v[84:87], v[32:35]
    ds_read2_b32 v[142:143], v179 offset0:98 offset1:99
    v_mfma_f32_16x16x32_bf16 v[36:39], v[60:63], v[88:91], v[36:39]
    ds_read_b128 v[172:175], v211 offset:3968
    v_mfma_f32_16x16x32_bf16 v[40:43], v[60:63], v[92:95], v[40:43]
    v_mfma_f32_16x16x32_bf16 v[44:47], v[60:63], v[96:99], v[44:47]
    v_mfma_f32_16x16x32_bf16 v[32:35], v[64:67], v[80:83], v[32:35]
    v_mfma_f32_16x16x32_bf16 v[36:39], v[64:67], v[84:87], v[36:39]
    v_mfma_f32_16x16x32_bf16 v[40:43], v[64:67], v[88:91], v[40:43]
    v_mfma_f32_16x16x32_bf16 v[44:47], v[64:67], v[92:95], v[44:47]
    v_mfma_f32_16x16x32_bf16 v[36:39], v[68:71], v[80:83], v[36:39]
    v_mfma_f32_16x16x32_bf16 v[40:43], v[68:71], v[84:87], v[40:43]
    v_mfma_f32_16x16x32_bf16 v[44:47], v[68:71], v[88:91], v[44:47]
    v_mfma_f32_16x16x32_bf16 v[40:43], v[72:75], v[80:83], v[40:43]
    v_mfma_f32_16x16x32_bf16 v[44:47], v[72:75], v[84:87], v[44:47]
    v_mfma_f32_16x16x32_bf16 v[44:47], v[76:79], v[80:83], v[44:47]
    s_waitcnt lgkmcnt(0)
    v_mfma_f32_16x16x32_bf16 v[16:19], v[112:115], v[144:147], v[16:19]
    ds_read2_b32 v[48:49], v176 offset0:208 offset1:209
    v_mfma_f32_16x16x32_bf16 v[20:23], v[112:115], v[148:151], v[20:23]
    ds_read2_b32 v[50:51], v176 offset0:210 offset1:211
    v_mfma_f32_16x16x32_bf16 v[24:27], v[112:115], v[152:155], v[24:27]
    ds_read_b128 v[80:83], v211 offset:320
    v_mfma_f32_16x16x32_bf16 v[28:31], v[112:115], v[156:159], v[28:31]
    ds_read2_b32 v[52:53], v176 offset0:80 offset1:81
    v_mfma_f32_16x16x32_bf16 v[32:35], v[112:115], v[160:163], v[32:35]
    ds_read2_b32 v[54:55], v176 offset0:82 offset1:83
    v_mfma_f32_16x16x32_bf16 v[36:39], v[112:115], v[164:167], v[36:39]
    ds_read_b128 v[84:87], v211 offset:832
    v_mfma_f32_16x16x32_bf16 v[40:43], v[112:115], v[168:171], v[40:43]
    ds_read2_b32 v[56:57], v177 offset0:208 offset1:209
    v_mfma_f32_16x16x32_bf16 v[44:47], v[112:115], v[172:175], v[44:47]
    ds_read2_b32 v[58:59], v177 offset0:210 offset1:211
    v_mfma_f32_16x16x32_bf16 v[20:23], v[116:119], v[144:147], v[20:23]
    ds_read_b128 v[88:91], v211 offset:1344
    v_mfma_f32_16x16x32_bf16 v[24:27], v[116:119], v[148:151], v[24:27]
    ds_read2_b32 v[60:61], v177 offset0:80 offset1:81
    v_mfma_f32_16x16x32_bf16 v[28:31], v[116:119], v[152:155], v[28:31]
    ds_read2_b32 v[62:63], v177 offset0:82 offset1:83
    v_mfma_f32_16x16x32_bf16 v[32:35], v[116:119], v[156:159], v[32:35]
    ds_read_b128 v[92:95], v211 offset:1856
    v_mfma_f32_16x16x32_bf16 v[36:39], v[116:119], v[160:163], v[36:39]
    ds_read2_b32 v[64:65], v178 offset0:208 offset1:209
    v_mfma_f32_16x16x32_bf16 v[40:43], v[116:119], v[164:167], v[40:43]
    ds_read2_b32 v[66:67], v178 offset0:210 offset1:211
    v_mfma_f32_16x16x32_bf16 v[44:47], v[116:119], v[168:171], v[44:47]
    ds_read_b128 v[96:99], v211 offset:2368
    v_mfma_f32_16x16x32_bf16 v[24:27], v[120:123], v[144:147], v[24:27]
    ds_read2_b32 v[68:69], v178 offset0:80 offset1:81
    v_mfma_f32_16x16x32_bf16 v[28:31], v[120:123], v[148:151], v[28:31]
    ds_read2_b32 v[70:71], v178 offset0:82 offset1:83
    v_mfma_f32_16x16x32_bf16 v[32:35], v[120:123], v[152:155], v[32:35]
    ds_read_b128 v[100:103], v211 offset:2880
    v_mfma_f32_16x16x32_bf16 v[36:39], v[120:123], v[156:159], v[36:39]
    ds_read2_b32 v[72:73], v179 offset0:208 offset1:209
    v_mfma_f32_16x16x32_bf16 v[40:43], v[120:123], v[160:163], v[40:43]
    ds_read2_b32 v[74:75], v179 offset0:210 offset1:211
    v_mfma_f32_16x16x32_bf16 v[44:47], v[120:123], v[164:167], v[44:47]
    ds_read_b128 v[104:107], v211 offset:3392
    v_mfma_f32_16x16x32_bf16 v[28:31], v[124:127], v[144:147], v[28:31]
    ds_read2_b32 v[76:77], v179 offset0:80 offset1:81
    v_mfma_f32_16x16x32_bf16 v[32:35], v[124:127], v[148:151], v[32:35]
    ds_read2_b32 v[78:79], v179 offset0:82 offset1:83
    v_mfma_f32_16x16x32_bf16 v[36:39], v[124:127], v[152:155], v[36:39]
    ds_read_b128 v[108:111], v211 offset:3904
    v_mfma_f32_16x16x32_bf16 v[40:43], v[124:127], v[156:159], v[40:43]
    v_mfma_f32_16x16x32_bf16 v[44:47], v[124:127], v[160:163], v[44:47]
    v_mfma_f32_16x16x32_bf16 v[32:35], v[128:131], v[144:147], v[32:35]
    v_mfma_f32_16x16x32_bf16 v[36:39], v[128:131], v[148:151], v[36:39]
    v_mfma_f32_16x16x32_bf16 v[40:43], v[128:131], v[152:155], v[40:43]
    v_mfma_f32_16x16x32_bf16 v[44:47], v[128:131], v[156:159], v[44:47]
    v_mfma_f32_16x16x32_bf16 v[36:39], v[132:135], v[144:147], v[36:39]
    v_mfma_f32_16x16x32_bf16 v[40:43], v[132:135], v[148:151], v[40:43]
    v_mfma_f32_16x16x32_bf16 v[44:47], v[132:135], v[152:155], v[44:47]
    v_mfma_f32_16x16x32_bf16 v[40:43], v[136:139], v[144:147], v[40:43]
    v_mfma_f32_16x16x32_bf16 v[44:47], v[136:139], v[148:151], v[44:47]
    v_mfma_f32_16x16x32_bf16 v[44:47], v[140:143], v[144:147], v[44:47]
    s_waitcnt lgkmcnt(0)
    v_mfma_f32_16x16x32_bf16 v[16:19], v[48:51], v[80:83], v[16:19]
    buffer_load_dword v254, v214, s[4:7], s63 offen
    ds_read2_b32 v[112:113], v176 offset0:192 offset1:193
    v_mfma_f32_16x16x32_bf16 v[20:23], v[48:51], v[84:87], v[20:23]
    ds_read2_b32 v[114:115], v176 offset0:194 offset1:195
    v_mfma_f32_16x16x32_bf16 v[24:27], v[48:51], v[88:91], v[24:27]
    ds_read_b128 v[144:147], v211 offset:256
    v_mfma_f32_16x16x32_bf16 v[28:31], v[48:51], v[92:95], v[28:31]
    ds_read2_b32 v[116:117], v176 offset0:64 offset1:65
    v_mfma_f32_16x16x32_bf16 v[32:35], v[48:51], v[96:99], v[32:35]
    ds_read2_b32 v[118:119], v176 offset0:66 offset1:67
    v_mfma_f32_16x16x32_bf16 v[36:39], v[48:51], v[100:103], v[36:39]
    ds_read_b128 v[148:151], v211 offset:768
    v_mfma_f32_16x16x32_bf16 v[40:43], v[48:51], v[104:107], v[40:43]
    ds_read2_b32 v[120:121], v177 offset0:192 offset1:193
    v_mfma_f32_16x16x32_bf16 v[44:47], v[48:51], v[108:111], v[44:47]
    ds_read2_b32 v[122:123], v177 offset0:194 offset1:195
    v_mfma_f32_16x16x32_bf16 v[20:23], v[52:55], v[80:83], v[20:23]
    ds_read_b128 v[152:155], v211 offset:1280
    v_mfma_f32_16x16x32_bf16 v[24:27], v[52:55], v[84:87], v[24:27]
    ds_read2_b32 v[124:125], v177 offset0:64 offset1:65
    v_mfma_f32_16x16x32_bf16 v[28:31], v[52:55], v[88:91], v[28:31]
    ds_read2_b32 v[126:127], v177 offset0:66 offset1:67
    v_mfma_f32_16x16x32_bf16 v[32:35], v[52:55], v[92:95], v[32:35]
    ds_read_b128 v[156:159], v211 offset:1792
    v_mfma_f32_16x16x32_bf16 v[36:39], v[52:55], v[96:99], v[36:39]
    ds_read2_b32 v[128:129], v178 offset0:192 offset1:193
    v_mfma_f32_16x16x32_bf16 v[40:43], v[52:55], v[100:103], v[40:43]
    ds_read2_b32 v[130:131], v178 offset0:194 offset1:195
    v_mfma_f32_16x16x32_bf16 v[44:47], v[52:55], v[104:107], v[44:47]
    ds_read_b128 v[160:163], v211 offset:2304
    v_mfma_f32_16x16x32_bf16 v[24:27], v[56:59], v[80:83], v[24:27]
    ds_read2_b32 v[132:133], v178 offset0:64 offset1:65
    v_mfma_f32_16x16x32_bf16 v[28:31], v[56:59], v[84:87], v[28:31]
    ds_read2_b32 v[134:135], v178 offset0:66 offset1:67
    v_mfma_f32_16x16x32_bf16 v[32:35], v[56:59], v[88:91], v[32:35]
    ds_read_b128 v[164:167], v211 offset:2816
    v_mfma_f32_16x16x32_bf16 v[36:39], v[56:59], v[92:95], v[36:39]
    ds_read2_b32 v[136:137], v179 offset0:192 offset1:193
    v_mfma_f32_16x16x32_bf16 v[40:43], v[56:59], v[96:99], v[40:43]
    ds_read2_b32 v[138:139], v179 offset0:194 offset1:195
    v_mfma_f32_16x16x32_bf16 v[44:47], v[56:59], v[100:103], v[44:47]
    ds_read_b128 v[168:171], v211 offset:3328
    v_mfma_f32_16x16x32_bf16 v[28:31], v[60:63], v[80:83], v[28:31]
    ds_read2_b32 v[140:141], v179 offset0:64 offset1:65
    v_mfma_f32_16x16x32_bf16 v[32:35], v[60:63], v[84:87], v[32:35]
    ds_read2_b32 v[142:143], v179 offset0:66 offset1:67
    v_mfma_f32_16x16x32_bf16 v[36:39], v[60:63], v[88:91], v[36:39]
    ds_read_b128 v[172:175], v211 offset:3840
    v_mfma_f32_16x16x32_bf16 v[40:43], v[60:63], v[92:95], v[40:43]
    v_mfma_f32_16x16x32_bf16 v[44:47], v[60:63], v[96:99], v[44:47]
    v_mfma_f32_16x16x32_bf16 v[32:35], v[64:67], v[80:83], v[32:35]
    v_mfma_f32_16x16x32_bf16 v[36:39], v[64:67], v[84:87], v[36:39]
    v_mfma_f32_16x16x32_bf16 v[40:43], v[64:67], v[88:91], v[40:43]
    v_mfma_f32_16x16x32_bf16 v[44:47], v[64:67], v[92:95], v[44:47]
    v_mfma_f32_16x16x32_bf16 v[36:39], v[68:71], v[80:83], v[36:39]
    v_mfma_f32_16x16x32_bf16 v[40:43], v[68:71], v[84:87], v[40:43]
    v_mfma_f32_16x16x32_bf16 v[44:47], v[68:71], v[88:91], v[44:47]
    v_mfma_f32_16x16x32_bf16 v[40:43], v[72:75], v[80:83], v[40:43]
    v_mfma_f32_16x16x32_bf16 v[44:47], v[72:75], v[84:87], v[44:47]
    v_mfma_f32_16x16x32_bf16 v[44:47], v[76:79], v[80:83], v[44:47]
    s_waitcnt lgkmcnt(0)
    v_mfma_f32_16x16x32_bf16 v[16:19], v[112:115], v[144:147], v[16:19]
    buffer_load_dword v254, v218, s[4:7], s63 offen
    ds_read2_b32 v[48:49], v176 offset0:176 offset1:177
    v_mfma_f32_16x16x32_bf16 v[20:23], v[112:115], v[148:151], v[20:23]
    ds_read2_b32 v[50:51], v176 offset0:178 offset1:179
    v_mfma_f32_16x16x32_bf16 v[24:27], v[112:115], v[152:155], v[24:27]
    ds_read_b128 v[80:83], v211 offset:192
    v_mfma_f32_16x16x32_bf16 v[28:31], v[112:115], v[156:159], v[28:31]
    ds_read2_b32 v[52:53], v176 offset0:48 offset1:49
    v_mfma_f32_16x16x32_bf16 v[32:35], v[112:115], v[160:163], v[32:35]
    ds_read2_b32 v[54:55], v176 offset0:50 offset1:51
    v_mfma_f32_16x16x32_bf16 v[36:39], v[112:115], v[164:167], v[36:39]
    ds_read_b128 v[84:87], v211 offset:704
    v_mfma_f32_16x16x32_bf16 v[40:43], v[112:115], v[168:171], v[40:43]
    ds_read2_b32 v[56:57], v177 offset0:176 offset1:177
    v_mfma_f32_16x16x32_bf16 v[44:47], v[112:115], v[172:175], v[44:47]
    ds_read2_b32 v[58:59], v177 offset0:178 offset1:179
    v_mfma_f32_16x16x32_bf16 v[20:23], v[116:119], v[144:147], v[20:23]
    ds_read_b128 v[88:91], v211 offset:1216
    v_mfma_f32_16x16x32_bf16 v[24:27], v[116:119], v[148:151], v[24:27]
    ds_read2_b32 v[60:61], v177 offset0:48 offset1:49
    v_mfma_f32_16x16x32_bf16 v[28:31], v[116:119], v[152:155], v[28:31]
    ds_read2_b32 v[62:63], v177 offset0:50 offset1:51
    v_mfma_f32_16x16x32_bf16 v[32:35], v[116:119], v[156:159], v[32:35]
    ds_read_b128 v[92:95], v211 offset:1728
    v_mfma_f32_16x16x32_bf16 v[36:39], v[116:119], v[160:163], v[36:39]
    ds_read2_b32 v[64:65], v178 offset0:176 offset1:177
    v_mfma_f32_16x16x32_bf16 v[40:43], v[116:119], v[164:167], v[40:43]
    ds_read2_b32 v[66:67], v178 offset0:178 offset1:179
    v_mfma_f32_16x16x32_bf16 v[44:47], v[116:119], v[168:171], v[44:47]
    ds_read_b128 v[96:99], v211 offset:2240
    v_mfma_f32_16x16x32_bf16 v[24:27], v[120:123], v[144:147], v[24:27]
    ds_read2_b32 v[68:69], v178 offset0:48 offset1:49
    v_mfma_f32_16x16x32_bf16 v[28:31], v[120:123], v[148:151], v[28:31]
    ds_read2_b32 v[70:71], v178 offset0:50 offset1:51
    v_mfma_f32_16x16x32_bf16 v[32:35], v[120:123], v[152:155], v[32:35]
    ds_read_b128 v[100:103], v211 offset:2752
    v_mfma_f32_16x16x32_bf16 v[36:39], v[120:123], v[156:159], v[36:39]
    ds_read2_b32 v[72:73], v179 offset0:176 offset1:177
    v_mfma_f32_16x16x32_bf16 v[40:43], v[120:123], v[160:163], v[40:43]
    ds_read2_b32 v[74:75], v179 offset0:178 offset1:179
    v_mfma_f32_16x16x32_bf16 v[44:47], v[120:123], v[164:167], v[44:47]
    ds_read_b128 v[104:107], v211 offset:3264
    v_mfma_f32_16x16x32_bf16 v[28:31], v[124:127], v[144:147], v[28:31]
    ds_read2_b32 v[76:77], v179 offset0:48 offset1:49
    v_mfma_f32_16x16x32_bf16 v[32:35], v[124:127], v[148:151], v[32:35]
    ds_read2_b32 v[78:79], v179 offset0:50 offset1:51
    v_mfma_f32_16x16x32_bf16 v[36:39], v[124:127], v[152:155], v[36:39]
    ds_read_b128 v[108:111], v211 offset:3776
    v_mfma_f32_16x16x32_bf16 v[40:43], v[124:127], v[156:159], v[40:43]
    v_mfma_f32_16x16x32_bf16 v[44:47], v[124:127], v[160:163], v[44:47]
    v_mfma_f32_16x16x32_bf16 v[32:35], v[128:131], v[144:147], v[32:35]
    v_mfma_f32_16x16x32_bf16 v[36:39], v[128:131], v[148:151], v[36:39]
    v_mfma_f32_16x16x32_bf16 v[40:43], v[128:131], v[152:155], v[40:43]
    v_mfma_f32_16x16x32_bf16 v[44:47], v[128:131], v[156:159], v[44:47]
    v_mfma_f32_16x16x32_bf16 v[36:39], v[132:135], v[144:147], v[36:39]
    v_mfma_f32_16x16x32_bf16 v[40:43], v[132:135], v[148:151], v[40:43]
    v_mfma_f32_16x16x32_bf16 v[44:47], v[132:135], v[152:155], v[44:47]
    v_mfma_f32_16x16x32_bf16 v[40:43], v[136:139], v[144:147], v[40:43]
    v_mfma_f32_16x16x32_bf16 v[44:47], v[136:139], v[148:151], v[44:47]
    v_mfma_f32_16x16x32_bf16 v[44:47], v[140:143], v[144:147], v[44:47]
    s_waitcnt lgkmcnt(0)
    v_mfma_f32_16x16x32_bf16 v[16:19], v[48:51], v[80:83], v[16:19]
    buffer_load_dword v254, v219, s[4:7], s63 offen
    ds_read2_b32 v[112:113], v176 offset0:160 offset1:161
    v_mfma_f32_16x16x32_bf16 v[20:23], v[48:51], v[84:87], v[20:23]
    ds_read2_b32 v[114:115], v176 offset0:162 offset1:163
    v_mfma_f32_16x16x32_bf16 v[24:27], v[48:51], v[88:91], v[24:27]
    ds_read_b128 v[144:147], v211 offset:128
    v_mfma_f32_16x16x32_bf16 v[28:31], v[48:51], v[92:95], v[28:31]
    ds_read2_b32 v[116:117], v176 offset0:32 offset1:33
    v_mfma_f32_16x16x32_bf16 v[32:35], v[48:51], v[96:99], v[32:35]
    ds_read2_b32 v[118:119], v176 offset0:34 offset1:35
    v_mfma_f32_16x16x32_bf16 v[36:39], v[48:51], v[100:103], v[36:39]
    ds_read_b128 v[148:151], v211 offset:640
    v_mfma_f32_16x16x32_bf16 v[40:43], v[48:51], v[104:107], v[40:43]
    ds_read2_b32 v[120:121], v177 offset0:160 offset1:161
    v_mfma_f32_16x16x32_bf16 v[44:47], v[48:51], v[108:111], v[44:47]
    ds_read2_b32 v[122:123], v177 offset0:162 offset1:163
    v_mfma_f32_16x16x32_bf16 v[20:23], v[52:55], v[80:83], v[20:23]
    ds_read_b128 v[152:155], v211 offset:1152
    v_mfma_f32_16x16x32_bf16 v[24:27], v[52:55], v[84:87], v[24:27]
    ds_read2_b32 v[124:125], v177 offset0:32 offset1:33
    v_mfma_f32_16x16x32_bf16 v[28:31], v[52:55], v[88:91], v[28:31]
    ds_read2_b32 v[126:127], v177 offset0:34 offset1:35
    v_mfma_f32_16x16x32_bf16 v[32:35], v[52:55], v[92:95], v[32:35]
    ds_read_b128 v[156:159], v211 offset:1664
    v_mfma_f32_16x16x32_bf16 v[36:39], v[52:55], v[96:99], v[36:39]
    ds_read2_b32 v[128:129], v178 offset0:160 offset1:161
    v_mfma_f32_16x16x32_bf16 v[40:43], v[52:55], v[100:103], v[40:43]
    ds_read2_b32 v[130:131], v178 offset0:162 offset1:163
    v_mfma_f32_16x16x32_bf16 v[44:47], v[52:55], v[104:107], v[44:47]
    ds_read_b128 v[160:163], v211 offset:2176
    v_mfma_f32_16x16x32_bf16 v[24:27], v[56:59], v[80:83], v[24:27]
    ds_read2_b32 v[132:133], v178 offset0:32 offset1:33
    v_mfma_f32_16x16x32_bf16 v[28:31], v[56:59], v[84:87], v[28:31]
    ds_read2_b32 v[134:135], v178 offset0:34 offset1:35
    v_mfma_f32_16x16x32_bf16 v[32:35], v[56:59], v[88:91], v[32:35]
    ds_read_b128 v[164:167], v211 offset:2688
    v_mfma_f32_16x16x32_bf16 v[36:39], v[56:59], v[92:95], v[36:39]
    ds_read2_b32 v[136:137], v179 offset0:160 offset1:161
    v_mfma_f32_16x16x32_bf16 v[40:43], v[56:59], v[96:99], v[40:43]
    ds_read2_b32 v[138:139], v179 offset0:162 offset1:163
    v_mfma_f32_16x16x32_bf16 v[44:47], v[56:59], v[100:103], v[44:47]
    ds_read_b128 v[168:171], v211 offset:3200
    v_mfma_f32_16x16x32_bf16 v[28:31], v[60:63], v[80:83], v[28:31]
    ds_read2_b32 v[140:141], v179 offset0:32 offset1:33
    v_mfma_f32_16x16x32_bf16 v[32:35], v[60:63], v[84:87], v[32:35]
    ds_read2_b32 v[142:143], v179 offset0:34 offset1:35
    v_mfma_f32_16x16x32_bf16 v[36:39], v[60:63], v[88:91], v[36:39]
    ds_read_b128 v[172:175], v211 offset:3712
    v_mfma_f32_16x16x32_bf16 v[40:43], v[60:63], v[92:95], v[40:43]
    v_mfma_f32_16x16x32_bf16 v[44:47], v[60:63], v[96:99], v[44:47]
    v_mfma_f32_16x16x32_bf16 v[32:35], v[64:67], v[80:83], v[32:35]
    v_mfma_f32_16x16x32_bf16 v[36:39], v[64:67], v[84:87], v[36:39]
    v_mfma_f32_16x16x32_bf16 v[40:43], v[64:67], v[88:91], v[40:43]
    v_mfma_f32_16x16x32_bf16 v[44:47], v[64:67], v[92:95], v[44:47]
    v_mfma_f32_16x16x32_bf16 v[36:39], v[68:71], v[80:83], v[36:39]
    v_mfma_f32_16x16x32_bf16 v[40:43], v[68:71], v[84:87], v[40:43]
    v_mfma_f32_16x16x32_bf16 v[44:47], v[68:71], v[88:91], v[44:47]
    v_mfma_f32_16x16x32_bf16 v[40:43], v[72:75], v[80:83], v[40:43]
    v_mfma_f32_16x16x32_bf16 v[44:47], v[72:75], v[84:87], v[44:47]
    v_mfma_f32_16x16x32_bf16 v[44:47], v[76:79], v[80:83], v[44:47]
    s_waitcnt lgkmcnt(0)
    v_mfma_f32_16x16x32_bf16 v[16:19], v[112:115], v[144:147], v[16:19]
    buffer_load_dword v254, v220, s[4:7], s63 offen
    ds_read2_b32 v[48:49], v176 offset0:144 offset1:145
    v_mfma_f32_16x16x32_bf16 v[20:23], v[112:115], v[148:151], v[20:23]
    s_mov_b32 s12, s64
    ds_read2_b32 v[50:51], v176 offset0:146 offset1:147
    v_mfma_f32_16x16x32_bf16 v[24:27], v[112:115], v[152:155], v[24:27]
    s_mov_b32 s13, s65
    ds_read_b128 v[80:83], v211 offset:64
    v_mfma_f32_16x16x32_bf16 v[28:31], v[112:115], v[156:159], v[28:31]
    s_mov_b32 s14, 0x280000
    ds_read2_b32 v[52:53], v176 offset0:16 offset1:17
    v_mfma_f32_16x16x32_bf16 v[32:35], v[112:115], v[160:163], v[32:35]
    s_mov_b32 s15, 0x20000
    ds_read2_b32 v[54:55], v176 offset0:18 offset1:19
    v_mfma_f32_16x16x32_bf16 v[36:39], v[112:115], v[164:167], v[36:39]
    s_mov_b32 s20, s88
    ds_read_b128 v[84:87], v211 offset:576
    v_mfma_f32_16x16x32_bf16 v[40:43], v[112:115], v[168:171], v[40:43]
    s_mov_b32 s21, s89
    ds_read2_b32 v[56:57], v177 offset0:144 offset1:145
    v_mfma_f32_16x16x32_bf16 v[44:47], v[112:115], v[172:175], v[44:47]
    s_mov_b32 s22, 0x280000
    ds_read2_b32 v[58:59], v177 offset0:146 offset1:147
    v_mfma_f32_16x16x32_bf16 v[20:23], v[116:119], v[144:147], v[20:23]
    s_mov_b32 s23, 0x20000
    ds_read_b128 v[88:91], v211 offset:1088
    v_mfma_f32_16x16x32_bf16 v[24:27], v[116:119], v[148:151], v[24:27]
    v_and_b32 v246, 15, v0
    ds_read2_b32 v[60:61], v177 offset0:16 offset1:17
    v_mfma_f32_16x16x32_bf16 v[28:31], v[116:119], v[152:155], v[28:31]
    v_lshlrev_b32 v247, 1, v246
    ds_read2_b32 v[62:63], v177 offset0:18 offset1:19
    v_mfma_f32_16x16x32_bf16 v[32:35], v[116:119], v[156:159], v[32:35]
    v_mul_u32_u24 v246, 1280, v246
    ds_read_b128 v[92:95], v211 offset:1600
    v_mfma_f32_16x16x32_bf16 v[36:39], v[116:119], v[160:163], v[36:39]
    v_lshrrev_b32 v248, 4, v0
    ds_read2_b32 v[64:65], v178 offset0:144 offset1:145
    v_mfma_f32_16x16x32_bf16 v[40:43], v[116:119], v[164:167], v[40:43]
    v_lshl_add_u32 v249, v248, 3, v246
    ds_read2_b32 v[66:67], v178 offset0:146 offset1:147
    v_mfma_f32_16x16x32_bf16 v[44:47], v[116:119], v[168:171], v[44:47]
    v_bfe_u32 v248, v0, 4, 1
    ds_read_b128 v[96:99], v211 offset:2112
    v_mfma_f32_16x16x32_bf16 v[24:27], v[120:123], v[144:147], v[24:27]
    v_lshl_add_u32 v246, v248, 5, v246
    ds_read2_b32 v[68:69], v178 offset0:16 offset1:17
    v_mfma_f32_16x16x32_bf16 v[28:31], v[120:123], v[148:151], v[28:31]
    v_lshrrev_b32 v248, 5, v0
    ds_read2_b32 v[70:71], v178 offset0:18 offset1:19
    v_mfma_f32_16x16x32_bf16 v[32:35], v[120:123], v[152:155], v[32:35]
    v_lshl_add_u32 v246, v248, 4, v246
    ds_read_b128 v[100:103], v211 offset:2624
    v_mfma_f32_16x16x32_bf16 v[36:39], v[120:123], v[156:159], v[36:39]
    s_lshl_b32 s39, s26, 2
    ds_read2_b32 v[72:73], v179 offset0:144 offset1:145
    v_mfma_f32_16x16x32_bf16 v[40:43], v[120:123], v[160:163], v[40:43]
    s_add_u32 s39, s39, s3
    ds_read2_b32 v[74:75], v179 offset0:146 offset1:147
    v_mfma_f32_16x16x32_bf16 v[44:47], v[120:123], v[164:167], v[44:47]
    s_lshl_b32 s29, s39, 5
    ds_read_b128 v[104:107], v211 offset:3136
    v_mfma_f32_16x16x32_bf16 v[28:31], v[124:127], v[144:147], v[28:31]
    s_mul_i32 s39, s39, 20480
    ds_read2_b32 v[76:77], v179 offset0:16 offset1:17
    v_mfma_f32_16x16x32_bf16 v[32:35], v[124:127], v[148:151], v[32:35]
    s_mul_i32 s55, s24, 160
    ds_read2_b32 v[78:79], v179 offset0:18 offset1:19
    v_mfma_f32_16x16x32_bf16 v[36:39], v[124:127], v[152:155], v[36:39]
    s_add_u32 s39, s39, s55
    ds_read_b128 v[108:111], v211 offset:3648
    v_mfma_f32_16x16x32_bf16 v[40:43], v[124:127], v[156:159], v[40:43]
    v_add_u32 v247, s29, v247
    v_mfma_f32_16x16x32_bf16 v[44:47], v[124:127], v[160:163], v[44:47]
    v_mfma_f32_16x16x32_bf16 v[32:35], v[128:131], v[144:147], v[32:35]
    buffer_load_dwordx4 v[180:183], v246, s[12:15], s39 offen offset:0
    v_mfma_f32_16x16x32_bf16 v[36:39], v[128:131], v[148:151], v[36:39]
    v_mfma_f32_16x16x32_bf16 v[40:43], v[128:131], v[152:155], v[40:43]
    buffer_load_dwordx4 v[184:187], v246, s[12:15], s39 offen offset:64
    v_mfma_f32_16x16x32_bf16 v[44:47], v[128:131], v[156:159], v[44:47]
    v_mfma_f32_16x16x32_bf16 v[36:39], v[132:135], v[144:147], v[36:39]
    buffer_load_dwordx2 v[188:189], v249, s[12:15], s39 offen offset:128
    v_mfma_f32_16x16x32_bf16 v[40:43], v[132:135], v[148:151], v[40:43]
    v_mfma_f32_16x16x32_bf16 v[44:47], v[132:135], v[152:155], v[44:47]
    global_load_ushort v190, v247, s[86:87]
    v_mfma_f32_16x16x32_bf16 v[40:43], v[136:139], v[144:147], v[40:43]
    v_mfma_f32_16x16x32_bf16 v[44:47], v[136:139], v[148:151], v[44:47]
    v_mfma_f32_16x16x32_bf16 v[44:47], v[140:143], v[144:147], v[44:47]
    s_waitcnt lgkmcnt(0)
    v_mfma_f32_16x16x32_bf16 v[16:19], v[48:51], v[80:83], v[16:19]
    s_add_u32 m0, s32, 0
    s_add_u32 s54, s101, 0
    s_mul_i32 s54, s54, 131072
    s_add_u32 s54, s54, s34
    buffer_load_dwordx4 v3, s[4:7], s54 offen offset:0  lds
    buffer_load_dwordx4 v4, s[4:7], s54 offen offset:1024  lds
    ds_read2_b32 v[112:113], v176 offset0:128 offset1:129
    v_mfma_f32_16x16x32_bf16 v[20:23], v[48:51], v[84:87], v[20:23]
    ds_read2_b32 v[114:115], v176 offset0:130 offset1:131
    v_mfma_f32_16x16x32_bf16 v[24:27], v[48:51], v[88:91], v[24:27]
    ds_read_b128 v[144:147], v211 offset:0
    v_mfma_f32_16x16x32_bf16 v[28:31], v[48:51], v[92:95], v[28:31]
    ds_read2_b32 v[116:117], v176 offset0:0 offset1:1
    v_mfma_f32_16x16x32_bf16 v[32:35], v[48:51], v[96:99], v[32:35]
    ds_read2_b32 v[118:119], v176 offset0:2 offset1:3
    v_mfma_f32_16x16x32_bf16 v[36:39], v[48:51], v[100:103], v[36:39]
    ds_read_b128 v[148:151], v211 offset:512
    v_mfma_f32_16x16x32_bf16 v[40:43], v[48:51], v[104:107], v[40:43]
    ds_read2_b32 v[120:121], v177 offset0:128 offset1:129
    v_mfma_f32_16x16x32_bf16 v[44:47], v[48:51], v[108:111], v[44:47]
    buffer_load_dwordx4 v252, s[4:7], s54 offen offset:2048  lds
    buffer_load_dwordx4 v253, s[4:7], s54 offen offset:3072  lds
    ds_read2_b32 v[122:123], v177 offset0:130 offset1:131
    v_mfma_f32_16x16x32_bf16 v[20:23], v[52:55], v[80:83], v[20:23]
    ds_read_b128 v[152:155], v211 offset:1024
    v_mfma_f32_16x16x32_bf16 v[24:27], v[52:55], v[84:87], v[24:27]
    ds_read2_b32 v[124:125], v177 offset0:0 offset1:1
    v_mfma_f32_16x16x32_bf16 v[28:31], v[52:55], v[88:91], v[28:31]
    ds_read2_b32 v[126:127], v177 offset0:2 offset1:3
    v_mfma_f32_16x16x32_bf16 v[32:35], v[52:55], v[92:95], v[32:35]
    ds_read_b128 v[156:159], v211 offset:1536
    v_mfma_f32_16x16x32_bf16 v[36:39], v[52:55], v[96:99], v[36:39]
    ds_read2_b32 v[128:129], v178 offset0:128 offset1:129
    v_mfma_f32_16x16x32_bf16 v[40:43], v[52:55], v[100:103], v[40:43]
    ds_read2_b32 v[130:131], v178 offset0:130 offset1:131
    v_mfma_f32_16x16x32_bf16 v[44:47], v[52:55], v[104:107], v[44:47]
    ds_read_b128 v[160:163], v211 offset:2048
    s_add_u32 m0, s32, 4096
    s_add_u32 s54, s101, 1
    s_mul_i32 s54, s54, 131072
    s_add_u32 s54, s54, s34
    buffer_load_dwordx4 v3, s[4:7], s54 offen offset:0  lds
    buffer_load_dwordx4 v4, s[4:7], s54 offen offset:1024  lds
    v_mfma_f32_16x16x32_bf16 v[24:27], v[56:59], v[80:83], v[24:27]
    ds_read2_b32 v[132:133], v178 offset0:0 offset1:1
    v_mfma_f32_16x16x32_bf16 v[28:31], v[56:59], v[84:87], v[28:31]
    ds_read2_b32 v[134:135], v178 offset0:2 offset1:3
    v_mfma_f32_16x16x32_bf16 v[32:35], v[56:59], v[88:91], v[32:35]
    ds_read_b128 v[164:167], v211 offset:2560
    v_mfma_f32_16x16x32_bf16 v[36:39], v[56:59], v[92:95], v[36:39]
    ds_read2_b32 v[136:137], v179 offset0:128 offset1:129
    v_mfma_f32_16x16x32_bf16 v[40:43], v[56:59], v[96:99], v[40:43]
    ds_read2_b32 v[138:139], v179 offset0:130 offset1:131
    v_mfma_f32_16x16x32_bf16 v[44:47], v[56:59], v[100:103], v[44:47]
    ds_read_b128 v[168:171], v211 offset:3072
    v_mfma_f32_16x16x32_bf16 v[28:31], v[60:63], v[80:83], v[28:31]
    ds_read2_b32 v[140:141], v179 offset0:0 offset1:1
    v_mfma_f32_16x16x32_bf16 v[32:35], v[60:63], v[84:87], v[32:35]
    buffer_load_dwordx4 v252, s[4:7], s54 offen offset:2048  lds
    buffer_load_dwordx4 v253, s[4:7], s54 offen offset:3072  lds
    ds_read2_b32 v[142:143], v179 offset0:2 offset1:3
    v_mfma_f32_16x16x32_bf16 v[36:39], v[60:63], v[88:91], v[36:39]
    ds_read_b128 v[172:175], v211 offset:3584
    v_mfma_f32_16x16x32_bf16 v[40:43], v[60:63], v[92:95], v[40:43]
    v_mfma_f32_16x16x32_bf16 v[44:47], v[60:63], v[96:99], v[44:47]
    v_mfma_f32_16x16x32_bf16 v[32:35], v[64:67], v[80:83], v[32:35]
    v_mfma_f32_16x16x32_bf16 v[36:39], v[64:67], v[84:87], v[36:39]
    v_mfma_f32_16x16x32_bf16 v[40:43], v[64:67], v[88:91], v[40:43]
    v_mfma_f32_16x16x32_bf16 v[44:47], v[64:67], v[92:95], v[44:47]
    v_mfma_f32_16x16x32_bf16 v[36:39], v[68:71], v[80:83], v[36:39]
    v_mfma_f32_16x16x32_bf16 v[40:43], v[68:71], v[84:87], v[40:43]
    v_mfma_f32_16x16x32_bf16 v[44:47], v[68:71], v[88:91], v[44:47]
    v_mfma_f32_16x16x32_bf16 v[40:43], v[72:75], v[80:83], v[40:43]
    v_mfma_f32_16x16x32_bf16 v[44:47], v[72:75], v[84:87], v[44:47]
    v_mfma_f32_16x16x32_bf16 v[44:47], v[76:79], v[80:83], v[44:47]
    s_waitcnt lgkmcnt(0)
    v_mfma_f32_16x16x32_bf16 v[16:19], v[112:115], v[144:147], v[16:19]
    s_add_u32 m0, s32, 8192
    s_add_u32 s54, s101, 2
    s_mul_i32 s54, s54, 131072
    s_add_u32 s54, s54, s34
    buffer_load_dwordx4 v3, s[4:7], s54 offen offset:0  lds
    buffer_load_dwordx4 v4, s[4:7], s54 offen offset:1024  lds
    v_mfma_f32_16x16x32_bf16 v[20:23], v[112:115], v[148:151], v[20:23]
    v_mfma_f32_16x16x32_bf16 v[24:27], v[112:115], v[152:155], v[24:27]
    v_mfma_f32_16x16x32_bf16 v[28:31], v[112:115], v[156:159], v[28:31]
    v_mfma_f32_16x16x32_bf16 v[32:35], v[112:115], v[160:163], v[32:35]
    v_mfma_f32_16x16x32_bf16 v[36:39], v[112:115], v[164:167], v[36:39]
    v_mfma_f32_16x16x32_bf16 v[40:43], v[112:115], v[168:171], v[40:43]
    v_mfma_f32_16x16x32_bf16 v[44:47], v[112:115], v[172:175], v[44:47]
    v_mfma_f32_16x16x32_bf16 v[20:23], v[116:119], v[144:147], v[20:23]
    buffer_load_dwordx4 v252, s[4:7], s54 offen offset:2048  lds
    buffer_load_dwordx4 v253, s[4:7], s54 offen offset:3072  lds
    v_mfma_f32_16x16x32_bf16 v[24:27], v[116:119], v[148:151], v[24:27]
    v_mfma_f32_16x16x32_bf16 v[28:31], v[116:119], v[152:155], v[28:31]
    v_mfma_f32_16x16x32_bf16 v[32:35], v[116:119], v[156:159], v[32:35]
    v_mfma_f32_16x16x32_bf16 v[36:39], v[116:119], v[160:163], v[36:39]
    v_mfma_f32_16x16x32_bf16 v[40:43], v[116:119], v[164:167], v[40:43]
    v_mfma_f32_16x16x32_bf16 v[44:47], v[116:119], v[168:171], v[44:47]
    v_mfma_f32_16x16x32_bf16 v[24:27], v[120:123], v[144:147], v[24:27]
    v_mfma_f32_16x16x32_bf16 v[28:31], v[120:123], v[148:151], v[28:31]
    v_mfma_f32_16x16x32_bf16 v[32:35], v[120:123], v[152:155], v[32:35]
    s_add_u32 m0, s32, 12288
    s_add_u32 s54, s101, 3
    s_mul_i32 s54, s54, 131072
    s_add_u32 s54, s54, s34
    buffer_load_dwordx4 v3, s[4:7], s54 offen offset:0  lds
    buffer_load_dwordx4 v4, s[4:7], s54 offen offset:1024  lds
    v_mfma_f32_16x16x32_bf16 v[36:39], v[120:123], v[156:159], v[36:39]
    v_mfma_f32_16x16x32_bf16 v[40:43], v[120:123], v[160:163], v[40:43]
    v_mfma_f32_16x16x32_bf16 v[44:47], v[120:123], v[164:167], v[44:47]
    v_mfma_f32_16x16x32_bf16 v[28:31], v[124:127], v[144:147], v[28:31]
    v_mfma_f32_16x16x32_bf16 v[32:35], v[124:127], v[148:151], v[32:35]
    v_mfma_f32_16x16x32_bf16 v[36:39], v[124:127], v[152:155], v[36:39]
    v_mfma_f32_16x16x32_bf16 v[40:43], v[124:127], v[156:159], v[40:43]
    v_mfma_f32_16x16x32_bf16 v[44:47], v[124:127], v[160:163], v[44:47]
    v_mfma_f32_16x16x32_bf16 v[32:35], v[128:131], v[144:147], v[32:35]
    buffer_load_dwordx4 v252, s[4:7], s54 offen offset:2048  lds
    buffer_load_dwordx4 v253, s[4:7], s54 offen offset:3072  lds
    v_mfma_f32_16x16x32_bf16 v[36:39], v[128:131], v[148:151], v[36:39]
    v_mfma_f32_16x16x32_bf16 v[40:43], v[128:131], v[152:155], v[40:43]
    v_mfma_f32_16x16x32_bf16 v[44:47], v[128:131], v[156:159], v[44:47]
    v_mfma_f32_16x16x32_bf16 v[36:39], v[132:135], v[144:147], v[36:39]
    v_mfma_f32_16x16x32_bf16 v[40:43], v[132:135], v[148:151], v[40:43]
    v_mfma_f32_16x16x32_bf16 v[44:47], v[132:135], v[152:155], v[44:47]
    v_mfma_f32_16x16x32_bf16 v[40:43], v[136:139], v[144:147], v[40:43]
    v_mfma_f32_16x16x32_bf16 v[44:47], v[136:139], v[148:151], v[44:47]
    v_mfma_f32_16x16x32_bf16 v[44:47], v[140:143], v[144:147], v[44:47]
    s_lshl_b32 s37, s35, 12
    s_add_u32 s37, s37, 0x700000
    v_and_b32 v192, 15, v0
    v_lshlrev_b32 v192, 5, v192
    v_bfe_u32 v193, v0, 4, 1
    v_lshl_add_u32 v192, v193, 9, v192
    v_lshrrev_b32 v193, 5, v0
    v_lshl_add_u32 v192, v193, 4, v192
    v_cvt_pk_bf16_f32 v194, v16, v17
    v_cvt_pk_bf16_f32 v195, v18, v19
    v_cvt_pk_bf16_f32 v196, v20, v21
    v_cvt_pk_bf16_f32 v197, v22, v23
    s_nop 0
    v_permlane16_swap_b32 v194, v196
    v_permlane16_swap_b32 v195, v197
    buffer_store_dwordx4 v[194:197], v192, s[8:11], s37 offen offset:0 sc1
    v_cvt_pk_bf16_f32 v198, v24, v25
    v_cvt_pk_bf16_f32 v199, v26, v27
    v_cvt_pk_bf16_f32 v200, v28, v29
    v_cvt_pk_bf16_f32 v201, v30, v31
    s_nop 0
    v_permlane16_swap_b32 v198, v200
    v_permlane16_swap_b32 v199, v201
    buffer_store_dwordx4 v[198:201], v192, s[8:11], s37 offen offset:1024 sc1
    v_cvt_pk_bf16_f32 v202, v32, v33
    v_cvt_pk_bf16_f32 v203, v34, v35
    v_cvt_pk_bf16_f32 v204, v36, v37
    v_cvt_pk_bf16_f32 v205, v38, v39
    s_nop 0
    v_permlane16_swap_b32 v202, v204
    v_permlane16_swap_b32 v203, v205
    buffer_store_dwordx4 v[202:205], v192, s[8:11], s37 offen offset:2048 sc1
    v_cvt_pk_bf16_f32 v206, v40, v41
    v_cvt_pk_bf16_f32 v207, v42, v43
    v_cvt_pk_bf16_f32 v208, v44, v45
    v_cvt_pk_bf16_f32 v209, v46, v47
    s_nop 0
    v_permlane16_swap_b32 v206, v208
    v_permlane16_swap_b32 v207, v209
    buffer_store_dwordx4 v[206:209], v192, s[8:11], s37 offen offset:3072 sc1
    s_waitcnt vmcnt(16)
    s_nop 0
    ds_read_b64_tr_b16 a[0:1], v10 offset:0
    ds_read_b64_tr_b16 a[2:3], v10 offset:1024
    ds_read_b64_tr_b16 a[4:5], v11 offset:0
    ds_read_b64_tr_b16 a[6:7], v11 offset:1024
    ds_read_b64_tr_b16 a[8:9], v12 offset:0
    ds_read_b64_tr_b16 a[10:11], v12 offset:1024
    ds_read_b64_tr_b16 a[12:13], v13 offset:0
    ds_read_b64_tr_b16 a[14:15], v13 offset:1024
    s_waitcnt vmcnt(12)
    s_nop 0
    ds_read_b64_tr_b16 a[16:17], v10 offset:4096
    ds_read_b64_tr_b16 a[18:19], v10 offset:5120
    ds_read_b64_tr_b16 a[20:21], v11 offset:4096
    ds_read_b64_tr_b16 a[22:23], v11 offset:5120
    ds_read_b64_tr_b16 a[24:25], v12 offset:4096
    ds_read_b64_tr_b16 a[26:27], v12 offset:5120
    ds_read_b64_tr_b16 a[28:29], v13 offset:4096
    ds_read_b64_tr_b16 a[30:31], v13 offset:5120
    s_waitcnt vmcnt(8)
    s_nop 0
    ds_read_b64_tr_b16 a[32:33], v10 offset:8192
    ds_read_b64_tr_b16 a[34:35], v10 offset:9216
    ds_read_b64_tr_b16 a[36:37], v11 offset:8192
    ds_read_b64_tr_b16 a[38:39], v11 offset:9216
    ds_read_b64_tr_b16 a[40:41], v12 offset:8192
    ds_read_b64_tr_b16 a[42:43], v12 offset:9216
    ds_read_b64_tr_b16 a[44:45], v13 offset:8192
    ds_read_b64_tr_b16 a[46:47], v13 offset:9216
    s_waitcnt vmcnt(4)
    s_nop 0
    ds_read_b64_tr_b16 a[48:49], v10 offset:12288
    ds_read_b64_tr_b16 a[50:51], v10 offset:13312
    ds_read_b64_tr_b16 a[52:53], v11 offset:12288
    ds_read_b64_tr_b16 a[54:55], v11 offset:13312
    ds_read_b64_tr_b16 a[56:57], v12 offset:12288
    ds_read_b64_tr_b16 a[58:59], v12 offset:13312
    ds_read_b64_tr_b16 a[60:61], v13 offset:12288
    ds_read_b64_tr_b16 a[62:63], v13 offset:13312
    s_add_u32 m0, s33, 0
    s_sub_u32 s54, 8, s101
    s_mul_i32 s54, s54, 131072
    s_add_u32 s54, s54, s34
    buffer_load_dwordx4 v3, s[4:7], s54 offen offset:0  lds
    buffer_load_dwordx4 v4, s[4:7], s54 offen offset:1024  lds
    buffer_load_dwordx4 v252, s[4:7], s54 offen offset:2048  lds
    buffer_load_dwordx4 v253, s[4:7], s54 offen offset:3072  lds
    s_add_u32 m0, s33, 4096
    s_sub_u32 s54, 9, s101
    s_mul_i32 s54, s54, 131072
    s_add_u32 s54, s54, s34
    buffer_load_dwordx4 v3, s[4:7], s54 offen offset:0  lds
    buffer_load_dwordx4 v4, s[4:7], s54 offen offset:1024  lds
    buffer_load_dwordx4 v252, s[4:7], s54 offen offset:2048  lds
    buffer_load_dwordx4 v253, s[4:7], s54 offen offset:3072  lds
    s_add_u32 m0, s33, 8192
    s_sub_u32 s54, 10, s101
    s_mul_i32 s54, s54, 131072
    s_add_u32 s54, s54, s34
    buffer_load_dwordx4 v3, s[4:7], s54 offen offset:0  lds
    buffer_load_dwordx4 v4, s[4:7], s54 offen offset:1024  lds
    buffer_load_dwordx4 v252, s[4:7], s54 offen offset:2048  lds
    buffer_load_dwordx4 v253, s[4:7], s54 offen offset:3072  lds
    s_add_u32 m0, s33, 12288
    s_sub_u32 s54, 11, s101
    s_mul_i32 s54, s54, 131072
    s_add_u32 s54, s54, s34
    buffer_load_dwordx4 v3, s[4:7], s54 offen offset:0  lds
    buffer_load_dwordx4 v4, s[4:7], s54 offen offset:1024  lds
    buffer_load_dwordx4 v252, s[4:7], s54 offen offset:2048  lds
    buffer_load_dwordx4 v253, s[4:7], s54 offen offset:3072  lds
    s_waitcnt lgkmcnt(0)
    v_add_u32 v10, 65536, v10
    v_add_u32 v11, 65536, v11
    v_add_u32 v12, 65536, v12
    v_add_u32 v13, 65536, v13
    s_add_u32 m0, s32, 0
    s_add_u32 s54, s101, 4
    s_mul_i32 s54, s54, 131072
    s_add_u32 s54, s54, s34
    buffer_load_dwordx4 v3, s[4:7], s54 offen offset:0  lds
    buffer_load_dwordx4 v4, s[4:7], s54 offen offset:1024  lds
    buffer_load_dwordx4 v252, s[4:7], s54 offen offset:2048  lds
    buffer_load_dwordx4 v253, s[4:7], s54 offen offset:3072  lds
    s_add_u32 m0, s32, 4096
    s_add_u32 s54, s101, 5
    s_mul_i32 s54, s54, 131072
    s_add_u32 s54, s54, s34
    buffer_load_dwordx4 v3, s[4:7], s54 offen offset:0  lds
    buffer_load_dwordx4 v4, s[4:7], s54 offen offset:1024  lds
    buffer_load_dwordx4 v252, s[4:7], s54 offen offset:2048  lds
    buffer_load_dwordx4 v253, s[4:7], s54 offen offset:3072  lds
    s_add_u32 m0, s32, 8192
    s_sub_u32 s54, 6, s101
    s_mul_i32 s54, s54, 131072
    s_add_u32 s54, s54, s34
    buffer_load_dwordx4 v3, s[4:7], s54 offen offset:0  lds
    buffer_load_dwordx4 v4, s[4:7], s54 offen offset:1024  lds
    buffer_load_dwordx4 v252, s[4:7], s54 offen offset:2048  lds
    buffer_load_dwordx4 v253, s[4:7], s54 offen offset:3072  lds
    s_add_u32 m0, s32, 12288
    s_sub_u32 s54, 7, s101
    s_mul_i32 s54, s54, 131072
    s_add_u32 s54, s54, s34
    buffer_load_dwordx4 v3, s[4:7], s54 offen offset:0  lds
    buffer_load_dwordx4 v4, s[4:7], s54 offen offset:1024  lds
    buffer_load_dwordx4 v252, s[4:7], s54 offen offset:2048  lds
    buffer_load_dwordx4 v253, s[4:7], s54 offen offset:3072  lds
    s_mov_b32 s38, 0
    v_mov_b32 v240, 0
    v_mov_b32 v241, 0
L_G2:
    v_mul_u32_u24_e64 v250, 64, v0
    s_mul_i32 s42, s24, 2048
    s_add_u32 s43, s42, 0xa20000
    s_add_u32 s42, s42, 0xa10000
    s_mul_i32 s36, s3, 491520
    s_mul_i32 s44, s24, 5120
    s_add_u32 s36, s36, s44
    s_add_u32 s36, s36, 0x500000
    s_mov_b32 s59, s43
    s_mul_i32 s43, s3, 384
    s_add_u32 s42, s42, s43
    s_waitcnt lgkmcnt(0)
    s_mov_b64 exec, 63
    v_cmp_ne_u64 vcc, s[30:31], v[240:241]
    s_mov_b64 exec, -1
    s_cbranch_vccz L_np2
    s_mov_b64 exec, 0x3f
    s_mov_b32 s29, 0
L_pl29:
    buffer_load_dwordx2 v[242:243], v250, s[8:11], s42 offen sc1
    s_add_u32 s29, s29, 1
    s_cmp_gt_u32 s29, 262144
    s_cbranch_scc1 L_pl30
    s_waitcnt vmcnt(0)
    v_cmp_ne_u64 vcc, s[30:31], v[242:243]
    s_cbranch_vccz L_pl30
    s_branch L_pl29
L_pl30:
    s_mov_b64 exec, -1
L_np2:
    s_add_u32 s62, s101, 0
    s_mul_i32 s62, s62, 40960
    s_add_u32 s62, s62, s36
    buffer_load_dwordx4 v[96:99], v1, s[8:11], s62 offen offset:0 sc1
    buffer_load_dwordx4 v[100:103], v1, s[8:11], s62 offen offset:1024 sc1
    buffer_load_dwordx4 v[104:107], v1, s[8:11], s62 offen offset:2048 sc1
    buffer_load_dwordx4 v[108:111], v1, s[8:11], s62 offen offset:3072 sc1
    buffer_load_dwordx4 v[112:115], v2, s[8:11], s62 offen sc1
    s_add_u32 s63, s101, 1
    s_mul_i32 s63, s63, 40960
    s_add_u32 s63, s63, s36
    buffer_load_dwordx4 v[116:119], v1, s[8:11], s63 offen offset:0 sc1
    buffer_load_dwordx4 v[120:123], v1, s[8:11], s63 offen offset:1024 sc1
    buffer_load_dwordx4 v[124:127], v1, s[8:11], s63 offen offset:2048 sc1
    buffer_load_dwordx4 v[128:131], v1, s[8:11], s63 offen offset:3072 sc1
    buffer_load_dwordx4 v[132:135], v2, s[8:11], s63 offen sc1
    s_add_u32 s62, s101, 2
    s_mul_i32 s62, s62, 40960
    s_add_u32 s62, s62, s36
    buffer_load_dwordx4 v[136:139], v1, s[8:11], s62 offen offset:0 sc1
    buffer_load_dwordx4 v[140:143], v1, s[8:11], s62 offen offset:1024 sc1
    s_cmp_eq_u32 s38, 0
    s_cbranch_scc1 L_nost3
    s_cmp_lt_u32 s3, 2
    s_cbranch_scc0 L_cy1
    ds_read_b128 v[48:51], v176 offset:4096
    ds_read_b128 v[52:55], v176 offset:5120
    ds_read_b128 v[56:59], v176 offset:6144
    ds_read_b128 v[60:63], v176 offset:7168
    s_waitcnt lgkmcnt(3)
    v_pk_add_f32 v[64:65], v[16:17], v[48:49]
    v_pk_add_f32 v[66:67], v[18:19], v[50:51]
    s_waitcnt lgkmcnt(2)
    v_pk_add_f32 v[68:69], v[20:21], v[52:53]
    v_pk_add_f32 v[70:71], v[22:23], v[54:55]
    s_waitcnt lgkmcnt(1)
    v_pk_add_f32 v[72:73], v[24:25], v[56:57]
    v_pk_add_f32 v[74:75], v[26:27], v[58:59]
    s_waitcnt lgkmcnt(0)
    v_pk_add_f32 v[76:77], v[28:29], v[60:61]
    v_pk_add_f32 v[78:79], v[30:31], v[62:63]
    s_branch L_cy2
L_cy1:
    ds_read_b128 v[48:51], v176 offset:0
    ds_read_b128 v[52:55], v176 offset:1024
    ds_read_b128 v[56:59], v176 offset:2048
    ds_read_b128 v[60:63], v176 offset:3072
    s_waitcnt lgkmcnt(3)
    v_pk_add_f32 v[64:65], v[32:33], v[48:49]
    v_pk_add_f32 v[66:67], v[34:35], v[50:51]
    s_waitcnt lgkmcnt(2)
    v_pk_add_f32 v[68:69], v[36:37], v[52:53]
    v_pk_add_f32 v[70:71], v[38:39], v[54:55]
    s_waitcnt lgkmcnt(1)
    v_pk_add_f32 v[72:73], v[40:41], v[56:57]
    v_pk_add_f32 v[74:75], v[42:43], v[58:59]
    s_waitcnt lgkmcnt(0)
    v_pk_add_f32 v[76:77], v[44:45], v[60:61]
    v_pk_add_f32 v[78:79], v[46:47], v[62:63]
L_cy2:
    v_cvt_pk_bf16_f32 v218, v64, v65
    v_cvt_pk_bf16_f32 v219, v66, v67
    v_cvt_pk_bf16_f32 v220, v68, v69
    v_cvt_pk_bf16_f32 v221, v70, v71
    s_nop 0
    v_permlane16_swap_b32 v218, v220
    v_permlane16_swap_b32 v219, v221
    buffer_store_dwordx4 v[218:221], v216, s[8:11], s37 offen offset:0 sc1
    v_cvt_pk_bf16_f32 v222, v72, v73
    v_cvt_pk_bf16_f32 v223, v74, v75
    v_cvt_pk_bf16_f32 v224, v76, v77
    v_cvt_pk_bf16_f32 v225, v78, v79
    s_nop 0
    v_permlane16_swap_b32 v222, v224
    v_permlane16_swap_b32 v223, v225
    buffer_store_dwordx4 v[222:225], v216, s[8:11], s37 offen offset:1024 sc1
L_nost3:
    v_subrev_u32 v10, 65536, v10
    v_subrev_u32 v11, 65536, v11
    v_subrev_u32 v12, 65536, v12
    v_subrev_u32 v13, 65536, v13
    s_waitcnt vmcnt(11)
    v_mfma_f32_16x16x32_bf16 v[16:19], v[96:99], a[0:3], 0
    s_add_u32 s63, s101, 3
    s_mul_i32 s63, s63, 40960
    v_mfma_f32_16x16x32_bf16 v[36:39], v[96:99], a[4:7], 0
    buffer_load_dwordx4 v[144:147], v1, s[8:11], s62 offen offset:2048 sc1
    v_mfma_f32_16x16x32_bf16 v[56:59], v[96:99], a[8:11], 0
    s_add_u32 s63, s63, s36
    v_mfma_f32_16x16x32_bf16 v[76:79], v[96:99], a[12:15], 0
    s_xor_b32 s42, s3, 1
    s_mul_i32 s42, s42, 15360
    s_add_u32 s42, s42, 0
    v_add_u32 v212, s42, v1
    s_waitcnt vmcnt(11)
    v_mfma_f32_16x16x32_bf16 v[20:23], v[100:103], a[0:3], 0
    s_xor_b32 s42, s3, 2
    s_mul_i32 s42, s42, 15360
    v_mfma_f32_16x16x32_bf16 v[40:43], v[100:103], a[4:7], 0
    buffer_load_dwordx4 v[148:151], v1, s[8:11], s62 offen offset:3072 sc1
    v_mfma_f32_16x16x32_bf16 v[60:63], v[100:103], a[8:11], 0
    s_add_u32 s42, s42, 5120
    v_add_u32 v213, s42, v1
    v_mfma_f32_16x16x32_bf16 v[80:83], v[100:103], a[12:15], 0
    s_waitcnt vmcnt(11)
    v_mfma_f32_16x16x32_bf16 v[24:27], v[104:107], a[0:3], 0
    s_xor_b32 s42, s3, 3
    s_mul_i32 s42, s42, 15360
    v_mfma_f32_16x16x32_bf16 v[44:47], v[104:107], a[4:7], 0
    buffer_load_dwordx4 v[152:155], v2, s[8:11], s62 offen sc1
    v_mfma_f32_16x16x32_bf16 v[64:67], v[104:107], a[8:11], 0
    s_add_u32 s42, s42, 10240
    v_add_u32 v214, s42, v1
    v_mfma_f32_16x16x32_bf16 v[84:87], v[104:107], a[12:15], 0
    s_waitcnt vmcnt(11)
    v_mfma_f32_16x16x32_bf16 v[28:31], v[108:111], a[0:3], 0
    s_mul_i32 s42, s3, 15360
    v_add_u32 v215, s42, v1
    v_mfma_f32_16x16x32_bf16 v[48:51], v[108:111], a[4:7], 0
    buffer_load_dwordx4 v[156:159], v1, s[8:11], s63 offen offset:0 sc1
    v_mfma_f32_16x16x32_bf16 v[68:71], v[108:111], a[8:11], 0
    s_add_u32 s62, s101, 4
    s_mul_i32 s62, s62, 40960
    v_mfma_f32_16x16x32_bf16 v[88:91], v[108:111], a[12:15], 0
    v_lshlrev_b32 v190, 16, v190
    v_permlane16_swap_b32 v180, v182
    s_waitcnt vmcnt(11)
    v_mfma_f32_16x16x32_bf16 v[32:35], v[112:115], a[0:3], 0
    s_add_u32 s62, s62, s36
    v_mfma_f32_16x16x32_bf16 v[52:55], v[112:115], a[4:7], 0
    buffer_load_dwordx4 v[160:163], v1, s[8:11], s63 offen offset:1024 sc1
    v_mfma_f32_16x16x32_bf16 v[72:75], v[112:115], a[8:11], 0
    v_permlane16_swap_b32 v181, v183
    v_permlane16_swap_b32 v184, v186
    v_mfma_f32_16x16x32_bf16 v[92:95], v[112:115], a[12:15], 0
    v_permlane16_swap_b32 v185, v187
    v_lshlrev_b32 v192, 16, v180
    s_waitcnt vmcnt(11)
    v_mfma_f32_16x16x32_bf16 v[16:19], v[116:119], a[16:19], v[16:19]
    v_and_b32 v193, 0xffff0000, v180
    v_pk_add_f32 v[192:193], v[192:193], v[190:191] op_sel_hi:[1,0]
    v_mfma_f32_16x16x32_bf16 v[36:39], v[116:119], a[20:23], v[36:39]
    buffer_load_dwordx4 v[164:167], v1, s[8:11], s63 offen offset:2048 sc1
    v_mfma_f32_16x16x32_bf16 v[56:59], v[116:119], a[24:27], v[56:59]
    v_lshlrev_b32 v194, 16, v181
    v_and_b32 v195, 0xffff0000, v181
    v_mfma_f32_16x16x32_bf16 v[76:79], v[116:119], a[28:31], v[76:79]
    s_waitcnt vmcnt(11)
    v_mfma_f32_16x16x32_bf16 v[20:23], v[120:123], a[16:19], v[20:23]
    v_pk_add_f32 v[194:195], v[194:195], v[190:191] op_sel_hi:[1,0]
    v_lshlrev_b32 v196, 16, v182
    v_mfma_f32_16x16x32_bf16 v[40:43], v[120:123], a[20:23], v[40:43]
    buffer_load_dwordx4 v[168:171], v1, s[8:11], s63 offen offset:3072 sc1
    v_mfma_f32_16x16x32_bf16 v[60:63], v[120:123], a[24:27], v[60:63]
    v_and_b32 v197, 0xffff0000, v182
    v_pk_add_f32 v[196:197], v[196:197], v[190:191] op_sel_hi:[1,0]
    v_mfma_f32_16x16x32_bf16 v[80:83], v[120:123], a[28:31], v[80:83]
    s_waitcnt vmcnt(11)
    v_mfma_f32_16x16x32_bf16 v[24:27], v[124:127], a[16:19], v[24:27]
    v_lshlrev_b32 v198, 16, v183
    v_and_b32 v199, 0xffff0000, v183
    v_mfma_f32_16x16x32_bf16 v[44:47], v[124:127], a[20:23], v[44:47]
    buffer_load_dwordx4 v[172:175], v2, s[8:11], s63 offen sc1
    v_mfma_f32_16x16x32_bf16 v[64:67], v[124:127], a[24:27], v[64:67]
    v_pk_add_f32 v[198:199], v[198:199], v[190:191] op_sel_hi:[1,0]
    v_lshlrev_b32 v200, 16, v184
    v_mfma_f32_16x16x32_bf16 v[84:87], v[124:127], a[28:31], v[84:87]
    s_waitcnt vmcnt(11)
    v_mfma_f32_16x16x32_bf16 v[28:31], v[128:131], a[16:19], v[28:31]
    v_and_b32 v201, 0xffff0000, v184
    v_pk_add_f32 v[200:201], v[200:201], v[190:191] op_sel_hi:[1,0]
    v_mfma_f32_16x16x32_bf16 v[48:51], v[128:131], a[20:23], v[48:51]
    buffer_load_dwordx4 v[176:179], v1, s[8:11], s62 offen offset:0 sc1
    v_mfma_f32_16x16x32_bf16 v[68:71], v[128:131], a[24:27], v[68:71]
    s_add_u32 s63, s101, 5
    s_mul_i32 s63, s63, 40960
    v_mfma_f32_16x16x32_bf16 v[88:91], v[128:131], a[28:31], v[88:91]
    v_lshlrev_b32 v202, 16, v185
    v_and_b32 v203, 0xffff0000, v185
    s_waitcnt vmcnt(11)
    v_mfma_f32_16x16x32_bf16 v[32:35], v[132:135], a[16:19], v[32:35]
    s_add_u32 s63, s63, s36
    v_mfma_f32_16x16x32_bf16 v[52:55], v[132:135], a[20:23], v[52:55]
    buffer_load_dwordx4 v[96:99], v1, s[8:11], s62 offen offset:1024 sc1
    v_mfma_f32_16x16x32_bf16 v[72:75], v[132:135], a[24:27], v[72:75]
    v_pk_add_f32 v[202:203], v[202:203], v[190:191] op_sel_hi:[1,0]
    v_lshlrev_b32 v204, 16, v186
    v_mfma_f32_16x16x32_bf16 v[92:95], v[132:135], a[28:31], v[92:95]
    v_and_b32 v205, 0xffff0000, v186
    v_pk_add_f32 v[204:205], v[204:205], v[190:191] op_sel_hi:[1,0]
    s_waitcnt vmcnt(11)
    v_mfma_f32_16x16x32_bf16 v[16:19], v[136:139], a[32:35], v[16:19]
    v_lshlrev_b32 v206, 16, v187
    v_and_b32 v207, 0xffff0000, v187
    v_mfma_f32_16x16x32_bf16 v[36:39], v[136:139], a[36:39], v[36:39]
    buffer_load_dwordx4 v[100:103], v1, s[8:11], s62 offen offset:2048 sc1
    v_mfma_f32_16x16x32_bf16 v[56:59], v[136:139], a[40:43], v[56:59]
    v_pk_add_f32 v[206:207], v[206:207], v[190:191] op_sel_hi:[1,0]
    v_lshlrev_b32 v208, 16, v188
    v_mfma_f32_16x16x32_bf16 v[76:79], v[136:139], a[44:47], v[76:79]
    ds_read_b64_tr_b16 a[64:65], v10 offset:0
    ds_read_b64_tr_b16 a[66:67], v10 offset:1024
    s_waitcnt vmcnt(11)
    v_mfma_f32_16x16x32_bf16 v[20:23], v[140:143], a[32:35], v[20:23]
    v_and_b32 v209, 0xffff0000, v188
    v_pk_add_f32 v[208:209], v[208:209], v[190:191] op_sel_hi:[1,0]
    v_mfma_f32_16x16x32_bf16 v[40:43], v[140:143], a[36:39], v[40:43]
    buffer_load_dwordx4 v[104:107], v1, s[8:11], s62 offen offset:3072 sc1
    v_mfma_f32_16x16x32_bf16 v[60:63], v[140:143], a[40:43], v[60:63]
    v_lshlrev_b32 v210, 16, v189
    v_and_b32 v211, 0xffff0000, v189
    v_mfma_f32_16x16x32_bf16 v[80:83], v[140:143], a[44:47], v[80:83]
    ds_read_b64_tr_b16 a[68:69], v11 offset:0
    ds_read_b64_tr_b16 a[70:71], v11 offset:1024
    s_waitcnt vmcnt(11)
    v_mfma_f32_16x16x32_bf16 v[24:27], v[144:147], a[32:35], v[24:27]
    v_mfma_f32_16x16x32_bf16 v[44:47], v[144:147], a[36:39], v[44:47]
    buffer_load_dwordx4 v[108:111], v2, s[8:11], s62 offen sc1
    v_mfma_f32_16x16x32_bf16 v[64:67], v[144:147], a[40:43], v[64:67]
    v_mfma_f32_16x16x32_bf16 v[84:87], v[144:147], a[44:47], v[84:87]
    s_lshl_b32 s50, s24, 5
    s_add_u32 s50, s50, s26
    s_mul_i32 s50, s50, 64
    s_add_u32 s50, s50, 0xa20000
    v_mov_b32 v242, 163080
    v_mov_b32 v243, 1
    s_mov_b64 exec, 1
    ds_add_rtn_u32 v243, v242, v243
    s_waitcnt lgkmcnt(0)
    v_readfirstlane_b32 s29, v243
    s_nop 0
    s_cmp_eq_u32 s29, 3
    s_cbranch_scc0 L_sg31
    v_mov_b32 v242, s30
    v_mov_b32 v243, s31
    v_mov_b32 v244, 0
    buffer_store_dwordx2 v[242:243], v244, s[8:11], s50 offen sc1
L_sg31:
    s_mov_b64 exec, -1
    v_pk_add_f32 v[210:211], v[210:211], v[190:191] op_sel_hi:[1,0]
    v_lshrrev_b32 v180, 1, v0
    v_lshlrev_b32 v180, 12, v180
    v_and_b32 v181, 1, v0
    ds_read_b64_tr_b16 a[72:73], v12 offset:0
    ds_read_b64_tr_b16 a[74:75], v12 offset:1024
    s_waitcnt vmcnt(11)
    v_mfma_f32_16x16x32_bf16 v[28:31], v[148:151], a[32:35], v[28:31]
    v_lshl_add_u32 v180, v181, 4, v180
    s_mul_i32 s43, s3, 2560
    v_mfma_f32_16x16x32_bf16 v[48:51], v[148:151], a[36:39], v[48:51]
    buffer_load_dwordx4 v[112:115], v1, s[8:11], s63 offen offset:0 sc1
    v_mfma_f32_16x16x32_bf16 v[68:71], v[148:151], a[40:43], v[68:71]
    s_sub_u32 s62, 6, s101
    s_mul_i32 s62, s62, 40960
    v_mfma_f32_16x16x32_bf16 v[88:91], v[148:151], a[44:47], v[88:91]
    s_add_u32 s43, s43, 65536
    v_add_u32 v181, s43, v1
    ds_read_b64_tr_b16 a[76:77], v13 offset:0
    ds_read_b64_tr_b16 a[78:79], v13 offset:1024
    s_waitcnt vmcnt(11)
    v_mfma_f32_16x16x32_bf16 v[32:35], v[152:155], a[32:35], v[32:35]
    s_add_u32 s62, s62, s36
    v_mfma_f32_16x16x32_bf16 v[52:55], v[152:155], a[36:39], v[52:55]
    buffer_load_dwordx4 v[116:119], v1, s[8:11], s63 offen offset:1024 sc1
    v_mfma_f32_16x16x32_bf16 v[72:75], v[152:155], a[40:43], v[72:75]
    v_bfe_u32 v251, v0, 2, 4
    v_lshlrev_b32 v251, 5, v251
    v_mfma_f32_16x16x32_bf16 v[92:95], v[152:155], a[44:47], v[92:95]
    v_and_b32 v182, 3, v0
    v_lshl_add_u32 v251, v182, 3, v251
    s_waitcnt vmcnt(11)
    v_mfma_f32_16x16x32_bf16 v[16:19], v[156:159], a[48:51], v[16:19]
    v_add_u32 v251, s43, v251
    s_mul_i32 s45, s24, 327680
    v_mfma_f32_16x16x32_bf16 v[36:39], v[156:159], a[52:55], v[36:39]
    buffer_load_dwordx4 v[120:123], v1, s[8:11], s63 offen offset:2048 sc1
    v_mfma_f32_16x16x32_bf16 v[56:59], v[156:159], a[56:59], v[56:59]
    s_lshl_b32 s43, s26, 7
    s_add_u32 s45, s45, s43
    v_mfma_f32_16x16x32_bf16 v[76:79], v[156:159], a[60:63], v[76:79]
    ds_read_b64_tr_b16 a[80:81], v10 offset:4096
    ds_read_b64_tr_b16 a[82:83], v10 offset:5120
    s_waitcnt vmcnt(11)
    v_mfma_f32_16x16x32_bf16 v[20:23], v[160:163], a[48:51], v[20:23]
    s_lshl_b32 s43, s3, 5
    s_add_u32 s45, s45, s43
    v_mfma_f32_16x16x32_bf16 v[40:43], v[160:163], a[52:55], v[40:43]
    buffer_load_dwordx4 v[124:127], v1, s[8:11], s63 offen offset:3072 sc1
    v_mfma_f32_16x16x32_bf16 v[60:63], v[160:163], a[56:59], v[60:63]
    s_add_u32 s45, s45, 0x700000
    s_add_u32 s46, s45, 131072
    v_mfma_f32_16x16x32_bf16 v[80:83], v[160:163], a[60:63], v[80:83]
    ds_read_b64_tr_b16 a[84:85], v11 offset:4096
    ds_read_b64_tr_b16 a[86:87], v11 offset:5120
    s_waitcnt vmcnt(11)
    v_mfma_f32_16x16x32_bf16 v[24:27], v[164:167], a[48:51], v[24:27]
    s_add_u32 s47, s45, 262144
    v_mfma_f32_16x16x32_bf16 v[44:47], v[164:167], a[52:55], v[44:47]
    buffer_load_dwordx4 v[128:131], v2, s[8:11], s63 offen sc1
    v_mfma_f32_16x16x32_bf16 v[64:67], v[164:167], a[56:59], v[64:67]
    ds_read_b64_tr_b16 a[88:89], v12 offset:4096
    ds_read_b64_tr_b16 a[90:91], v12 offset:5120
    v_mfma_f32_16x16x32_bf16 v[84:87], v[164:167], a[60:63], v[84:87]
    s_waitcnt vmcnt(11)
    v_mfma_f32_16x16x32_bf16 v[28:31], v[168:171], a[48:51], v[28:31]
    ds_read_b64_tr_b16 a[92:93], v13 offset:4096
    ds_read_b64_tr_b16 a[94:95], v13 offset:5120
    v_mfma_f32_16x16x32_bf16 v[48:51], v[168:171], a[52:55], v[48:51]
    buffer_load_dwordx4 v[132:135], v1, s[8:11], s62 offen offset:0 sc1
    v_mfma_f32_16x16x32_bf16 v[68:71], v[168:171], a[56:59], v[68:71]
    s_sub_u32 s63, 7, s101
    s_mul_i32 s63, s63, 40960
    v_mfma_f32_16x16x32_bf16 v[88:91], v[168:171], a[60:63], v[88:91]
    s_waitcnt vmcnt(11)
    v_mfma_f32_16x16x32_bf16 v[32:35], v[172:175], a[48:51], v[32:35]
    s_add_u32 s63, s63, s36
    v_mfma_f32_16x16x32_bf16 v[52:55], v[172:175], a[52:55], v[52:55]
    buffer_load_dwordx4 v[136:139], v1, s[8:11], s62 offen offset:1024 sc1
    v_mfma_f32_16x16x32_bf16 v[72:75], v[172:175], a[56:59], v[72:75]
    s_waitcnt lgkmcnt(0)
    v_mfma_f32_16x16x32_bf16 v[92:95], v[172:175], a[60:63], v[92:95]
    s_waitcnt vmcnt(11)
    v_mfma_f32_16x16x32_bf16 v[16:19], v[176:179], a[64:67], v[16:19]
    ds_read_b64_tr_b16 a[96:97], v10 offset:8192
    ds_read_b64_tr_b16 a[98:99], v10 offset:9216
    v_mfma_f32_16x16x32_bf16 v[36:39], v[176:179], a[68:71], v[36:39]
    buffer_load_dwordx4 v[140:143], v1, s[8:11], s62 offen offset:2048 sc1
    v_mfma_f32_16x16x32_bf16 v[56:59], v[176:179], a[72:75], v[56:59]
    v_mfma_f32_16x16x32_bf16 v[76:79], v[176:179], a[76:79], v[76:79]
    s_waitcnt vmcnt(11)
    v_mfma_f32_16x16x32_bf16 v[20:23], v[96:99], a[64:67], v[20:23]
    ds_read_b64_tr_b16 a[100:101], v11 offset:8192
    ds_read_b64_tr_b16 a[102:103], v11 offset:9216
    v_mfma_f32_16x16x32_bf16 v[40:43], v[96:99], a[68:71], v[40:43]
    buffer_load_dwordx4 v[144:147], v1, s[8:11], s62 offen offset:3072 sc1
    v_mfma_f32_16x16x32_bf16 v[60:63], v[96:99], a[72:75], v[60:63]
    v_mfma_f32_16x16x32_bf16 v[80:83], v[96:99], a[76:79], v[80:83]
    s_waitcnt vmcnt(11)
    v_mfma_f32_16x16x32_bf16 v[24:27], v[100:103], a[64:67], v[24:27]
    ds_read_b64_tr_b16 a[104:105], v12 offset:8192
    ds_read_b64_tr_b16 a[106:107], v12 offset:9216
    v_mfma_f32_16x16x32_bf16 v[44:47], v[100:103], a[68:71], v[44:47]
    buffer_load_dwordx4 v[148:151], v2, s[8:11], s62 offen sc1
    v_mfma_f32_16x16x32_bf16 v[64:67], v[100:103], a[72:75], v[64:67]
    v_mfma_f32_16x16x32_bf16 v[84:87], v[100:103], a[76:79], v[84:87]
    s_waitcnt vmcnt(11)
    v_mfma_f32_16x16x32_bf16 v[28:31], v[104:107], a[64:67], v[28:31]
    ds_read_b64_tr_b16 a[108:109], v13 offset:8192
    ds_read_b64_tr_b16 a[110:111], v13 offset:9216
    v_mfma_f32_16x16x32_bf16 v[48:51], v[104:107], a[68:71], v[48:51]
    buffer_load_dwordx4 v[152:155], v1, s[8:11], s63 offen offset:0 sc1
    v_mfma_f32_16x16x32_bf16 v[68:71], v[104:107], a[72:75], v[68:71]
    s_sub_u32 s62, 8, s101
    s_mul_i32 s62, s62, 40960
    v_mfma_f32_16x16x32_bf16 v[88:91], v[104:107], a[76:79], v[88:91]
    s_waitcnt vmcnt(11)
    v_mfma_f32_16x16x32_bf16 v[32:35], v[108:111], a[64:67], v[32:35]
    s_add_u32 s62, s62, s36
    v_mfma_f32_16x16x32_bf16 v[52:55], v[108:111], a[68:71], v[52:55]
    buffer_load_dwordx4 v[156:159], v1, s[8:11], s63 offen offset:1024 sc1
    v_mfma_f32_16x16x32_bf16 v[72:75], v[108:111], a[72:75], v[72:75]
    s_waitcnt lgkmcnt(0)
    v_mfma_f32_16x16x32_bf16 v[92:95], v[108:111], a[76:79], v[92:95]
    s_waitcnt vmcnt(11)
    v_mfma_f32_16x16x32_bf16 v[16:19], v[112:115], a[80:83], v[16:19]
    ds_read_b64_tr_b16 a[112:113], v10 offset:12288
    ds_read_b64_tr_b16 a[114:115], v10 offset:13312
    v_mfma_f32_16x16x32_bf16 v[36:39], v[112:115], a[84:87], v[36:39]
    buffer_load_dwordx4 v[160:163], v1, s[8:11], s63 offen offset:2048 sc1
    v_mfma_f32_16x16x32_bf16 v[56:59], v[112:115], a[88:91], v[56:59]
    v_mfma_f32_16x16x32_bf16 v[76:79], v[112:115], a[92:95], v[76:79]
    s_waitcnt vmcnt(11)
    v_mfma_f32_16x16x32_bf16 v[20:23], v[116:119], a[80:83], v[20:23]
    ds_read_b64_tr_b16 a[116:117], v11 offset:12288
    ds_read_b64_tr_b16 a[118:119], v11 offset:13312
    v_mfma_f32_16x16x32_bf16 v[40:43], v[116:119], a[84:87], v[40:43]
    buffer_load_dwordx4 v[164:167], v1, s[8:11], s63 offen offset:3072 sc1
    v_mfma_f32_16x16x32_bf16 v[60:63], v[116:119], a[88:91], v[60:63]
    v_mfma_f32_16x16x32_bf16 v[80:83], v[116:119], a[92:95], v[80:83]
    s_waitcnt vmcnt(11)
    v_mfma_f32_16x16x32_bf16 v[24:27], v[120:123], a[80:83], v[24:27]
    ds_read_b64_tr_b16 a[120:121], v12 offset:12288
    ds_read_b64_tr_b16 a[122:123], v12 offset:13312
    v_mfma_f32_16x16x32_bf16 v[44:47], v[120:123], a[84:87], v[44:47]
    buffer_load_dwordx4 v[168:171], v2, s[8:11], s63 offen sc1
    v_mfma_f32_16x16x32_bf16 v[64:67], v[120:123], a[88:91], v[64:67]
    v_mfma_f32_16x16x32_bf16 v[84:87], v[120:123], a[92:95], v[84:87]
    s_waitcnt vmcnt(11)
    v_mfma_f32_16x16x32_bf16 v[28:31], v[124:127], a[80:83], v[28:31]
    ds_read_b64_tr_b16 a[124:125], v13 offset:12288
    ds_read_b64_tr_b16 a[126:127], v13 offset:13312
    v_mfma_f32_16x16x32_bf16 v[48:51], v[124:127], a[84:87], v[48:51]
    buffer_load_dwordx4 v[172:175], v1, s[8:11], s62 offen offset:0 sc1
    v_mfma_f32_16x16x32_bf16 v[68:71], v[124:127], a[88:91], v[68:71]
    s_sub_u32 s63, 9, s101
    s_mul_i32 s63, s63, 40960
    v_mfma_f32_16x16x32_bf16 v[88:91], v[124:127], a[92:95], v[88:91]
    s_waitcnt vmcnt(11)
    v_mfma_f32_16x16x32_bf16 v[32:35], v[128:131], a[80:83], v[32:35]
    s_add_u32 s63, s63, s36
    v_mfma_f32_16x16x32_bf16 v[52:55], v[128:131], a[84:87], v[52:55]
    buffer_load_dwordx4 v[176:179], v1, s[8:11], s62 offen offset:1024 sc1
    v_mfma_f32_16x16x32_bf16 v[72:75], v[128:131], a[88:91], v[72:75]
    s_waitcnt lgkmcnt(0)
    v_mfma_f32_16x16x32_bf16 v[92:95], v[128:131], a[92:95], v[92:95]
    v_add_u32 v10, 65536, v10
    v_add_u32 v11, 65536, v11
    v_add_u32 v12, 65536, v12
    v_add_u32 v13, 65536, v13
    s_waitcnt vmcnt(11)
    v_mfma_f32_16x16x32_bf16 v[16:19], v[132:135], a[96:99], v[16:19]
    ds_read_b64_tr_b16 a[128:129], v10 offset:0
    ds_read_b64_tr_b16 a[130:131], v10 offset:1024
    v_mfma_f32_16x16x32_bf16 v[36:39], v[132:135], a[100:103], v[36:39]
    buffer_load_dwordx4 v[96:99], v1, s[8:11], s62 offen offset:2048 sc1
    v_mfma_f32_16x16x32_bf16 v[56:59], v[132:135], a[104:107], v[56:59]
    v_mfma_f32_16x16x32_bf16 v[76:79], v[132:135], a[108:111], v[76:79]
    s_waitcnt vmcnt(11)
    v_mfma_f32_16x16x32_bf16 v[20:23], v[136:139], a[96:99], v[20:23]
    ds_read_b64_tr_b16 a[132:133], v11 offset:0
    ds_read_b64_tr_b16 a[134:135], v11 offset:1024
    v_mfma_f32_16x16x32_bf16 v[40:43], v[136:139], a[100:103], v[40:43]
    buffer_load_dwordx4 v[100:103], v1, s[8:11], s62 offen offset:3072 sc1
    v_mfma_f32_16x16x32_bf16 v[60:63], v[136:139], a[104:107], v[60:63]
    v_mfma_f32_16x16x32_bf16 v[80:83], v[136:139], a[108:111], v[80:83]
    s_waitcnt vmcnt(11)
    v_mfma_f32_16x16x32_bf16 v[24:27], v[140:143], a[96:99], v[24:27]
    ds_read_b64_tr_b16 a[136:137], v12 offset:0
    ds_read_b64_tr_b16 a[138:139], v12 offset:1024
    v_mfma_f32_16x16x32_bf16 v[44:47], v[140:143], a[100:103], v[44:47]
    buffer_load_dwordx4 v[104:107], v2, s[8:11], s62 offen sc1
    v_mfma_f32_16x16x32_bf16 v[64:67], v[140:143], a[104:107], v[64:67]
    v_mfma_f32_16x16x32_bf16 v[84:87], v[140:143], a[108:111], v[84:87]
    s_waitcnt vmcnt(11)
    v_mfma_f32_16x16x32_bf16 v[28:31], v[144:147], a[96:99], v[28:31]
    ds_read_b64_tr_b16 a[140:141], v13 offset:0
    ds_read_b64_tr_b16 a[142:143], v13 offset:1024
    v_mfma_f32_16x16x32_bf16 v[48:51], v[144:147], a[100:103], v[48:51]
    buffer_load_dwordx4 v[108:111], v1, s[8:11], s63 offen offset:0 sc1
    v_mfma_f32_16x16x32_bf16 v[68:71], v[144:147], a[104:107], v[68:71]
    s_sub_u32 s62, 10, s101
    s_mul_i32 s62, s62, 40960
    v_mfma_f32_16x16x32_bf16 v[88:91], v[144:147], a[108:111], v[88:91]
    s_waitcnt vmcnt(11)
    v_mfma_f32_16x16x32_bf16 v[32:35], v[148:151], a[96:99], v[32:35]
    s_add_u32 s62, s62, s36
    v_mfma_f32_16x16x32_bf16 v[52:55], v[148:151], a[100:103], v[52:55]
    buffer_load_dwordx4 v[112:115], v1, s[8:11], s63 offen offset:1024 sc1
    v_mfma_f32_16x16x32_bf16 v[72:75], v[148:151], a[104:107], v[72:75]
    s_waitcnt lgkmcnt(0)
    v_mfma_f32_16x16x32_bf16 v[92:95], v[148:151], a[108:111], v[92:95]
    s_waitcnt vmcnt(11)
    v_mfma_f32_16x16x32_bf16 v[16:19], v[152:155], a[112:115], v[16:19]
    ds_read_b64_tr_b16 a[144:145], v10 offset:4096
    ds_read_b64_tr_b16 a[146:147], v10 offset:5120
    v_mfma_f32_16x16x32_bf16 v[36:39], v[152:155], a[116:119], v[36:39]
    buffer_load_dwordx4 v[116:119], v1, s[8:11], s63 offen offset:2048 sc1
    v_mfma_f32_16x16x32_bf16 v[56:59], v[152:155], a[120:123], v[56:59]
    v_mfma_f32_16x16x32_bf16 v[76:79], v[152:155], a[124:127], v[76:79]
    s_waitcnt vmcnt(11)
    v_mfma_f32_16x16x32_bf16 v[20:23], v[156:159], a[112:115], v[20:23]
    ds_read_b64_tr_b16 a[148:149], v11 offset:4096
    ds_read_b64_tr_b16 a[150:151], v11 offset:5120
    v_mfma_f32_16x16x32_bf16 v[40:43], v[156:159], a[116:119], v[40:43]
    buffer_load_dwordx4 v[120:123], v1, s[8:11], s63 offen offset:3072 sc1
    v_mfma_f32_16x16x32_bf16 v[60:63], v[156:159], a[120:123], v[60:63]
    v_mfma_f32_16x16x32_bf16 v[80:83], v[156:159], a[124:127], v[80:83]
    s_waitcnt vmcnt(11)
    v_mfma_f32_16x16x32_bf16 v[24:27], v[160:163], a[112:115], v[24:27]
    ds_read_b64_tr_b16 a[152:153], v12 offset:4096
    ds_read_b64_tr_b16 a[154:155], v12 offset:5120
    v_mfma_f32_16x16x32_bf16 v[44:47], v[160:163], a[116:119], v[44:47]
    buffer_load_dwordx4 v[124:127], v2, s[8:11], s63 offen sc1
    v_mfma_f32_16x16x32_bf16 v[64:67], v[160:163], a[120:123], v[64:67]
    v_mfma_f32_16x16x32_bf16 v[84:87], v[160:163], a[124:127], v[84:87]
    s_waitcnt vmcnt(11)
    v_mfma_f32_16x16x32_bf16 v[28:31], v[164:167], a[112:115], v[28:31]
    ds_read_b64_tr_b16 a[156:157], v13 offset:4096
    ds_read_b64_tr_b16 a[158:159], v13 offset:5120
    v_mfma_f32_16x16x32_bf16 v[48:51], v[164:167], a[116:119], v[48:51]
    buffer_load_dwordx4 v[128:131], v1, s[8:11], s62 offen offset:0 sc1
    v_mfma_f32_16x16x32_bf16 v[68:71], v[164:167], a[120:123], v[68:71]
    s_sub_u32 s63, 11, s101
    s_mul_i32 s63, s63, 40960
    v_mfma_f32_16x16x32_bf16 v[88:91], v[164:167], a[124:127], v[88:91]
    s_waitcnt vmcnt(11)
    v_mfma_f32_16x16x32_bf16 v[32:35], v[168:171], a[112:115], v[32:35]
    s_add_u32 s63, s63, s36
    v_mfma_f32_16x16x32_bf16 v[52:55], v[168:171], a[116:119], v[52:55]
    buffer_load_dwordx4 v[132:135], v1, s[8:11], s62 offen offset:1024 sc1
    v_mfma_f32_16x16x32_bf16 v[72:75], v[168:171], a[120:123], v[72:75]
    s_waitcnt lgkmcnt(0)
    v_mfma_f32_16x16x32_bf16 v[92:95], v[168:171], a[124:127], v[92:95]
    s_waitcnt vmcnt(11)
    v_mfma_f32_16x16x32_bf16 v[16:19], v[172:175], a[128:131], v[16:19]
    ds_read_b64_tr_b16 a[160:161], v10 offset:8192
    ds_read_b64_tr_b16 a[162:163], v10 offset:9216
    v_mfma_f32_16x16x32_bf16 v[36:39], v[172:175], a[132:135], v[36:39]
    buffer_load_dwordx4 v[136:139], v1, s[8:11], s62 offen offset:2048 sc1
    v_mfma_f32_16x16x32_bf16 v[56:59], v[172:175], a[136:139], v[56:59]
    v_mfma_f32_16x16x32_bf16 v[76:79], v[172:175], a[140:143], v[76:79]
    s_waitcnt vmcnt(11)
    v_mfma_f32_16x16x32_bf16 v[20:23], v[176:179], a[128:131], v[20:23]
    ds_read_b64_tr_b16 a[164:165], v11 offset:8192
    ds_read_b64_tr_b16 a[166:167], v11 offset:9216
    v_mfma_f32_16x16x32_bf16 v[40:43], v[176:179], a[132:135], v[40:43]
    buffer_load_dwordx4 v[140:143], v1, s[8:11], s62 offen offset:3072 sc1
    v_mfma_f32_16x16x32_bf16 v[60:63], v[176:179], a[136:139], v[60:63]
    v_mfma_f32_16x16x32_bf16 v[80:83], v[176:179], a[140:143], v[80:83]
    s_waitcnt vmcnt(11)
    v_mfma_f32_16x16x32_bf16 v[24:27], v[96:99], a[128:131], v[24:27]
    ds_read_b64_tr_b16 a[168:169], v12 offset:8192
    ds_read_b64_tr_b16 a[170:171], v12 offset:9216
    v_mfma_f32_16x16x32_bf16 v[44:47], v[96:99], a[132:135], v[44:47]
    buffer_load_dwordx4 v[144:147], v2, s[8:11], s62 offen sc1
    v_mfma_f32_16x16x32_bf16 v[64:67], v[96:99], a[136:139], v[64:67]
    v_mfma_f32_16x16x32_bf16 v[84:87], v[96:99], a[140:143], v[84:87]
    s_waitcnt vmcnt(11)
    v_mfma_f32_16x16x32_bf16 v[28:31], v[100:103], a[128:131], v[28:31]
    ds_read_b64_tr_b16 a[172:173], v13 offset:8192
    ds_read_b64_tr_b16 a[174:175], v13 offset:9216
    v_mfma_f32_16x16x32_bf16 v[48:51], v[100:103], a[132:135], v[48:51]
    buffer_load_dwordx4 v[148:151], v1, s[8:11], s63 offen offset:0 sc1
    v_mfma_f32_16x16x32_bf16 v[68:71], v[100:103], a[136:139], v[68:71]
    v_mfma_f32_16x16x32_bf16 v[88:91], v[100:103], a[140:143], v[88:91]
    s_waitcnt vmcnt(11)
    v_mfma_f32_16x16x32_bf16 v[32:35], v[104:107], a[128:131], v[32:35]
    s_waitcnt lgkmcnt(0)
    v_mfma_f32_16x16x32_bf16 v[52:55], v[104:107], a[132:135], v[52:55]
    buffer_load_dwordx4 v[152:155], v1, s[8:11], s63 offen offset:1024 sc1
    v_mfma_f32_16x16x32_bf16 v[72:75], v[104:107], a[136:139], v[72:75]
    v_mfma_f32_16x16x32_bf16 v[92:95], v[104:107], a[140:143], v[92:95]
    s_waitcnt vmcnt(11)
    v_mfma_f32_16x16x32_bf16 v[16:19], v[108:111], a[144:147], v[16:19]
    ds_read_b64_tr_b16 a[176:177], v10 offset:12288
    ds_read_b64_tr_b16 a[178:179], v10 offset:13312
    v_mfma_f32_16x16x32_bf16 v[36:39], v[108:111], a[148:151], v[36:39]
    buffer_load_dwordx4 v[156:159], v1, s[8:11], s63 offen offset:2048 sc1
    v_mfma_f32_16x16x32_bf16 v[56:59], v[108:111], a[152:155], v[56:59]
    v_mfma_f32_16x16x32_bf16 v[76:79], v[108:111], a[156:159], v[76:79]
    s_waitcnt vmcnt(11)
    v_mfma_f32_16x16x32_bf16 v[20:23], v[112:115], a[144:147], v[20:23]
    ds_read_b64_tr_b16 a[180:181], v11 offset:12288
    ds_read_b64_tr_b16 a[182:183], v11 offset:13312
    v_mfma_f32_16x16x32_bf16 v[40:43], v[112:115], a[148:151], v[40:43]
    buffer_load_dwordx4 v[160:163], v1, s[8:11], s63 offen offset:3072 sc1
    v_mfma_f32_16x16x32_bf16 v[60:63], v[112:115], a[152:155], v[60:63]
    v_mfma_f32_16x16x32_bf16 v[80:83], v[112:115], a[156:159], v[80:83]
    s_waitcnt vmcnt(11)
    v_mfma_f32_16x16x32_bf16 v[24:27], v[116:119], a[144:147], v[24:27]
    ds_read_b64_tr_b16 a[184:185], v12 offset:12288
    ds_read_b64_tr_b16 a[186:187], v12 offset:13312
    v_mfma_f32_16x16x32_bf16 v[44:47], v[116:119], a[148:151], v[44:47]
    buffer_load_dwordx4 v[164:167], v2, s[8:11], s63 offen sc1
    v_mfma_f32_16x16x32_bf16 v[64:67], v[116:119], a[152:155], v[64:67]
    v_mfma_f32_16x16x32_bf16 v[84:87], v[116:119], a[156:159], v[84:87]
    s_waitcnt vmcnt(11)
    v_mfma_f32_16x16x32_bf16 v[28:31], v[120:123], a[144:147], v[28:31]
    ds_read_b64_tr_b16 a[188:189], v13 offset:12288
    ds_read_b64_tr_b16 a[190:191], v13 offset:13312
    v_mfma_f32_16x16x32_bf16 v[48:51], v[120:123], a[148:151], v[48:51]
    v_mfma_f32_16x16x32_bf16 v[68:71], v[120:123], a[152:155], v[68:71]
    v_mfma_f32_16x16x32_bf16 v[88:91], v[120:123], a[156:159], v[88:91]
    s_mov_b32 exec_hi, 0
    buffer_load_dwordx2 v[242:243], v250, s[8:11], s59 offen sc1
    s_mov_b64 exec, -1
    s_waitcnt vmcnt(11)
    v_mfma_f32_16x16x32_bf16 v[32:35], v[124:127], a[144:147], v[32:35]
    s_waitcnt lgkmcnt(0)
    v_mfma_f32_16x16x32_bf16 v[52:55], v[124:127], a[148:151], v[52:55]
    v_mfma_f32_16x16x32_bf16 v[72:75], v[124:127], a[152:155], v[72:75]
    v_mfma_f32_16x16x32_bf16 v[92:95], v[124:127], a[156:159], v[92:95]
    s_waitcnt vmcnt(10)
    v_mfma_f32_16x16x32_bf16 v[16:19], v[128:131], a[160:163], v[16:19]
    v_mfma_f32_16x16x32_bf16 v[36:39], v[128:131], a[164:167], v[36:39]
    v_mfma_f32_16x16x32_bf16 v[56:59], v[128:131], a[168:171], v[56:59]
    v_mfma_f32_16x16x32_bf16 v[76:79], v[128:131], a[172:175], v[76:79]
    s_waitcnt vmcnt(9)
    v_mfma_f32_16x16x32_bf16 v[20:23], v[132:135], a[160:163], v[20:23]
    v_mfma_f32_16x16x32_bf16 v[40:43], v[132:135], a[164:167], v[40:43]
    v_mfma_f32_16x16x32_bf16 v[60:63], v[132:135], a[168:171], v[60:63]
    v_mfma_f32_16x16x32_bf16 v[80:83], v[132:135], a[172:175], v[80:83]
    s_waitcnt vmcnt(8)
    v_mfma_f32_16x16x32_bf16 v[24:27], v[136:139], a[160:163], v[24:27]
    v_mfma_f32_16x16x32_bf16 v[44:47], v[136:139], a[164:167], v[44:47]
    v_mfma_f32_16x16x32_bf16 v[64:67], v[136:139], a[168:171], v[64:67]
    v_mfma_f32_16x16x32_bf16 v[84:87], v[136:139], a[172:175], v[84:87]
    s_waitcnt vmcnt(7)
    v_mfma_f32_16x16x32_bf16 v[28:31], v[140:143], a[160:163], v[28:31]
    v_mfma_f32_16x16x32_bf16 v[48:51], v[140:143], a[164:167], v[48:51]
    v_mfma_f32_16x16x32_bf16 v[68:71], v[140:143], a[168:171], v[68:71]
    v_mfma_f32_16x16x32_bf16 v[88:91], v[140:143], a[172:175], v[88:91]
    s_waitcnt vmcnt(6)
    v_mfma_f32_16x16x32_bf16 v[32:35], v[144:147], a[160:163], v[32:35]
    s_waitcnt lgkmcnt(0)
    s_barrier
    v_mfma_f32_16x16x32_bf16 v[52:55], v[144:147], a[164:167], v[52:55]
    v_mfma_f32_16x16x32_bf16 v[72:75], v[144:147], a[168:171], v[72:75]
    v_mfma_f32_16x16x32_bf16 v[92:95], v[144:147], a[172:175], v[92:95]
    s_waitcnt vmcnt(5)
    v_mfma_f32_16x16x32_bf16 v[36:39], v[148:151], a[180:183], v[36:39]
    s_waitcnt vmcnt(4)
    v_mfma_f32_16x16x32_bf16 v[40:43], v[152:155], a[180:183], v[40:43]
    s_waitcnt vmcnt(3)
    v_mfma_f32_16x16x32_bf16 v[44:47], v[156:159], a[180:183], v[44:47]
    s_waitcnt vmcnt(2)
    v_mfma_f32_16x16x32_bf16 v[48:51], v[160:163], a[180:183], v[48:51]
    s_waitcnt vmcnt(1)
    v_mfma_f32_16x16x32_bf16 v[52:55], v[164:167], a[180:183], v[52:55]
    v_mfma_f32_16x16x32_bf16 v[56:59], v[148:151], a[184:187], v[56:59]
    v_mfma_f32_16x16x32_bf16 v[60:63], v[152:155], a[184:187], v[60:63]
    v_cvt_pk_bf16_f32 v36, v36, v37
    v_cvt_pk_bf16_f32 v37, v38, v39
    v_mfma_f32_16x16x32_bf16 v[64:67], v[156:159], a[184:187], v[64:67]
    v_cvt_pk_bf16_f32 v38, v40, v41
    v_cvt_pk_bf16_f32 v39, v42, v43
    v_mfma_f32_16x16x32_bf16 v[68:71], v[160:163], a[184:187], v[68:71]
    ds_write_b128 v212, v[36:39] offset:0
    v_mfma_f32_16x16x32_bf16 v[72:75], v[164:167], a[184:187], v[72:75]
    v_cvt_pk_bf16_f32 v44, v44, v45
    v_cvt_pk_bf16_f32 v45, v46, v47
    v_mfma_f32_16x16x32_bf16 v[76:79], v[148:151], a[188:191], v[76:79]
    v_mfma_f32_16x16x32_bf16 v[80:83], v[152:155], a[188:191], v[80:83]
    s_waitcnt vmcnt(0)
    s_mov_b32 exec_hi, 0
    v_cmp_ne_u64 vcc, s[30:31], v[242:243]
    s_mov_b64 exec, -1
    s_cbranch_vccz L_cvok
    s_mov_b32 exec_hi, 0
    s_mov_b32 s29, 0
L_pl32:
    buffer_load_dwordx2 v[242:243], v250, s[8:11], s59 offen sc1
    s_add_u32 s29, s29, 1
    s_cmp_gt_u32 s29, 262144
    s_cbranch_scc1 L_pl33
    s_waitcnt vmcnt(0)
    v_cmp_ne_u64 vcc, s[30:31], v[242:243]
    s_cbranch_vccz L_pl33
    s_branch L_pl32
L_pl33:
    s_mov_b64 exec, -1
L_cvok:
    buffer_load_dwordx4 v[216:219], v180, s[8:11], s45 offen sc1
    buffer_load_dwordx4 v[220:223], v180, s[8:11], s46 offen sc1
    s_mov_b32 exec_hi, 0
    buffer_load_dwordx4 v[224:227], v180, s[8:11], s47 offen sc1
    s_mov_b64 exec, -1
    v_cvt_pk_bf16_f32 v46, v48, v49
    v_cvt_pk_bf16_f32 v47, v50, v51
    v_mfma_f32_16x16x32_bf16 v[84:87], v[156:159], a[188:191], v[84:87]
    ds_write_b128 v212, v[44:47] offset:1024
    v_mfma_f32_16x16x32_bf16 v[88:91], v[160:163], a[188:191], v[88:91]
    v_cvt_pk_bf16_f32 v52, v52, v53
    v_cvt_pk_bf16_f32 v53, v54, v55
    v_mfma_f32_16x16x32_bf16 v[92:95], v[164:167], a[188:191], v[92:95]
    ds_write_b64 v212, v[52:53] offset:2048
    v_mfma_f32_16x16x32_bf16 v[16:19], v[148:151], a[176:179], v[16:19]
    v_mfma_f32_16x16x32_bf16 v[20:23], v[152:155], a[176:179], v[20:23]
    v_cvt_pk_bf16_f32 v56, v56, v57
    v_cvt_pk_bf16_f32 v57, v58, v59
    v_mfma_f32_16x16x32_bf16 v[24:27], v[156:159], a[176:179], v[24:27]
    v_cvt_pk_bf16_f32 v58, v60, v61
    v_cvt_pk_bf16_f32 v59, v62, v63
    v_mfma_f32_16x16x32_bf16 v[28:31], v[160:163], a[176:179], v[28:31]
    ds_write_b128 v213, v[56:59] offset:0
    v_mfma_f32_16x16x32_bf16 v[32:35], v[164:167], a[176:179], v[32:35]
    s_nop 0
    v_cvt_pk_bf16_f32 v64, v64, v65
    v_cvt_pk_bf16_f32 v65, v66, v67
    v_cvt_pk_bf16_f32 v66, v68, v69
    v_cvt_pk_bf16_f32 v67, v70, v71
    ds_write_b128 v213, v[64:67] offset:1024
    v_cvt_pk_bf16_f32 v72, v72, v73
    v_cvt_pk_bf16_f32 v73, v74, v75
    ds_write_b64 v213, v[72:73] offset:2048
    v_cvt_pk_bf16_f32 v76, v76, v77
    v_cvt_pk_bf16_f32 v77, v78, v79
    v_cvt_pk_bf16_f32 v78, v80, v81
    v_cvt_pk_bf16_f32 v79, v82, v83
    ds_write_b128 v214, v[76:79] offset:0
    v_cvt_pk_bf16_f32 v84, v84, v85
    v_cvt_pk_bf16_f32 v85, v86, v87
    v_cvt_pk_bf16_f32 v86, v88, v89
    v_cvt_pk_bf16_f32 v87, v90, v91
    ds_write_b128 v214, v[84:87] offset:1024
    v_cvt_pk_bf16_f32 v92, v92, v93
    v_cvt_pk_bf16_f32 v93, v94, v95
    ds_write_b64 v214, v[92:93] offset:2048
    s_waitcnt lgkmcnt(0)
    s_barrier
    s_mov_b32 s98, 0x3f80
    s_mov_b32 s99, 0x3f800000
    s_nop 0
    ds_read_b128 v[36:39], v215 offset:0
    ds_read_b128 v[56:59], v215 offset:5120
    ds_read_b128 v[76:79], v215 offset:10240
    ds_read_b128 v[44:47], v215 offset:1024
    ds_read_b128 v[64:67], v215 offset:6144
    ds_read_b128 v[84:87], v215 offset:11264
    ds_read_b64 v[52:53], v215 offset:2048
    ds_read_b64 v[72:73], v215 offset:7168
    ds_read_b64 v[92:93], v215 offset:12288
    v_pk_add_f32 v[16:17], v[16:17], v[192:193]
    v_pk_add_f32 v[18:19], v[18:19], v[194:195]
    v_pk_add_f32 v[20:21], v[20:21], v[196:197]
    v_pk_add_f32 v[22:23], v[22:23], v[198:199]
    v_pk_add_f32 v[24:25], v[24:25], v[200:201]
    v_pk_add_f32 v[26:27], v[26:27], v[202:203]
    v_pk_add_f32 v[28:29], v[28:29], v[204:205]
    v_pk_add_f32 v[30:31], v[30:31], v[206:207]
    v_pk_add_f32 v[32:33], v[32:33], v[208:209]
    v_pk_add_f32 v[34:35], v[34:35], v[210:211]
    s_waitcnt lgkmcnt(6)
    v_dot2c_f32_bf16 v16, s98, v36
    v_dot2c_f32_bf16 v17, s99, v36
    v_dot2c_f32_bf16 v16, s98, v56
    v_dot2c_f32_bf16 v17, s99, v56
    v_dot2c_f32_bf16 v16, s98, v76
    v_dot2c_f32_bf16 v17, s99, v76
    v_dot2c_f32_bf16 v18, s98, v37
    v_dot2c_f32_bf16 v19, s99, v37
    v_dot2c_f32_bf16 v18, s98, v57
    v_dot2c_f32_bf16 v19, s99, v57
    v_dot2c_f32_bf16 v18, s98, v77
    v_dot2c_f32_bf16 v19, s99, v77
    s_waitcnt lgkmcnt(6)
    v_dot2c_f32_bf16 v20, s98, v38
    v_dot2c_f32_bf16 v21, s99, v38
    v_dot2c_f32_bf16 v20, s98, v58
    v_dot2c_f32_bf16 v21, s99, v58
    v_dot2c_f32_bf16 v20, s98, v78
    v_dot2c_f32_bf16 v21, s99, v78
    v_dot2c_f32_bf16 v22, s98, v39
    v_dot2c_f32_bf16 v23, s99, v39
    v_dot2c_f32_bf16 v22, s98, v59
    v_dot2c_f32_bf16 v23, s99, v59
    v_dot2c_f32_bf16 v22, s98, v79
    v_dot2c_f32_bf16 v23, s99, v79
    s_waitcnt lgkmcnt(3)
    v_dot2c_f32_bf16 v24, s98, v44
    v_dot2c_f32_bf16 v25, s99, v44
    v_dot2c_f32_bf16 v24, s98, v64
    v_dot2c_f32_bf16 v25, s99, v64
    v_dot2c_f32_bf16 v24, s98, v84
    v_dot2c_f32_bf16 v25, s99, v84
    v_dot2c_f32_bf16 v26, s98, v45
    v_dot2c_f32_bf16 v27, s99, v45
    v_dot2c_f32_bf16 v26, s98, v65
    v_dot2c_f32_bf16 v27, s99, v65
    v_dot2c_f32_bf16 v26, s98, v85
    v_dot2c_f32_bf16 v27, s99, v85
    s_waitcnt lgkmcnt(3)
    v_dot2c_f32_bf16 v28, s98, v46
    v_dot2c_f32_bf16 v29, s99, v46
    v_dot2c_f32_bf16 v28, s98, v66
    v_dot2c_f32_bf16 v29, s99, v66
    v_dot2c_f32_bf16 v28, s98, v86
    v_dot2c_f32_bf16 v29, s99, v86
    v_dot2c_f32_bf16 v30, s98, v47
    v_dot2c_f32_bf16 v31, s99, v47
    v_dot2c_f32_bf16 v30, s98, v67
    v_dot2c_f32_bf16 v31, s99, v67
    v_dot2c_f32_bf16 v30, s98, v87
    v_dot2c_f32_bf16 v31, s99, v87
    s_waitcnt lgkmcnt(0)
    v_dot2c_f32_bf16 v32, s98, v52
    v_dot2c_f32_bf16 v33, s99, v52
    v_dot2c_f32_bf16 v32, s98, v72
    v_dot2c_f32_bf16 v33, s99, v72
    v_dot2c_f32_bf16 v32, s98, v92
    v_dot2c_f32_bf16 v33, s99, v92
    v_dot2c_f32_bf16 v34, s98, v53
    v_dot2c_f32_bf16 v35, s99, v53
    v_dot2c_f32_bf16 v34, s98, v73
    v_dot2c_f32_bf16 v35, s99, v73
    v_dot2c_f32_bf16 v34, s98, v93
    v_dot2c_f32_bf16 v35, s99, v93
    s_waitcnt vmcnt(0)
    ds_write_b128 v181, v[216:219] offset:0
    ds_write_b128 v181, v[220:223] offset:1024
    s_mov_b32 exec_hi, 0
    ds_write_b128 v181, v[224:227] offset:2048
    s_mov_b64 exec, -1
    ds_read_b64_tr_b16 v[108:109], v251 offset:0
    ds_read_b64_tr_b16 v[110:111], v251 offset:512
    ds_read_b64_tr_b16 v[112:113], v251 offset:1024
    ds_read_b64_tr_b16 v[114:115], v251 offset:1536
    ds_read_b64_tr_b16 v[116:117], v251 offset:2048
    s_waitcnt lgkmcnt(4)
    v_dot2c_f32_bf16 v16, s98, v108
    v_dot2c_f32_bf16 v17, s99, v108
    v_dot2c_f32_bf16 v18, s98, v109
    v_dot2c_f32_bf16 v19, s99, v109
    s_nop 0
    v_cvt_pk_bf16_f32 v128, v16, v17
    s_nop 0
    v_cvt_pk_bf16_f32 v129, v18, v19
    s_waitcnt lgkmcnt(3)
    v_dot2c_f32_bf16 v20, s98, v110
    v_dot2c_f32_bf16 v21, s99, v110
    v_dot2c_f32_bf16 v22, s98, v111
    v_dot2c_f32_bf16 v23, s99, v111
    s_nop 0
    v_cvt_pk_bf16_f32 v130, v20, v21
    s_nop 0
    v_cvt_pk_bf16_f32 v131, v22, v23
    v_permlane16_swap_b32 v128, v130
    s_nop 0
    v_permlane16_swap_b32 v129, v131
    buffer_store_dwordx4 v[128:131], v246, s[20:23], s39 offen offset:0
    s_waitcnt lgkmcnt(2)
    v_dot2c_f32_bf16 v24, s98, v112
    v_dot2c_f32_bf16 v25, s99, v112
    v_dot2c_f32_bf16 v26, s98, v113
    v_dot2c_f32_bf16 v27, s99, v113
    s_nop 0
    v_cvt_pk_bf16_f32 v132, v24, v25
    s_nop 0
    v_cvt_pk_bf16_f32 v133, v26, v27
    s_waitcnt lgkmcnt(1)
    v_dot2c_f32_bf16 v28, s98, v114
    v_dot2c_f32_bf16 v29, s99, v114
    v_dot2c_f32_bf16 v30, s98, v115
    v_dot2c_f32_bf16 v31, s99, v115
    s_nop 0
    v_cvt_pk_bf16_f32 v134, v28, v29
    s_nop 0
    v_cvt_pk_bf16_f32 v135, v30, v31
    v_permlane16_swap_b32 v132, v134
    s_nop 0
    v_permlane16_swap_b32 v133, v135
    buffer_store_dwordx4 v[132:135], v246, s[20:23], s39 offen offset:64
    s_waitcnt lgkmcnt(0)
    v_dot2c_f32_bf16 v32, s98, v116
    v_dot2c_f32_bf16 v33, s99, v116
    v_dot2c_f32_bf16 v34, s98, v117
    v_dot2c_f32_bf16 v35, s99, v117
    s_nop 0
    v_cvt_pk_bf16_f32 v136, v32, v33
    s_nop 0
    v_cvt_pk_bf16_f32 v137, v34, v35
    buffer_store_dwordx2 v[136:137], v249, s[20:23], s39 offen offset:128
L_end:
    s_endpgm
L_codeend:
.p2align 8
.type gtab,@object
gtab:
.long 2560,2560,2560,2560,2556,2556,2556,2552,2552,2552,2552,2552,2548,2548,2548,2544
.long 2544,2544,2544,2544,2540,2540,2540,2536,2536,2536,2536,2536,2532,2532,2532,2528
.long 2528,2528,2528,2528,2524,2524,2524,2520,2520,2520,2520,2520,2516,2516,2516,2512
.long 2512,2512,2512,2512,2508,2508,2508,2504,2504,2504,2504,2504,2500,2500,2500,2496
.long 2496,2496,2496,2496,2492,2492,2492,2488,2488,2488,2488,2488,2484,2484,2484,2480
.long 2480,2480,2480,2480,2476,2476,2476,2472,2472,2472,2472,2472,2468,2468,2468,2464
.long 2464,2464,2464,2464,2460,2460,2460,2456,2456,2456,2456,2456,2452,2452,2452,2448
.long 2448,2448,2448,2448,2444,2444,2444,2440,2440,2440,2440,2440,2436,2436,2436,2432
.long 2432,2432,2432,2432,2428,2428,2428,2424,2424,2424,2424,2424,2420,2420,2420,2416
.long 2416,2416,2416,2416,2412,2412,2412,2408,2408,2408,2408,2408,2404,2404,2404,2400
.long 2400,2400,2400,2400,2396,2396,2396,2392,2392,2392,2392,2392,2388,2388,2388,2384
.long 2384,2384,2384,2384,2380,2380,2380,2376,2376,2376,2376,2376,2372,2372,2372,2368
.long 2368,2368,2368,2368,2364,2364,2364,2360,2360,2360,2360,2360,2356,2356,2356,2352
.long 2352,2352,2352,2352,2348,2348,2348,2344,2344,2344,2344,2344,2340,2340,2340,2336
.long 2336,2336,2336,2336,2332,2332,2332,2328,2328,2328,2328,2328,2324,2324,2324,2320
.long 2320,2320,2320,2320,2316,2316,2316,2312,2312,2312,2312,2312,2308,2308,2308,2304
.long 2556,2556,2556,2556,2552,2552,2552,2552,2548,2548,2548,2548,2544,2544,2544,2544
.long 2540,2540,2540,2540,2536,2536,2536,2536,2532,2532,2532,2532,2528,2528,2528,2528
.long 2524,2524,2524,2524,2520,2520,2520,2520,2516,2516,2516,2516,2512,2512,2512,2512
.long 2508,2508,2508,2508,2504,2504,2504,2504,2500,2500,2500,2500,2496,2496,2496,2496
.long 2492,2492,2492,2492,2488,2488,2488,2488,2484,2484,2484,2484,2480,2480,2480,2480
.long 2476,2476,2476,2476,2472,2472,2472,2472,2468,2468,2468,2468,2464,2464,2464,2464
.long 2460,2460,2460,2460,2456,2456,2456,2456,2452,2452,2452,2452,2448,2448,2448,2448
.long 2444,2444,2444,2444,2440,2440,2440,2440,2436,2436,2436,2436,2432,2432,2432,2432
.long 2428,2428,2428,2428,2424,2424,2424,2424,2420,2420,2420,2420,2416,2416,2416,2416
.long 2412,2412,2412,2412,2408,2408,2408,2408,2404,2404,2404,2404,2400,2400,2400,2400
.long 2396,2396,2396,2396,2392,2392,2392,2392,2388,2388,2388,2388,2384,2384,2384,2384
.long 2380,2380,2380,2380,2376,2376,2376,2376,2372,2372,2372,2372,2368,2368,2368,2368
.long 2364,2364,2364,2364,2360,2360,2360,2360,2356,2356,2356,2356,2352,2352,2352,2352
.long 2348,2348,2348,2348,2344,2344,2344,2344,2340,2340,2340,2340,2336,2336,2336,2336
.long 2332,2332,2332,2332,2328,2328,2328,2328,2324,2324,2324,2324,2320,2320,2320,2320
.long 2316,2316,2316,2316,2312,2312,2312,2312,2308,2308,2308,2308,2304,2304,2304,2304
.long 2556,0,0,0,2552,0,0,0,2548,0,0,0,2544,0,0,0
.long 2540,0,0,0,2536,0,0,0,2532,0,0,0,2528,0,0,0
.long 2524,0,0,0,2520,0,0,0,2516,0,0,0,2512,0,0,0
.long 2508,0,0,0,2504,0,0,0,2500,0,0,0,2496,0,0,0
.long 2492,0,0,0,2488,0,0,0,2484,0,0,0,2480,0,0,0
.long 2476,0,0,0,2472,0,0,0,2468,0,0,0,2464,0,0,0
.long 2460,0,0,0,2456,0,0,0,2452,0,0,0,2448,0,0,0
.long 2444,0,0,0,2440,0,0,0,2436,0,0,0,2432,0,0,0
.long 2428,0,0,0,2424,0,0,0,2420,0,0,0,2416,0,0,0
.long 2412,0,0,0,2408,0,0,0,2404,0,0,0,2400,0,0,0
.long 2396,0,0,0,2392,0,0,0,2388,0,0,0,2384,0,0,0
.long 2380,0,0,0,2376,0,0,0,2372,0,0,0,2368,0,0,0
.long 2364,0,0,0,2360,0,0,0,2356,0,0,0,2352,0,0,0
.long 2348,0,0,0,2344,0,0,0,2340,0,0,0,2336,0,0,0
.long 2332,0,0,0,2328,0,0,0,2324,0,0,0,2320,0,0,0
.long 2316,0,0,0,2312,0,0,0,2308,0,0,0,2304,0,0,0
.long 2304,2304,2304,2304,2300,2300,2300,2296,2296,2296,2296,2296,2292,2292,2292,2288
.long 2288,2288,2288,2288,2284,2284,2284,2280,2280,2280,2280,2280,2276,2276,2276,2272
.long 2272,2272,2272,2272,2268,2268,2268,2264,2264,2264,2264,2264,2260,2260,2260,2256
.long 2256,2256,2256,2256,2252,2252,2252,2248,2248,2248,2248,2248,2244,2244,2244,2240
.long 2240,2240,2240,2240,2236,2236,2236,2232,2232,2232,2232,2232,2228,2228,2228,2224
.long 2224,2224,2224,2224,2220,2220,2220,2216,2216,2216,2216,2216,2212,2212,2212,2208
.long 2208,2208,2208,2208,2204,2204,2204,2200,2200,2200,2200,2200,2196,2196,2196,2192
.long 2192,2192,2192,2192,2188,2188,2188,2184,2184,2184,2184,2184,2180,2180,2180,2176
.long 2176,2176,2176,2176,2172,2172,2172,2168,2168,2168,2168,2168,2164,2164,2164,2160
.long 2160,2160,2160,2160,2156,2156,2156,2152,2152,2152,2152,2152,2148,2148,2148,2144
.long 2144,2144,2144,2144,2140,2140,2140,2136,2136,2136,2136,2136,2132,2132,2132,2128
.long 2128,2128,2128,2128,2124,2124,2124,2120,2120,2120,2120,2120,2116,2116,2116,2112
.long 2112,2112,2112,2112,2108,2108,2108,2104,2104,2104,2104,2104,2100,2100,2100,2096
.long 2096,2096,2096,2096,2092,2092,2092,2088,2088,2088,2088,2088,2084,2084,2084,2080
.long 2080,2080,2080,2080,2076,2076,2076,2072,2072,2072,2072,2072,2068,2068,2068,2064
.long 2064,2064,2064,2064,2060,2060,2060,2056,2056,2056,2056,2056,2052,2052,2052,2048
.long 2300,2300,2300,2300,2296,2296,2296,2296,2292,2292,2292,2292,2288,2288,2288,2288
.long 2284,2284,2284,2284,2280,2280,2280,2280,2276,2276,2276,2276,2272,2272,2272,2272
.long 2268,2268,2268,2268,2264,2264,2264,2264,2260,2260,2260,2260,2256,2256,2256,2256
.long 2252,2252,2252,2252,2248,2248,2248,2248,2244,2244,2244,2244,2240,2240,2240,2240
.long 2236,2236,2236,2236,2232,2232,2232,2232,2228,2228,2228,2228,2224,2224,2224,2224
.long 2220,2220,2220,2220,2216,2216,2216,2216,2212,2212,2212,2212,2208,2208,2208,2208
.long 2204,2204,2204,2204,2200,2200,2200,2200,2196,2196,2196,2196,2192,2192,2192,2192
.long 2188,2188,2188,2188,2184,2184,2184,2184,2180,2180,2180,2180,2176,2176,2176,2176
.long 2172,2172,2172,2172,2168,2168,2168,2168,2164,2164,2164,2164,2160,2160,2160,2160
.long 2156,2156,2156,2156,2152,2152,2152,2152,2148,2148,2148,2148,2144,2144,2144,2144
.long 2140,2140,2140,2140,2136,2136,2136,2136,2132,2132,2132,2132,2128,2128,2128,2128
.long 2124,2124,2124,2124,2120,2120,2120,2120,2116,2116,2116,2116,2112,2112,2112,2112
.long 2108,2108,2108,2108,2104,2104,2104,2104,2100,2100,2100,2100,2096,2096,2096,2096
.long 2092,2092,2092,2092,2088,2088,2088,2088,2084,2084,2084,2084,2080,2080,2080,2080
.long 2076,2076,2076,2076,2072,2072,2072,2072,2068,2068,2068,2068,2064,2064,2064,2064
.long 2060,2060,2060,2060,2056,2056,2056,2056,2052,2052,2052,2052,2048,2048,2048,2048
.long 2300,0,0,0,2296,0,0,0,2292,0,0,0,2288,0,0,0
.long 2284,0,0,0,2280,0,0,0,2276,0,0,0,2272,0,0,0
.long 2268,0,0,0,2264,0,0,0,2260,0,0,0,2256,0,0,0
.long 2252,0,0,0,2248,0,0,0,2244,0,0,0,2240,0,0,0
.long 2236,0,0,0,2232,0,0,0,2228,0,0,0,2224,0,0,0
.long 2220,0,0,0,2216,0,0,0,2212,0,0,0,2208,0,0,0
.long 2204,0,0,0,2200,0,0,0,2196,0,0,0,2192,0,0,0
.long 2188,0,0,0,2184,0,0,0,2180,0,0,0,2176,0,0,0
.long 2172,0,0,0,2168,0,0,0,2164,0,0,0,2160,0,0,0
.long 2156,0,0,0,2152,0,0,0,2148,0,0,0,2144,0,0,0
.long 2140,0,0,0,2136,0,0,0,2132,0,0,0,2128,0,0,0
.long 2124,0,0,0,2120,0,0,0,2116,0,0,0,2112,0,0,0
.long 2108,0,0,0,2104,0,0,0,2100,0,0,0,2096,0,0,0
.long 2092,0,0,0,2088,0,0,0,2084,0,0,0,2080,0,0,0
.long 2076,0,0,0,2072,0,0,0,2068,0,0,0,2064,0,0,0
.long 2060,0,0,0,2056,0,0,0,2052,0,0,0,2048,0,0,0
.long 2048,2048,2044,2044,1916,1916,2040,2040,1912,1912,2036,2036,1908,1908,2032,2032
.long 1904,1904,2028,2028,1900,1900,2024,2024,1896,1896,2020,2020,1892,1892,2016,2016
.long 1888,1888,2012,2012,1884,1884,2008,2008,1880,1880,2004,2004,1876,1876,2000,2000
.long 1872,1872,1996,1996,1868,1868,1992,1992,1864,1864,1988,1988,1860,1860,1984,1984
.long 1856,1856,1980,1980,1852,1852,1976,1976,1848,1848,1972,1972,1844,1844,1968,1968
.long 1840,1840,1964,1964,1836,1836,1960,1960,1832,1832,1956,1956,1828,1828,1952,1952
.long 1824,1824,1948,1948,1820,1820,1944,1944,1816,1816,1940,1940,1812,1812,1936,1936
.long 1808,1808,1932,1932,1804,1804,1928,1928,1800,1800,1924,1924,1796,1796,1920,1920
.long 1792,1792,1788,1788,1660,1660,1784,1784,1656,1656,1780,1780,1652,1652,1776,1776
.long 1648,1648,1772,1772,1644,1644,1768,1768,1640,1640,1764,1764,1636,1636,1760,1760
.long 1632,1632,1756,1756,1628,1628,1752,1752,1624,1624,1748,1748,1620,1620,1744,1744
.long 1616,1616,1740,1740,1612,1612,1736,1736,1608,1608,1732,1732,1604,1604,1728,1728
.long 1600,1600,1724,1724,1596,1596,1720,1720,1592,1592,1716,1716,1588,1588,1712,1712
.long 1584,1584,1708,1708,1580,1580,1704,1704,1576,1576,1700,1700,1572,1572,1696,1696
.long 1568,1568,1692,1692,1564,1564,1688,1688,1560,1560,1684,1684,1556,1556,1680,1680
.long 1552,1552,1676,1676,1548,1548,1672,1672,1544,1544,1668,1668,1540,1540,1664,1664
.long 2044,1916,1916,1916,2040,1912,1912,1912,2036,1908,1908,1908,2032,1904,1904,1904
.long 2028,1900,1900,1900,2024,1896,1896,1896,2020,1892,1892,1892,2016,1888,1888,1888
.long 2012,1884,1884,1884,2008,1880,1880,1880,2004,1876,1876,1876,2000,1872,1872,1872
.long 1996,1868,1868,1868,1992,1864,1864,1864,1988,1860,1860,1860,1984,1856,1856,1856
.long 1980,1852,1852,1852,1976,1848,1848,1848,1972,1844,1844,1844,1968,1840,1840,1840
.long 1964,1836,1836,1836,1960,1832,1832,1832,1956,1828,1828,1828,1952,1824,1824,1824
.long 1948,1820,1820,1820,1944,1816,1816,1816,1940,1812,1812,1812,1936,1808,1808,1808
.long 1932,1804,1804,1804,1928,1800,1800,1800,1924,1796,1796,1796,1920,1792,1792,1792
.long 1788,1660,1660,1660,1784,1656,1656,1656,1780,1652,1652,1652,1776,1648,1648,1648
.long 1772,1644,1644,1644,1768,1640,1640,1640,1764,1636,1636,1636,1760,1632,1632,1632
.long 1756,1628,1628,1628,1752,1624,1624,1624,1748,1620,1620,1620,1744,1616,1616,1616
.long 1740,1612,1612,1612,1736,1608,1608,1608,1732,1604,1604,1604,1728,1600,1600,1600
.long 1724,1596,1596,1596,1720,1592,1592,1592,1716,1588,1588,1588,1712,1584,1584,1584
.long 1708,1580,1580,1580,1704,1576,1576,1576,1700,1572,1572,1572,1696,1568,1568,1568
.long 1692,1564,1564,1564,1688,1560,1560,1560,1684,1556,1556,1556,1680,1552,1552,1552
.long 1676,1548,1548,1548,1672,1544,1544,1544,1668,1540,1540,1540,1664,1536,1536,1536
.long 1916,0,0,0,1912,0,0,0,1908,0,0,0,1904,0,0,0
.long 1900,0,0,0,1896,0,0,0,1892,0,0,0,1888,0,0,0
.long 1884,0,0,0,1880,0,0,0,1876,0,0,0,1872,0,0,0
.long 1868,0,0,0,1864,0,0,0,1860,0,0,0,1856,0,0,0
.long 1852,0,0,0,1848,0,0,0,1844,0,0,0,1840,0,0,0
.long 1836,0,0,0,1832,0,0,0,1828,0,0,0,1824,0,0,0
.long 1820,0,0,0,1816,0,0,0,1812,0,0,0,1808,0,0,0
.long 1804,0,0,0,1800,0,0,0,1796,0,0,0,1792,0,0,0
.long 1660,0,0,0,1656,0,0,0,1652,0,0,0,1648,0,0,0
.long 1644,0,0,0,1640,0,0,0,1636,0,0,0,1632,0,0,0
.long 1628,0,0,0,1624,0,0,0,1620,0,0,0,1616,0,0,0
.long 1612,0,0,0,1608,0,0,0,1604,0,0,0,1600,0,0,0
.long 1596,0,0,0,1592,0,0,0,1588,0,0,0,1584,0,0,0
.long 1580,0,0,0,1576,0,0,0,1572,0,0,0,1568,0,0,0
.long 1564,0,0,0,1560,0,0,0,1556,0,0,0,1552,0,0,0
.long 1548,0,0,0,1544,0,0,0,1540,0,0,0,1536,0,0,0
.long 1536,1532,1404,1404,1148,1528,1400,1400,1144,1524,1396,1396,1140,1520,1392,1392
.long 1136,1516,1388,1388,1132,1512,1384,1384,1128,1508,1380,1380,1124,1504,1376,1376
.long 1120,1500,1372,1372,1116,1496,1368,1368,1112,1492,1364,1364,1108,1488,1360,1360
.long 1104,1484,1356,1356,1100,1480,1352,1352,1096,1476,1348,1348,1092,1472,1344,1344
.long 1088,1468,1340,1340,1084,1464,1336,1336,1080,1460,1332,1332,1076,1456,1328,1328
.long 1072,1452,1324,1324,1068,1448,1320,1320,1064,1444,1316,1316,1060,1440,1312,1312
.long 1056,1436,1308,1308,1052,1432,1304,1304,1048,1428,1300,1300,1044,1424,1296,1296
.long 1040,1420,1292,1292,1036,1416,1288,1288,1032,1412,1284,1284,1028,1408,1280,1280
.long 1020,892,764,636,1016,888,760,632,1012,884,756,628,1008,880,752,624
.long 1004,876,748,620,1000,872,744,616,996,868,740,612,992,864,736,608
.long 988,860,732,604,984,856,728,600,980,852,724,596,976,848,720,592
.long 972,844,716,588,968,840,712,584,964,836,708,580,960,832,704,576
.long 956,828,700,572,952,824,696,568,948,820,692,564,944,816,688,560
.long 940,812,684,556,936,808,680,552,932,804,676,548,928,800,672,544
.long 924,796,668,540,920,792,664,536,916,788,660,532,912,784,656,528
.long 908,780,652,524,904,776,648,520,900,772,644,516,896,768,640,512
.long 1404,1276,1148,1148,1400,1272,1144,1144,1396,1268,1140,1140,1392,1264,1136,1136
.long 1388,1260,1132,1132,1384,1256,1128,1128,1380,1252,1124,1124,1376,1248,1120,1120
.long 1372,1244,1116,1116,1368,1240,1112,1112,1364,1236,1108,1108,1360,1232,1104,1104
.long 1356,1228,1100,1100,1352,1224,1096,1096,1348,1220,1092,1092,1344,1216,1088,1088
.long 1340,1212,1084,1084,1336,1208,1080,1080,1332,1204,1076,1076,1328,1200,1072,1072
.long 1324,1196,1068,1068,1320,1192,1064,1064,1316,1188,1060,1060,1312,1184,1056,1056
.long 1308,1180,1052,1052,1304,1176,1048,1048,1300,1172,1044,1044,1296,1168,1040,1040
.long 1292,1164,1036,1036,1288,1160,1032,1032,1284,1156,1028,1028,1280,1152,1024,1024
.long 508,380,252,124,504,376,248,120,500,372,244,116,496,368,240,112
.long 492,364,236,108,488,360,232,104,484,356,228,100,480,352,224,96
.long 476,348,220,92,472,344,216,88,468,340,212,84,464,336,208,80
.long 460,332,204,76,456,328,200,72,452,324,196,68,448,320,192,64
.long 444,316,188,60,440,312,184,56,436,308,180,52,432,304,176,48
.long 428,300,172,44,424,296,168,40,420,292,164,36,416,288,160,32
.long 412,284,156,28,408,280,152,24,404,276,148,20,400,272,144,16
.long 396,268,140,12,392,264,136,8,388,260,132,4,384,256,128,0
.long 1148,0,0,0,1144,0,0,0,1140,0,0,0,1136,0,0,0
.long 1132,0,0,0,1128,0,0,0,1124,0,0,0,1120,0,0,0
.long 1116,0,0,0,1112,0,0,0,1108,0,0,0,1104,0,0,0
.long 1100,0,0,0,1096,0,0,0,1092,0,0,0,1088,0,0,0
.long 1084,0,0,0,1080,0,0,0,1076,0,0,0,1072,0,0,0
.long 1068,0,0,0,1064,0,0,0,1060,0,0,0,1056,0,0,0
.long 1052,0,0,0,1048,0,0,0,1044,0,0,0,1040,0,0,0
.long 1036,0,0,0,1032,0,0,0,1028,0,0,0,1020,0,0,0
.long 1016,0,0,0,1012,0,0,0,1008,0,0,0,1004,0,0,0
.long 1000,0,0,0,996,0,0,0,992,0,0,0,988,0,0,0
.long 984,0,0,0,980,0,0,0,976,0,0,0,972,0,0,0
.long 968,0,0,0,964,0,0,0,960,0,0,0,956,0,0,0
.long 952,0,0,0,948,0,0,0,944,0,0,0,940,0,0,0
.long 936,0,0,0,932,0,0,0,928,0,0,0,924,0,0,0
.long 920,0,0,0,916,0,0,0,912,0,0,0,908,0,0,0
.long 904,0,0,0,900,0,0,0,896,0,0,0,2688,0,0,0
.size gtab, 12288
.section .rodata,"a"
.p2align 6
.amdhsa_kernel parallel_sum__ssm_conv_s4d__mixer_token_mlp__prompt_kernel
  .amdhsa_next_free_vgpr 512
  .amdhsa_next_free_sgpr 102
  .amdhsa_accum_offset 256
  .amdhsa_group_segment_fixed_size 0
  .amdhsa_kernarg_size 120
  .amdhsa_user_sgpr_count 2
  .amdhsa_user_sgpr_kernarg_segment_ptr 1
  .amdhsa_system_sgpr_workgroup_id_x 1
  .amdhsa_float_denorm_mode_32 3
.end_amdhsa_kernel
```
